```python
import torch

def _softmax(x, axis=-1):
    return torch.softmax(x, dim=axis)
def _gelu(x):
    return torch.nn.functional.gelu(x, approximate="tanh")
def _silu(x):
    return torch.nn.functional.silu(x)
def _sigmoid(x):
    return torch.sigmoid(x)
def _layernorm(x, axis=-1, eps=1e-5):
    m = x.mean(dim=axis, keepdim=True)
    v = x.var(dim=axis, keepdim=True, unbiased=False)
    return (x - m) / torch.sqrt(v + eps)
def _scatter_add(tgt, idx, src, axis=0):
    return tgt.clone().index_add_(axis, idx, src)
def _segment_sum(src, seg, n):
    out = torch.zeros((n,) + src.shape[1:], dtype=src.dtype)
    return out.index_add_(0, seg, src)
def _pad(x, pw):
    flat = tuple(v for pair in reversed(pw) for v in pair)
    return torch.nn.functional.pad(x, flat)

kernel_name = 'recurrent_scan__mha_block_cached__geglu_ffn__decode'

def setup_inputs():

    _w = (lambda a: (lambda t: t.to(torch.bfloat16) if t.is_floating_point() else t)(torch.as_tensor(a)))
    def _A_setup():
        B, Sq, D = 4, 1, 512
        H, Sk, Dh = 32, 8192, 128
        return {
            "x": _w((lambda *s: torch.randn(*s, dtype=torch.bfloat16) * 0.05)(B, Sq, D)),
            "k_cache": _w((lambda *s: torch.randn(*s, dtype=torch.bfloat16) * 1.6)(B, H, Sk, Dh)),
            "v_cache": _w((lambda *s: torch.randn(*s, dtype=torch.bfloat16) * 0.2)(B, H, Sk, Dh)),
            "wq": _w((lambda *s: torch.randn(*s, dtype=torch.bfloat16) * 1.6)(D, H * Dh) * (D ** -0.5)),
            "wo": _w((lambda *s: torch.randn(*s, dtype=torch.bfloat16) * 0.2)(H * Dh, D) * ((H * Dh) ** -0.5)),
        }
    _A_in = _A_setup()

    def _B_setup():
        B, S, D, F = 4, 1, 512, 1376
        return {
            "x": _w((lambda *s: torch.randn(*s, dtype=torch.bfloat16) * 0.05)(B, S, D)),
            "w_gate": _w((lambda *s: torch.randn(*s, dtype=torch.bfloat16) * 0.1)(D, F)),
            "w_up": _w((lambda *s: torch.randn(*s, dtype=torch.bfloat16) * 0.1)(D, F)),
            "w_down": _w((lambda *s: torch.randn(*s, dtype=torch.bfloat16) * 0.1)(F, D)),
        }
    _B_in = _B_setup()

    return {
        "A_x": _A_in["x"],
        "A_k_cache": _A_in["k_cache"],
        "A_v_cache": _A_in["v_cache"],
        "A_wq": _A_in["wq"],
        "A_wo": _A_in["wo"],
        "B_x": _B_in["x"],
        "B_w_gate": _B_in["w_gate"],
        "B_w_up": _B_in["w_up"],
        "B_w_down": _B_in["w_down"],
    }

def reference(A_x, A_k_cache, A_v_cache, A_wq, A_wo, B_x, B_w_gate, B_w_up, B_w_down):
    def _A_ref(x, k_cache, v_cache, wq, wo):
        B, Sq, D = x.shape
        H, Dh = 32, 128
        q = (lambda x, *d: x.permute(*d))((x @ wq).reshape(B, Sq, H, Dh), 0, 2, 1, 3)
        scores = torch.einsum("bhqd,bhkd->bhqk", q, k_cache) * (Dh ** -0.5)
        p = _softmax(scores, axis=-1)
        o = torch.einsum("bhqk,bhkd->bhqd", p, v_cache)
        return (lambda x, *d: x.permute(*d))(o, 0, 2, 1, 3).reshape(B, Sq, H * Dh) @ wo

    def _B_ref(x, w_gate, w_up, w_down):
        return (_gelu(x @ w_gate) * (x @ w_up)) @ w_down

    x = A_x
    xn = _layernorm(x, axis=-1)
    s = _A_ref(xn, A_k_cache, A_v_cache, A_wq, A_wo)
    g = _silu(_B_ref(xn, B_w_gate, B_w_up, B_w_down))
    return x + s * g
```

```asm
; @launch grid=(256,1,1) block=(512,1,1) lds=98304
.amdgcn_target "amdgcn-amd-amdhsa--gfx950"
.text
.globl recurrent_scan__mha_block_cached__geglu_ffn__decode_kernel
.p2align 8
.type recurrent_scan__mha_block_cached__geglu_ffn__decode_kernel,@function
recurrent_scan__mha_block_cached__geglu_ffn__decode_kernel:
  s_cmp_ge_u32 s2, 0x100
  s_cbranch_scc1 L_exit
  s_load_dwordx2 s[12:13], s[0:1], 8
  s_load_dwordx2 s[16:17], s[0:1], 16
  v_lshrrev_b32 v1, 6, v0
  v_and_b32 v2, 63, v0
  v_readfirstlane_b32 s3, v1
  s_nop 1
  s_cmp_ge_u32 s3, 4
  s_cbranch_scc1 L_helper
L_stream:
  s_and_b32 s23, s2, 7
  s_bfe_u32 s30, s2, 0x20003
  s_lshl_b32 s30, s30, 3
  s_add_u32 s23, s23, s30
  s_lshr_b32 s30, s2, 6
  s_lshl_b32 s30, s30, 5
  s_add_u32 s23, s23, s30
  s_lshl_b32 s23, s23, 1
  s_bfe_u32 s30, s2, 0x10005
  s_add_u32 s23, s23, s30
  s_lshl_b32 s20, s23, 20
  s_lshl_b32 s30, s3, 10
  v_lshlrev_b32 v3, 4, v2
  v_add_u32 v3, s30, v3
  s_mov_b32 s21, s20
  s_mul_i32 s31, s3, 16384
  s_add_u32 s31, s31, 32768
  s_mov_b32 s14, 0x10000000
  s_mov_b32 s15, 0x20000
  s_waitcnt lgkmcnt(0)
  buffer_load_dwordx4 v[48:51], v3, s[12:15], s21 offen nt
  s_add_u32 s21, s21, 0x1000
  buffer_load_dwordx4 v[52:55], v3, s[12:15], s21 offen nt
  s_add_u32 s21, s21, 0x1000
  buffer_load_dwordx4 v[56:59], v3, s[12:15], s21 offen nt
  s_add_u32 s21, s21, 0x1000
  buffer_load_dwordx4 v[60:63], v3, s[12:15], s21 offen nt
  s_add_u32 s21, s21, 0x1000
  buffer_load_dwordx4 v[64:67], v3, s[12:15], s21 offen nt
  s_add_u32 s21, s21, 0x1000
  s_mov_b32 s18, 0x10000000
  s_mov_b32 s19, 0x20000
  s_mov_b32 s24, 0xaaaaaaaa
  s_mov_b32 s25, 0xaaaaaaaa
  s_mov_b32 s26, 0xcccccccc
  s_mov_b32 s27, 0xcccccccc
  s_mov_b32 s28, 0x3db504f3
  s_mov_b32 s29, 0x3fb8aa3b
  s_lshl_b32 s30, s3, 12
  v_lshlrev_b32 v4, 2, v2
  v_add_u32 v4, s30, v4
  v_mov_b32 v5, 0xff800000
  v_and_b32 v1, 15, v2
  v_lshlrev_b32 v1, 5, v1
  s_lshl_b32 s30, s3, 2
  v_mov_b32 v44, s30
  v_lshlrev_b32 v46, 4, v2
  v_add_u32 v46, s31, v46
  s_setprio 2
  s_waitcnt vmcnt(4)
  buffer_load_dwordx4 v[68:71], v3, s[12:15], s21 offen nt
  s_add_u32 s21, s21, 0x1000
  s_waitcnt vmcnt(4)
  buffer_load_dwordx4 v[72:75], v3, s[12:15], s21 offen nt
  s_add_u32 s21, s21, 0x1000
  s_waitcnt vmcnt(4)
  buffer_load_dwordx4 v[76:79], v3, s[12:15], s21 offen nt
  s_add_u32 s21, s21, 0x1000
  s_waitcnt vmcnt(4)
  buffer_load_dwordx4 v[80:83], v3, s[12:15], s21 offen nt
  s_add_u32 s21, s21, 0x1000
  s_waitcnt vmcnt(4)
  buffer_load_dwordx4 v[84:87], v3, s[12:15], s21 offen nt
  s_add_u32 s21, s21, 0x1000
  s_waitcnt vmcnt(4)
  buffer_load_dwordx4 v[88:91], v3, s[12:15], s21 offen nt
  s_add_u32 s21, s21, 0x1000
  s_waitcnt vmcnt(4)
  buffer_load_dwordx4 v[92:95], v3, s[12:15], s21 offen nt
  s_add_u32 s21, s21, 0x1000
  s_waitcnt vmcnt(4)
  buffer_load_dwordx4 v[96:99], v3, s[12:15], s21 offen nt
  s_add_u32 s21, s21, 0x1000
  s_waitcnt vmcnt(4)
  buffer_load_dwordx4 v[100:103], v3, s[12:15], s21 offen nt
  s_add_u32 s21, s21, 0x1000
  s_waitcnt vmcnt(4)
  buffer_load_dwordx4 v[104:107], v3, s[12:15], s21 offen nt
  s_add_u32 s21, s21, 0x1000
  s_waitcnt vmcnt(4)
  buffer_load_dwordx4 v[108:111], v3, s[12:15], s21 offen nt
  s_add_u32 s21, s21, 0x1000
  s_waitcnt vmcnt(4)
  buffer_load_dwordx4 v[112:115], v3, s[12:15], s21 offen nt
  s_add_u32 s21, s21, 0x1000
  s_waitcnt vmcnt(4)
  buffer_load_dwordx4 v[116:119], v3, s[12:15], s21 offen nt
  s_add_u32 s21, s21, 0x1000
  s_waitcnt vmcnt(4)
  buffer_load_dwordx4 v[120:123], v3, s[12:15], s21 offen nt
  s_add_u32 s21, s21, 0x1000
  s_waitcnt vmcnt(4)
  buffer_load_dwordx4 v[124:127], v3, s[12:15], s21 offen nt
  s_add_u32 s21, s21, 0x1000
  s_waitcnt vmcnt(4)
  buffer_load_dwordx4 v[128:131], v3, s[12:15], s21 offen nt
  s_add_u32 s21, s21, 0x1000
  s_waitcnt vmcnt(4)
  buffer_load_dwordx4 v[132:135], v3, s[12:15], s21 offen nt
  s_add_u32 s21, s21, 0x1000
  s_waitcnt vmcnt(4)
  buffer_load_dwordx4 v[136:139], v3, s[12:15], s21 offen nt
  s_add_u32 s21, s21, 0x1000
  s_waitcnt vmcnt(4)
  buffer_load_dwordx4 v[140:143], v3, s[12:15], s21 offen nt
  s_add_u32 s21, s21, 0x1000
  s_waitcnt vmcnt(4)
  buffer_load_dwordx4 v[144:147], v3, s[12:15], s21 offen nt
  s_add_u32 s21, s21, 0x1000
  s_waitcnt vmcnt(4)
  buffer_load_dwordx4 v[148:151], v3, s[12:15], s21 offen nt
  s_add_u32 s21, s21, 0x1000
  s_waitcnt vmcnt(4)
  buffer_load_dwordx4 v[152:155], v3, s[12:15], s21 offen nt
  s_add_u32 s21, s21, 0x1000
  s_waitcnt vmcnt(4)
  buffer_load_dwordx4 v[156:159], v3, s[12:15], s21 offen nt
  s_add_u32 s21, s21, 0x1000
  s_waitcnt vmcnt(4)
  buffer_load_dwordx4 v[160:163], v3, s[12:15], s21 offen nt
  s_add_u32 s21, s21, 0x1000
  s_waitcnt vmcnt(4)
  buffer_load_dwordx4 v[164:167], v3, s[12:15], s21 offen nt
  s_add_u32 s21, s21, 0x1000
  s_waitcnt vmcnt(4)
  buffer_load_dwordx4 v[168:171], v3, s[12:15], s21 offen nt
  s_add_u32 s21, s21, 0x1000
  s_waitcnt vmcnt(4)
  buffer_load_dwordx4 v[172:175], v3, s[12:15], s21 offen nt
  s_add_u32 s21, s21, 0x1000
  s_waitcnt vmcnt(4)
  buffer_load_dwordx4 v[176:179], v3, s[12:15], s21 offen nt
  s_add_u32 s21, s21, 0x1000
  s_waitcnt vmcnt(4)
  buffer_load_dwordx4 v[180:183], v3, s[12:15], s21 offen nt
  s_add_u32 s21, s21, 0x1000
  s_waitcnt vmcnt(4)
  buffer_load_dwordx4 v[184:187], v3, s[12:15], s21 offen nt
  s_add_u32 s21, s21, 0x1000
  s_waitcnt vmcnt(4)
  buffer_load_dwordx4 v[188:191], v3, s[12:15], s21 offen nt
  s_add_u32 s21, s21, 0x1000
  s_waitcnt vmcnt(4)
  buffer_load_dwordx4 v[192:195], v3, s[12:15], s21 offen nt
  s_add_u32 s21, s21, 0x1000
  s_waitcnt vmcnt(4)
  buffer_load_dwordx4 v[196:199], v3, s[12:15], s21 offen nt
  s_add_u32 s21, s21, 0x1000
  s_waitcnt vmcnt(4)
  buffer_load_dwordx4 v[200:203], v3, s[12:15], s21 offen nt
  s_add_u32 s21, s21, 0x1000
  s_waitcnt vmcnt(4)
  buffer_load_dwordx4 v[204:207], v3, s[12:15], s21 offen nt
  s_add_u32 s21, s21, 0x1000
  s_waitcnt vmcnt(4)
  buffer_load_dwordx4 v[208:211], v3, s[12:15], s21 offen nt
  s_add_u32 s21, s21, 0x1000
  s_waitcnt vmcnt(4)
  buffer_load_dwordx4 v[212:215], v3, s[12:15], s21 offen nt
  s_add_u32 s21, s21, 0x1000
  s_waitcnt vmcnt(4)
  buffer_load_dwordx4 v[216:219], v3, s[12:15], s21 offen nt
  s_add_u32 s21, s21, 0x1000
  s_waitcnt vmcnt(4)
  buffer_load_dwordx4 v[220:223], v3, s[12:15], s21 offen nt
  s_add_u32 s21, s21, 0x1000
  s_waitcnt vmcnt(4)
  buffer_load_dwordx4 v[224:227], v3, s[12:15], s21 offen nt
  s_add_u32 s21, s21, 0x1000
  s_waitcnt vmcnt(4)
  buffer_load_dwordx4 v[228:231], v3, s[12:15], s21 offen nt
  s_add_u32 s21, s21, 0x1000
  s_waitcnt vmcnt(4)
  buffer_load_dwordx4 v[232:235], v3, s[12:15], s21 offen nt
  s_add_u32 s21, s21, 0x1000
  s_waitcnt vmcnt(4)
  buffer_load_dwordx4 v[236:239], v3, s[12:15], s21 offen nt
  s_add_u32 s21, s21, 0x1000
  s_waitcnt vmcnt(4)
  s_add_u32 m0, s31, 0
  s_nop 0
  buffer_load_dwordx4 v3, s[12:15], s21 offen nt lds
  s_add_u32 s21, s21, 0x1000
  s_waitcnt vmcnt(4)
  s_add_u32 m0, s31, 1024
  s_nop 0
  buffer_load_dwordx4 v3, s[12:15], s21 offen nt lds
  s_add_u32 s21, s21, 0x1000
  s_waitcnt vmcnt(4)
  s_add_u32 m0, s31, 2048
  s_nop 0
  buffer_load_dwordx4 v3, s[12:15], s21 offen nt lds
  s_add_u32 s21, s21, 0x1000
  s_waitcnt vmcnt(4)
  s_add_u32 m0, s31, 3072
  s_nop 0
  buffer_load_dwordx4 v3, s[12:15], s21 offen nt lds
  s_add_u32 s21, s21, 0x1000
  s_waitcnt vmcnt(4)
  s_add_u32 m0, s31, 4096
  s_nop 0
  buffer_load_dwordx4 v3, s[12:15], s21 offen nt lds
  s_add_u32 s21, s21, 0x1000
  s_waitcnt vmcnt(4)
  s_add_u32 m0, s31, 5120
  s_nop 0
  buffer_load_dwordx4 v3, s[12:15], s21 offen nt lds
  s_add_u32 s21, s21, 0x1000
  s_waitcnt vmcnt(4)
  s_add_u32 m0, s31, 6144
  s_nop 0
  buffer_load_dwordx4 v3, s[12:15], s21 offen nt lds
  s_add_u32 s21, s21, 0x1000
  s_waitcnt vmcnt(4)
  s_add_u32 m0, s31, 7168
  s_nop 0
  buffer_load_dwordx4 v3, s[12:15], s21 offen nt lds
  s_add_u32 s21, s21, 0x1000
  s_waitcnt vmcnt(4)
  s_add_u32 m0, s31, 8192
  s_nop 0
  buffer_load_dwordx4 v3, s[12:15], s21 offen nt lds
  s_add_u32 s21, s21, 0x1000
  s_waitcnt vmcnt(4)
  s_add_u32 m0, s31, 9216
  s_nop 0
  buffer_load_dwordx4 v3, s[12:15], s21 offen nt lds
  s_add_u32 s21, s21, 0x1000
  s_waitcnt vmcnt(4)
  s_add_u32 m0, s31, 10240
  s_nop 0
  buffer_load_dwordx4 v3, s[12:15], s21 offen nt lds
  s_add_u32 s21, s21, 0x1000
  s_waitcnt vmcnt(4)
  s_add_u32 m0, s31, 11264
  s_nop 0
  buffer_load_dwordx4 v3, s[12:15], s21 offen nt lds
  s_add_u32 s21, s21, 0x1000
  s_waitcnt vmcnt(4)
  s_add_u32 m0, s31, 12288
  s_nop 0
  buffer_load_dwordx4 v3, s[12:15], s21 offen nt lds
  s_add_u32 s21, s21, 0x1000
  s_waitcnt vmcnt(4)
  s_add_u32 m0, s31, 13312
  s_nop 0
  buffer_load_dwordx4 v3, s[12:15], s21 offen nt lds
  s_add_u32 s21, s21, 0x1000
  s_waitcnt vmcnt(4)
  s_add_u32 m0, s31, 14336
  s_nop 0
  buffer_load_dwordx4 v3, s[12:15], s21 offen nt lds
  s_add_u32 s21, s21, 0x1000
  s_waitcnt vmcnt(4)
  s_add_u32 m0, s31, 15360
  s_nop 0
  buffer_load_dwordx4 v3, s[12:15], s21 offen nt lds
  s_add_u32 s21, s21, 0x1000
  s_barrier
  ds_read_b128 v[12:15], v1 offset:16384
  ds_read_b128 v[16:19], v1 offset:16400
  ds_read_b128 v[20:23], v1 offset:16896
  ds_read_b128 v[24:27], v1 offset:16912
  ds_read_b128 v[28:31], v1 offset:17408
  ds_read_b128 v[32:35], v1 offset:17424
  ds_read_b128 v[36:39], v1 offset:17920
  ds_read_b128 v[40:43], v1 offset:17936
  s_waitcnt lgkmcnt(4)
  v_add_f32 v12, v12, v20
  v_add_f32 v13, v13, v21
  v_add_f32 v14, v14, v22
  v_add_f32 v15, v15, v23
  v_add_f32 v16, v16, v24
  v_add_f32 v17, v17, v25
  v_add_f32 v18, v18, v26
  v_add_f32 v19, v19, v27
  s_waitcnt lgkmcnt(0)
  v_add_f32 v28, v28, v36
  v_add_f32 v29, v29, v37
  v_add_f32 v30, v30, v38
  v_add_f32 v31, v31, v39
  v_add_f32 v32, v32, v40
  v_add_f32 v33, v33, v41
  v_add_f32 v34, v34, v42
  v_add_f32 v35, v35, v43
  v_add_f32 v12, v12, v28
  v_add_f32 v13, v13, v29
  v_add_f32 v14, v14, v30
  v_add_f32 v15, v15, v31
  v_add_f32 v16, v16, v32
  v_add_f32 v17, v17, v33
  v_add_f32 v18, v18, v34
  v_add_f32 v19, v19, v35
  v_cvt_pk_bf16_f32 v8, v12, v13
  v_cvt_pk_bf16_f32 v9, v14, v15
  v_cvt_pk_bf16_f32 v10, v16, v17
  v_cvt_pk_bf16_f32 v11, v18, v19
  v_dot2_f32_bf16 v12, v48, v8, 0
  v_dot2_f32_bf16 v12, v49, v9, v12
  v_dot2_f32_bf16 v12, v50, v10, v12
  v_dot2_f32_bf16 v12, v51, v11, v12
  buffer_load_dwordx4 v[48:51], v3, s[12:15], s21 offen nt
  s_add_u32 s21, s21, 0x1000
  v_dot2_f32_bf16 v13, v52, v8, 0
  v_dot2_f32_bf16 v13, v53, v9, v13
  v_dot2_f32_bf16 v13, v54, v10, v13
  v_dot2_f32_bf16 v13, v55, v11, v13
  buffer_load_dwordx4 v[52:55], v3, s[12:15], s21 offen nt
  s_add_u32 s21, s21, 0x1000
  v_dot2_f32_bf16 v14, v56, v8, 0
  v_dot2_f32_bf16 v14, v57, v9, v14
  v_dot2_f32_bf16 v14, v58, v10, v14
  v_dot2_f32_bf16 v14, v59, v11, v14
  buffer_load_dwordx4 v[56:59], v3, s[12:15], s21 offen nt
  s_add_u32 s21, s21, 0x1000
  v_dot2_f32_bf16 v15, v60, v8, 0
  v_dot2_f32_bf16 v15, v61, v9, v15
  v_dot2_f32_bf16 v15, v62, v10, v15
  v_dot2_f32_bf16 v15, v63, v11, v15
  buffer_load_dwordx4 v[60:63], v3, s[12:15], s21 offen nt
  s_add_u32 s21, s21, 0x1000
  v_dot2_f32_bf16 v16, v64, v8, 0
  v_dot2_f32_bf16 v16, v65, v9, v16
  v_dot2_f32_bf16 v16, v66, v10, v16
  v_dot2_f32_bf16 v16, v67, v11, v16
  buffer_load_dwordx4 v[64:67], v3, s[12:15], s21 offen nt
  s_add_u32 s21, s21, 0x1000
  v_dot2_f32_bf16 v17, v68, v8, 0
  v_dot2_f32_bf16 v17, v69, v9, v17
  v_dot2_f32_bf16 v17, v70, v10, v17
  v_dot2_f32_bf16 v17, v71, v11, v17
  v_dot2_f32_bf16 v18, v72, v8, 0
  v_dot2_f32_bf16 v18, v73, v9, v18
  v_dot2_f32_bf16 v18, v74, v10, v18
  v_dot2_f32_bf16 v18, v75, v11, v18
  v_dot2_f32_bf16 v19, v76, v8, 0
  v_dot2_f32_bf16 v19, v77, v9, v19
  v_dot2_f32_bf16 v19, v78, v10, v19
  v_dot2_f32_bf16 v19, v79, v11, v19
  v_dot2_f32_bf16 v20, v80, v8, 0
  v_dot2_f32_bf16 v20, v81, v9, v20
  v_dot2_f32_bf16 v20, v82, v10, v20
  v_dot2_f32_bf16 v20, v83, v11, v20
  v_dot2_f32_bf16 v21, v84, v8, 0
  v_dot2_f32_bf16 v21, v85, v9, v21
  v_dot2_f32_bf16 v21, v86, v10, v21
  v_dot2_f32_bf16 v21, v87, v11, v21
  v_add_f32_dpp v12, v12, v12 row_ror:8 row_mask:0xf bank_mask:0x3
  v_add_f32_dpp v12, v20, v20 row_ror:8 row_mask:0xf bank_mask:0xc
  v_dot2_f32_bf16 v22, v88, v8, 0
  v_dot2_f32_bf16 v22, v89, v9, v22
  v_dot2_f32_bf16 v22, v90, v10, v22
  v_dot2_f32_bf16 v22, v91, v11, v22
  v_add_f32_dpp v13, v13, v13 row_ror:8 row_mask:0xf bank_mask:0x3
  v_add_f32_dpp v13, v21, v21 row_ror:8 row_mask:0xf bank_mask:0xc
  v_dot2_f32_bf16 v23, v92, v8, 0
  v_dot2_f32_bf16 v23, v93, v9, v23
  v_dot2_f32_bf16 v23, v94, v10, v23
  v_dot2_f32_bf16 v23, v95, v11, v23
  v_add_f32_dpp v14, v14, v14 row_ror:8 row_mask:0xf bank_mask:0x3
  v_add_f32_dpp v14, v22, v22 row_ror:8 row_mask:0xf bank_mask:0xc
  v_dot2_f32_bf16 v24, v96, v8, 0
  v_dot2_f32_bf16 v24, v97, v9, v24
  v_dot2_f32_bf16 v24, v98, v10, v24
  v_dot2_f32_bf16 v24, v99, v11, v24
  v_add_f32_dpp v15, v15, v15 row_ror:8 row_mask:0xf bank_mask:0x3
  v_add_f32_dpp v15, v23, v23 row_ror:8 row_mask:0xf bank_mask:0xc
  v_dot2_f32_bf16 v25, v100, v8, 0
  v_dot2_f32_bf16 v25, v101, v9, v25
  v_dot2_f32_bf16 v25, v102, v10, v25
  v_dot2_f32_bf16 v25, v103, v11, v25
  v_add_f32_dpp v16, v16, v16 row_ror:8 row_mask:0xf bank_mask:0x3
  v_add_f32_dpp v16, v24, v24 row_ror:8 row_mask:0xf bank_mask:0xc
  v_dot2_f32_bf16 v26, v104, v8, 0
  v_dot2_f32_bf16 v26, v105, v9, v26
  v_dot2_f32_bf16 v26, v106, v10, v26
  v_dot2_f32_bf16 v26, v107, v11, v26
  v_add_f32_dpp v17, v17, v17 row_ror:8 row_mask:0xf bank_mask:0x3
  v_add_f32_dpp v17, v25, v25 row_ror:8 row_mask:0xf bank_mask:0xc
  v_dot2_f32_bf16 v27, v108, v8, 0
  v_dot2_f32_bf16 v27, v109, v9, v27
  v_dot2_f32_bf16 v27, v110, v10, v27
  v_dot2_f32_bf16 v27, v111, v11, v27
  v_add_f32_dpp v18, v18, v18 row_ror:8 row_mask:0xf bank_mask:0x3
  v_add_f32_dpp v18, v26, v26 row_ror:8 row_mask:0xf bank_mask:0xc
  s_nop 0
  v_add_f32_dpp v19, v19, v19 row_ror:8 row_mask:0xf bank_mask:0x3
  v_add_f32_dpp v19, v27, v27 row_ror:8 row_mask:0xf bank_mask:0xc
  v_add_f32_dpp v12, v12, v12 row_half_mirror row_mask:0xf bank_mask:0x5
  v_add_f32_dpp v12, v16, v16 row_half_mirror row_mask:0xf bank_mask:0xa
  v_add_f32_dpp v13, v13, v13 row_half_mirror row_mask:0xf bank_mask:0x5
  v_add_f32_dpp v13, v17, v17 row_half_mirror row_mask:0xf bank_mask:0xa
  v_add_f32_dpp v14, v14, v14 row_half_mirror row_mask:0xf bank_mask:0x5
  v_add_f32_dpp v14, v18, v18 row_half_mirror row_mask:0xf bank_mask:0xa
  v_add_f32_dpp v15, v15, v15 row_half_mirror row_mask:0xf bank_mask:0x5
  v_add_f32_dpp v15, v19, v19 row_half_mirror row_mask:0xf bank_mask:0xa
  s_nop 0
  v_add_f32_dpp v12, v12, v12 quad_perm:[2,3,0,1] row_mask:0xf bank_mask:0xf
  v_add_f32_dpp v13, v13, v13 quad_perm:[2,3,0,1] row_mask:0xf bank_mask:0xf
  v_add_f32_dpp v14, v14, v14 quad_perm:[2,3,0,1] row_mask:0xf bank_mask:0xf
  v_add_f32_dpp v15, v15, v15 quad_perm:[2,3,0,1] row_mask:0xf bank_mask:0xf
  v_cndmask_b32_e64 v12, v12, v14, s[26:27]
  v_cndmask_b32_e64 v13, v13, v15, s[26:27]
  s_nop 0
  v_add_f32_dpp v12, v12, v12 quad_perm:[1,0,3,2] row_mask:0xf bank_mask:0xf
  v_add_f32_dpp v13, v13, v13 quad_perm:[1,0,3,2] row_mask:0xf bank_mask:0xf
  v_cndmask_b32_e64 v12, v12, v13, s[24:25]
  v_cvt_pk_bf16_f32 v12, v12, v12
  v_and_b32 v12, 0xffff0000, v12
  v_mul_f32 v12, s28, v12
  v_cvt_pk_bf16_f32 v12, v12, v12
  v_and_b32 v12, 0xffff0000, v12
  v_max_f32 v5, v5, v12
  ds_write_b32 v4, v12 offset:0
  v_add_u32 v4, 0x100, v4
  v_dot2_f32_bf16 v12, v112, v8, 0
  v_dot2_f32_bf16 v12, v113, v9, v12
  v_dot2_f32_bf16 v12, v114, v10, v12
  v_dot2_f32_bf16 v12, v115, v11, v12
  v_dot2_f32_bf16 v13, v116, v8, 0
  v_dot2_f32_bf16 v13, v117, v9, v13
  v_dot2_f32_bf16 v13, v118, v10, v13
  v_dot2_f32_bf16 v13, v119, v11, v13
  v_dot2_f32_bf16 v14, v120, v8, 0
  v_dot2_f32_bf16 v14, v121, v9, v14
  v_dot2_f32_bf16 v14, v122, v10, v14
  v_dot2_f32_bf16 v14, v123, v11, v14
  v_dot2_f32_bf16 v15, v124, v8, 0
  v_dot2_f32_bf16 v15, v125, v9, v15
  v_dot2_f32_bf16 v15, v126, v10, v15
  v_dot2_f32_bf16 v15, v127, v11, v15
  v_dot2_f32_bf16 v16, v128, v8, 0
  v_dot2_f32_bf16 v16, v129, v9, v16
  v_dot2_f32_bf16 v16, v130, v10, v16
  v_dot2_f32_bf16 v16, v131, v11, v16
  v_dot2_f32_bf16 v17, v132, v8, 0
  v_dot2_f32_bf16 v17, v133, v9, v17
  v_dot2_f32_bf16 v17, v134, v10, v17
  v_dot2_f32_bf16 v17, v135, v11, v17
  v_dot2_f32_bf16 v18, v136, v8, 0
  v_dot2_f32_bf16 v18, v137, v9, v18
  v_dot2_f32_bf16 v18, v138, v10, v18
  v_dot2_f32_bf16 v18, v139, v11, v18
  v_dot2_f32_bf16 v19, v140, v8, 0
  v_dot2_f32_bf16 v19, v141, v9, v19
  v_dot2_f32_bf16 v19, v142, v10, v19
  v_dot2_f32_bf16 v19, v143, v11, v19
  v_dot2_f32_bf16 v20, v144, v8, 0
  v_dot2_f32_bf16 v20, v145, v9, v20
  v_dot2_f32_bf16 v20, v146, v10, v20
  v_dot2_f32_bf16 v20, v147, v11, v20
  v_dot2_f32_bf16 v21, v148, v8, 0
  v_dot2_f32_bf16 v21, v149, v9, v21
  v_dot2_f32_bf16 v21, v150, v10, v21
  v_dot2_f32_bf16 v21, v151, v11, v21
  v_add_f32_dpp v12, v12, v12 row_ror:8 row_mask:0xf bank_mask:0x3
  v_add_f32_dpp v12, v20, v20 row_ror:8 row_mask:0xf bank_mask:0xc
  v_dot2_f32_bf16 v22, v152, v8, 0
  v_dot2_f32_bf16 v22, v153, v9, v22
  v_dot2_f32_bf16 v22, v154, v10, v22
  v_dot2_f32_bf16 v22, v155, v11, v22
  v_add_f32_dpp v13, v13, v13 row_ror:8 row_mask:0xf bank_mask:0x3
  v_add_f32_dpp v13, v21, v21 row_ror:8 row_mask:0xf bank_mask:0xc
  v_dot2_f32_bf16 v23, v156, v8, 0
  v_dot2_f32_bf16 v23, v157, v9, v23
  v_dot2_f32_bf16 v23, v158, v10, v23
  v_dot2_f32_bf16 v23, v159, v11, v23
  v_add_f32_dpp v14, v14, v14 row_ror:8 row_mask:0xf bank_mask:0x3
  v_add_f32_dpp v14, v22, v22 row_ror:8 row_mask:0xf bank_mask:0xc
  v_dot2_f32_bf16 v24, v160, v8, 0
  v_dot2_f32_bf16 v24, v161, v9, v24
  v_dot2_f32_bf16 v24, v162, v10, v24
  v_dot2_f32_bf16 v24, v163, v11, v24
  v_add_f32_dpp v15, v15, v15 row_ror:8 row_mask:0xf bank_mask:0x3
  v_add_f32_dpp v15, v23, v23 row_ror:8 row_mask:0xf bank_mask:0xc
  v_dot2_f32_bf16 v25, v164, v8, 0
  v_dot2_f32_bf16 v25, v165, v9, v25
  v_dot2_f32_bf16 v25, v166, v10, v25
  v_dot2_f32_bf16 v25, v167, v11, v25
  v_add_f32_dpp v16, v16, v16 row_ror:8 row_mask:0xf bank_mask:0x3
  v_add_f32_dpp v16, v24, v24 row_ror:8 row_mask:0xf bank_mask:0xc
  s_waitcnt vmcnt(4)
  buffer_load_dwordx4 v[68:71], v3, s[12:15], s21 offen nt
  s_add_u32 s21, s21, 0x1000
  v_dot2_f32_bf16 v26, v168, v8, 0
  v_dot2_f32_bf16 v26, v169, v9, v26
  v_dot2_f32_bf16 v26, v170, v10, v26
  v_dot2_f32_bf16 v26, v171, v11, v26
  v_add_f32_dpp v17, v17, v17 row_ror:8 row_mask:0xf bank_mask:0x3
  v_add_f32_dpp v17, v25, v25 row_ror:8 row_mask:0xf bank_mask:0xc
  v_dot2_f32_bf16 v27, v172, v8, 0
  v_dot2_f32_bf16 v27, v173, v9, v27
  v_dot2_f32_bf16 v27, v174, v10, v27
  v_dot2_f32_bf16 v27, v175, v11, v27
  v_add_f32_dpp v18, v18, v18 row_ror:8 row_mask:0xf bank_mask:0x3
  v_add_f32_dpp v18, v26, v26 row_ror:8 row_mask:0xf bank_mask:0xc
  s_nop 0
  v_add_f32_dpp v19, v19, v19 row_ror:8 row_mask:0xf bank_mask:0x3
  v_add_f32_dpp v19, v27, v27 row_ror:8 row_mask:0xf bank_mask:0xc
  v_add_f32_dpp v12, v12, v12 row_half_mirror row_mask:0xf bank_mask:0x5
  v_add_f32_dpp v12, v16, v16 row_half_mirror row_mask:0xf bank_mask:0xa
  v_add_f32_dpp v13, v13, v13 row_half_mirror row_mask:0xf bank_mask:0x5
  v_add_f32_dpp v13, v17, v17 row_half_mirror row_mask:0xf bank_mask:0xa
  v_add_f32_dpp v14, v14, v14 row_half_mirror row_mask:0xf bank_mask:0x5
  v_add_f32_dpp v14, v18, v18 row_half_mirror row_mask:0xf bank_mask:0xa
  v_add_f32_dpp v15, v15, v15 row_half_mirror row_mask:0xf bank_mask:0x5
  v_add_f32_dpp v15, v19, v19 row_half_mirror row_mask:0xf bank_mask:0xa
  s_nop 0
  v_add_f32_dpp v12, v12, v12 quad_perm:[2,3,0,1] row_mask:0xf bank_mask:0xf
  v_add_f32_dpp v13, v13, v13 quad_perm:[2,3,0,1] row_mask:0xf bank_mask:0xf
  v_add_f32_dpp v14, v14, v14 quad_perm:[2,3,0,1] row_mask:0xf bank_mask:0xf
  v_add_f32_dpp v15, v15, v15 quad_perm:[2,3,0,1] row_mask:0xf bank_mask:0xf
  v_cndmask_b32_e64 v12, v12, v14, s[26:27]
  v_cndmask_b32_e64 v13, v13, v15, s[26:27]
  s_nop 0
  v_add_f32_dpp v12, v12, v12 quad_perm:[1,0,3,2] row_mask:0xf bank_mask:0xf
  v_add_f32_dpp v13, v13, v13 quad_perm:[1,0,3,2] row_mask:0xf bank_mask:0xf
  v_cndmask_b32_e64 v12, v12, v13, s[24:25]
  v_cvt_pk_bf16_f32 v12, v12, v12
  v_and_b32 v12, 0xffff0000, v12
  v_mul_f32 v12, s28, v12
  v_cvt_pk_bf16_f32 v12, v12, v12
  v_and_b32 v12, 0xffff0000, v12
  v_max_f32 v5, v5, v12
  ds_write_b32 v4, v12 offset:0
  v_add_u32 v4, 0x100, v4
  v_dot2_f32_bf16 v12, v176, v8, 0
  v_dot2_f32_bf16 v12, v177, v9, v12
  v_dot2_f32_bf16 v12, v178, v10, v12
  v_dot2_f32_bf16 v12, v179, v11, v12
  v_dot2_f32_bf16 v13, v180, v8, 0
  v_dot2_f32_bf16 v13, v181, v9, v13
  v_dot2_f32_bf16 v13, v182, v10, v13
  v_dot2_f32_bf16 v13, v183, v11, v13
  v_dot2_f32_bf16 v14, v184, v8, 0
  v_dot2_f32_bf16 v14, v185, v9, v14
  v_dot2_f32_bf16 v14, v186, v10, v14
  v_dot2_f32_bf16 v14, v187, v11, v14
  v_dot2_f32_bf16 v15, v188, v8, 0
  v_dot2_f32_bf16 v15, v189, v9, v15
  v_dot2_f32_bf16 v15, v190, v10, v15
  v_dot2_f32_bf16 v15, v191, v11, v15
  s_waitcnt vmcnt(4)
  buffer_load_dwordx4 v[72:75], v3, s[12:15], s21 offen nt
  s_add_u32 s21, s21, 0x1000
  v_dot2_f32_bf16 v16, v192, v8, 0
  v_dot2_f32_bf16 v16, v193, v9, v16
  v_dot2_f32_bf16 v16, v194, v10, v16
  v_dot2_f32_bf16 v16, v195, v11, v16
  v_dot2_f32_bf16 v17, v196, v8, 0
  v_dot2_f32_bf16 v17, v197, v9, v17
  v_dot2_f32_bf16 v17, v198, v10, v17
  v_dot2_f32_bf16 v17, v199, v11, v17
  v_dot2_f32_bf16 v18, v200, v8, 0
  v_dot2_f32_bf16 v18, v201, v9, v18
  v_dot2_f32_bf16 v18, v202, v10, v18
  v_dot2_f32_bf16 v18, v203, v11, v18
  v_dot2_f32_bf16 v19, v204, v8, 0
  v_dot2_f32_bf16 v19, v205, v9, v19
  v_dot2_f32_bf16 v19, v206, v10, v19
  v_dot2_f32_bf16 v19, v207, v11, v19
  v_dot2_f32_bf16 v20, v208, v8, 0
  v_dot2_f32_bf16 v20, v209, v9, v20
  v_dot2_f32_bf16 v20, v210, v10, v20
  v_dot2_f32_bf16 v20, v211, v11, v20
  v_dot2_f32_bf16 v21, v212, v8, 0
  v_dot2_f32_bf16 v21, v213, v9, v21
  v_dot2_f32_bf16 v21, v214, v10, v21
  v_dot2_f32_bf16 v21, v215, v11, v21
  v_add_f32_dpp v12, v12, v12 row_ror:8 row_mask:0xf bank_mask:0x3
  v_add_f32_dpp v12, v20, v20 row_ror:8 row_mask:0xf bank_mask:0xc
  s_waitcnt vmcnt(4)
  buffer_load_dwordx4 v[76:79], v3, s[12:15], s21 offen nt
  s_add_u32 s21, s21, 0x1000
  v_dot2_f32_bf16 v22, v216, v8, 0
  v_dot2_f32_bf16 v22, v217, v9, v22
  v_dot2_f32_bf16 v22, v218, v10, v22
  v_dot2_f32_bf16 v22, v219, v11, v22
  v_add_f32_dpp v13, v13, v13 row_ror:8 row_mask:0xf bank_mask:0x3
  v_add_f32_dpp v13, v21, v21 row_ror:8 row_mask:0xf bank_mask:0xc
  v_dot2_f32_bf16 v23, v220, v8, 0
  v_dot2_f32_bf16 v23, v221, v9, v23
  v_dot2_f32_bf16 v23, v222, v10, v23
  v_dot2_f32_bf16 v23, v223, v11, v23
  v_add_f32_dpp v14, v14, v14 row_ror:8 row_mask:0xf bank_mask:0x3
  v_add_f32_dpp v14, v22, v22 row_ror:8 row_mask:0xf bank_mask:0xc
  v_dot2_f32_bf16 v24, v224, v8, 0
  v_dot2_f32_bf16 v24, v225, v9, v24
  v_dot2_f32_bf16 v24, v226, v10, v24
  v_dot2_f32_bf16 v24, v227, v11, v24
  v_add_f32_dpp v15, v15, v15 row_ror:8 row_mask:0xf bank_mask:0x3
  v_add_f32_dpp v15, v23, v23 row_ror:8 row_mask:0xf bank_mask:0xc
  v_dot2_f32_bf16 v25, v228, v8, 0
  v_dot2_f32_bf16 v25, v229, v9, v25
  v_dot2_f32_bf16 v25, v230, v10, v25
  v_dot2_f32_bf16 v25, v231, v11, v25
  v_add_f32_dpp v16, v16, v16 row_ror:8 row_mask:0xf bank_mask:0x3
  v_add_f32_dpp v16, v24, v24 row_ror:8 row_mask:0xf bank_mask:0xc
  v_dot2_f32_bf16 v26, v232, v8, 0
  v_dot2_f32_bf16 v26, v233, v9, v26
  v_dot2_f32_bf16 v26, v234, v10, v26
  v_dot2_f32_bf16 v26, v235, v11, v26
  v_add_f32_dpp v17, v17, v17 row_ror:8 row_mask:0xf bank_mask:0x3
  v_add_f32_dpp v17, v25, v25 row_ror:8 row_mask:0xf bank_mask:0xc
  v_dot2_f32_bf16 v27, v236, v8, 0
  v_dot2_f32_bf16 v27, v237, v9, v27
  v_dot2_f32_bf16 v27, v238, v10, v27
  v_dot2_f32_bf16 v27, v239, v11, v27
  v_add_f32_dpp v18, v18, v18 row_ror:8 row_mask:0xf bank_mask:0x3
  v_add_f32_dpp v18, v26, v26 row_ror:8 row_mask:0xf bank_mask:0xc
  s_nop 0
  v_add_f32_dpp v19, v19, v19 row_ror:8 row_mask:0xf bank_mask:0x3
  v_add_f32_dpp v19, v27, v27 row_ror:8 row_mask:0xf bank_mask:0xc
  v_add_f32_dpp v12, v12, v12 row_half_mirror row_mask:0xf bank_mask:0x5
  v_add_f32_dpp v12, v16, v16 row_half_mirror row_mask:0xf bank_mask:0xa
  v_add_f32_dpp v13, v13, v13 row_half_mirror row_mask:0xf bank_mask:0x5
  v_add_f32_dpp v13, v17, v17 row_half_mirror row_mask:0xf bank_mask:0xa
  v_add_f32_dpp v14, v14, v14 row_half_mirror row_mask:0xf bank_mask:0x5
  v_add_f32_dpp v14, v18, v18 row_half_mirror row_mask:0xf bank_mask:0xa
  v_add_f32_dpp v15, v15, v15 row_half_mirror row_mask:0xf bank_mask:0x5
  v_add_f32_dpp v15, v19, v19 row_half_mirror row_mask:0xf bank_mask:0xa
  s_nop 0
  v_add_f32_dpp v12, v12, v12 quad_perm:[2,3,0,1] row_mask:0xf bank_mask:0xf
  v_add_f32_dpp v13, v13, v13 quad_perm:[2,3,0,1] row_mask:0xf bank_mask:0xf
  v_add_f32_dpp v14, v14, v14 quad_perm:[2,3,0,1] row_mask:0xf bank_mask:0xf
  v_add_f32_dpp v15, v15, v15 quad_perm:[2,3,0,1] row_mask:0xf bank_mask:0xf
  v_cndmask_b32_e64 v12, v12, v14, s[26:27]
  v_cndmask_b32_e64 v13, v13, v15, s[26:27]
  s_nop 0
  v_add_f32_dpp v12, v12, v12 quad_perm:[1,0,3,2] row_mask:0xf bank_mask:0xf
  v_add_f32_dpp v13, v13, v13 quad_perm:[1,0,3,2] row_mask:0xf bank_mask:0xf
  v_cndmask_b32_e64 v12, v12, v13, s[24:25]
  v_cvt_pk_bf16_f32 v12, v12, v12
  v_and_b32 v12, 0xffff0000, v12
  v_mul_f32 v12, s28, v12
  v_cvt_pk_bf16_f32 v12, v12, v12
  v_and_b32 v12, 0xffff0000, v12
  v_max_f32 v5, v5, v12
  ds_write_b32 v4, v12 offset:0
  v_add_u32 v4, 0x100, v4
  ds_read_b128 v[112:115], v46 offset:0
  ds_read_b128 v[116:119], v46 offset:1024
  ds_read_b128 v[120:123], v46 offset:2048
  ds_read_b128 v[124:127], v46 offset:3072
  ds_read_b128 v[128:131], v46 offset:4096
  ds_read_b128 v[132:135], v46 offset:5120
  ds_read_b128 v[136:139], v46 offset:6144
  ds_read_b128 v[140:143], v46 offset:7168
  ds_read_b128 v[144:147], v46 offset:8192
  ds_read_b128 v[148:151], v46 offset:9216
  ds_read_b128 v[152:155], v46 offset:10240
  ds_read_b128 v[156:159], v46 offset:11264
  ds_read_b128 v[160:163], v46 offset:12288
  ds_read_b128 v[164:167], v46 offset:13312
  ds_read_b128 v[168:171], v46 offset:14336
  ds_read_b128 v[172:175], v46 offset:15360
  s_waitcnt lgkmcnt(15)
  s_waitcnt vmcnt(4)
  buffer_load_dwordx4 v[80:83], v3, s[12:15], s21 offen nt
  s_add_u32 s21, s21, 0x1000
  v_dot2_f32_bf16 v12, v112, v8, 0
  v_dot2_f32_bf16 v12, v113, v9, v12
  v_dot2_f32_bf16 v12, v114, v10, v12
  v_dot2_f32_bf16 v12, v115, v11, v12
  s_waitcnt lgkmcnt(14)
  v_dot2_f32_bf16 v13, v116, v8, 0
  v_dot2_f32_bf16 v13, v117, v9, v13
  v_dot2_f32_bf16 v13, v118, v10, v13
  v_dot2_f32_bf16 v13, v119, v11, v13
  s_waitcnt lgkmcnt(13)
  v_dot2_f32_bf16 v14, v120, v8, 0
  v_dot2_f32_bf16 v14, v121, v9, v14
  v_dot2_f32_bf16 v14, v122, v10, v14
  v_dot2_f32_bf16 v14, v123, v11, v14
  s_waitcnt lgkmcnt(12)
  v_dot2_f32_bf16 v15, v124, v8, 0
  v_dot2_f32_bf16 v15, v125, v9, v15
  v_dot2_f32_bf16 v15, v126, v10, v15
  v_dot2_f32_bf16 v15, v127, v11, v15
  s_waitcnt lgkmcnt(11)
  v_dot2_f32_bf16 v16, v128, v8, 0
  v_dot2_f32_bf16 v16, v129, v9, v16
  v_dot2_f32_bf16 v16, v130, v10, v16
  v_dot2_f32_bf16 v16, v131, v11, v16
  s_waitcnt lgkmcnt(10)
  v_dot2_f32_bf16 v17, v132, v8, 0
  v_dot2_f32_bf16 v17, v133, v9, v17
  v_dot2_f32_bf16 v17, v134, v10, v17
  v_dot2_f32_bf16 v17, v135, v11, v17
  s_waitcnt lgkmcnt(9)
  s_waitcnt vmcnt(4)
  buffer_load_dwordx4 v[84:87], v3, s[12:15], s21 offen nt
  s_add_u32 s21, s21, 0x1000
  v_dot2_f32_bf16 v18, v136, v8, 0
  v_dot2_f32_bf16 v18, v137, v9, v18
  v_dot2_f32_bf16 v18, v138, v10, v18
  v_dot2_f32_bf16 v18, v139, v11, v18
  s_waitcnt lgkmcnt(8)
  v_dot2_f32_bf16 v19, v140, v8, 0
  v_dot2_f32_bf16 v19, v141, v9, v19
  v_dot2_f32_bf16 v19, v142, v10, v19
  v_dot2_f32_bf16 v19, v143, v11, v19
  s_waitcnt lgkmcnt(7)
  v_dot2_f32_bf16 v20, v144, v8, 0
  v_dot2_f32_bf16 v20, v145, v9, v20
  v_dot2_f32_bf16 v20, v146, v10, v20
  v_dot2_f32_bf16 v20, v147, v11, v20
  s_waitcnt lgkmcnt(6)
  v_dot2_f32_bf16 v21, v148, v8, 0
  v_dot2_f32_bf16 v21, v149, v9, v21
  v_dot2_f32_bf16 v21, v150, v10, v21
  v_dot2_f32_bf16 v21, v151, v11, v21
  v_add_f32_dpp v12, v12, v12 row_ror:8 row_mask:0xf bank_mask:0x3
  v_add_f32_dpp v12, v20, v20 row_ror:8 row_mask:0xf bank_mask:0xc
  s_waitcnt lgkmcnt(5)
  v_dot2_f32_bf16 v22, v152, v8, 0
  v_dot2_f32_bf16 v22, v153, v9, v22
  v_dot2_f32_bf16 v22, v154, v10, v22
  v_dot2_f32_bf16 v22, v155, v11, v22
  v_add_f32_dpp v13, v13, v13 row_ror:8 row_mask:0xf bank_mask:0x3
  v_add_f32_dpp v13, v21, v21 row_ror:8 row_mask:0xf bank_mask:0xc
  s_waitcnt lgkmcnt(4)
  v_dot2_f32_bf16 v23, v156, v8, 0
  v_dot2_f32_bf16 v23, v157, v9, v23
  v_dot2_f32_bf16 v23, v158, v10, v23
  v_dot2_f32_bf16 v23, v159, v11, v23
  v_add_f32_dpp v14, v14, v14 row_ror:8 row_mask:0xf bank_mask:0x3
  v_add_f32_dpp v14, v22, v22 row_ror:8 row_mask:0xf bank_mask:0xc
  s_waitcnt lgkmcnt(3)
  s_waitcnt vmcnt(4)
  buffer_load_dwordx4 v[88:91], v3, s[12:15], s21 offen nt
  s_add_u32 s21, s21, 0x1000
  v_dot2_f32_bf16 v24, v160, v8, 0
  v_dot2_f32_bf16 v24, v161, v9, v24
  v_dot2_f32_bf16 v24, v162, v10, v24
  v_dot2_f32_bf16 v24, v163, v11, v24
  v_add_f32_dpp v15, v15, v15 row_ror:8 row_mask:0xf bank_mask:0x3
  v_add_f32_dpp v15, v23, v23 row_ror:8 row_mask:0xf bank_mask:0xc
  s_waitcnt lgkmcnt(2)
  v_dot2_f32_bf16 v25, v164, v8, 0
  v_dot2_f32_bf16 v25, v165, v9, v25
  v_dot2_f32_bf16 v25, v166, v10, v25
  v_dot2_f32_bf16 v25, v167, v11, v25
  v_add_f32_dpp v16, v16, v16 row_ror:8 row_mask:0xf bank_mask:0x3
  v_add_f32_dpp v16, v24, v24 row_ror:8 row_mask:0xf bank_mask:0xc
  s_waitcnt lgkmcnt(1)
  v_dot2_f32_bf16 v26, v168, v8, 0
  v_dot2_f32_bf16 v26, v169, v9, v26
  v_dot2_f32_bf16 v26, v170, v10, v26
  v_dot2_f32_bf16 v26, v171, v11, v26
  v_add_f32_dpp v17, v17, v17 row_ror:8 row_mask:0xf bank_mask:0x3
  v_add_f32_dpp v17, v25, v25 row_ror:8 row_mask:0xf bank_mask:0xc
  s_waitcnt lgkmcnt(0)
  v_dot2_f32_bf16 v27, v172, v8, 0
  v_dot2_f32_bf16 v27, v173, v9, v27
  v_dot2_f32_bf16 v27, v174, v10, v27
  v_dot2_f32_bf16 v27, v175, v11, v27
  v_add_f32_dpp v18, v18, v18 row_ror:8 row_mask:0xf bank_mask:0x3
  v_add_f32_dpp v18, v26, v26 row_ror:8 row_mask:0xf bank_mask:0xc
  s_nop 0
  v_add_f32_dpp v19, v19, v19 row_ror:8 row_mask:0xf bank_mask:0x3
  v_add_f32_dpp v19, v27, v27 row_ror:8 row_mask:0xf bank_mask:0xc
  v_add_f32_dpp v12, v12, v12 row_half_mirror row_mask:0xf bank_mask:0x5
  v_add_f32_dpp v12, v16, v16 row_half_mirror row_mask:0xf bank_mask:0xa
  v_add_f32_dpp v13, v13, v13 row_half_mirror row_mask:0xf bank_mask:0x5
  v_add_f32_dpp v13, v17, v17 row_half_mirror row_mask:0xf bank_mask:0xa
  v_add_f32_dpp v14, v14, v14 row_half_mirror row_mask:0xf bank_mask:0x5
  v_add_f32_dpp v14, v18, v18 row_half_mirror row_mask:0xf bank_mask:0xa
  v_add_f32_dpp v15, v15, v15 row_half_mirror row_mask:0xf bank_mask:0x5
  v_add_f32_dpp v15, v19, v19 row_half_mirror row_mask:0xf bank_mask:0xa
  s_nop 0
  v_add_f32_dpp v12, v12, v12 quad_perm:[2,3,0,1] row_mask:0xf bank_mask:0xf
  v_add_f32_dpp v13, v13, v13 quad_perm:[2,3,0,1] row_mask:0xf bank_mask:0xf
  v_add_f32_dpp v14, v14, v14 quad_perm:[2,3,0,1] row_mask:0xf bank_mask:0xf
  v_add_f32_dpp v15, v15, v15 quad_perm:[2,3,0,1] row_mask:0xf bank_mask:0xf
  v_cndmask_b32_e64 v12, v12, v14, s[26:27]
  v_cndmask_b32_e64 v13, v13, v15, s[26:27]
  s_nop 0
  v_add_f32_dpp v12, v12, v12 quad_perm:[1,0,3,2] row_mask:0xf bank_mask:0xf
  v_add_f32_dpp v13, v13, v13 quad_perm:[1,0,3,2] row_mask:0xf bank_mask:0xf
  v_cndmask_b32_e64 v12, v12, v13, s[24:25]
  v_cvt_pk_bf16_f32 v12, v12, v12
  v_and_b32 v12, 0xffff0000, v12
  v_mul_f32 v12, s28, v12
  v_cvt_pk_bf16_f32 v12, v12, v12
  v_and_b32 v12, 0xffff0000, v12
  v_max_f32 v5, v5, v12
  ds_write_b32 v4, v12 offset:0
  v_add_u32 v4, 0x100, v4
  ds_read_b32 v47, v44 offset:22784
  v_dot2_f32_bf16 v12, v48, v8, 0
  v_dot2_f32_bf16 v12, v49, v9, v12
  v_dot2_f32_bf16 v12, v50, v10, v12
  v_dot2_f32_bf16 v12, v51, v11, v12
  v_dot2_f32_bf16 v13, v52, v8, 0
  v_dot2_f32_bf16 v13, v53, v9, v13
  v_dot2_f32_bf16 v13, v54, v10, v13
  v_dot2_f32_bf16 v13, v55, v11, v13
  v_dot2_f32_bf16 v14, v56, v8, 0
  v_dot2_f32_bf16 v14, v57, v9, v14
  v_dot2_f32_bf16 v14, v58, v10, v14
  v_dot2_f32_bf16 v14, v59, v11, v14
  v_dot2_f32_bf16 v15, v60, v8, 0
  v_dot2_f32_bf16 v15, v61, v9, v15
  v_dot2_f32_bf16 v15, v62, v10, v15
  v_dot2_f32_bf16 v15, v63, v11, v15
  v_dot2_f32_bf16 v16, v64, v8, 0
  v_dot2_f32_bf16 v16, v65, v9, v16
  v_dot2_f32_bf16 v16, v66, v10, v16
  v_dot2_f32_bf16 v16, v67, v11, v16
  v_dot2_f32_bf16 v17, v68, v8, 0
  v_dot2_f32_bf16 v17, v69, v9, v17
  v_dot2_f32_bf16 v17, v70, v10, v17
  v_dot2_f32_bf16 v17, v71, v11, v17
  s_waitcnt vmcnt(4)
  buffer_load_dwordx4 v[92:95], v3, s[12:15], s21 offen nt
  s_add_u32 s21, s21, 0x1000
  v_dot2_f32_bf16 v18, v72, v8, 0
  v_dot2_f32_bf16 v18, v73, v9, v18
  v_dot2_f32_bf16 v18, v74, v10, v18
  v_dot2_f32_bf16 v18, v75, v11, v18
  s_waitcnt vmcnt(4)
  buffer_load_dwordx4 v[96:99], v3, s[12:15], s21 offen nt
  s_add_u32 s21, s21, 0x1000
  v_dot2_f32_bf16 v19, v76, v8, 0
  v_dot2_f32_bf16 v19, v77, v9, v19
  v_dot2_f32_bf16 v19, v78, v10, v19
  v_dot2_f32_bf16 v19, v79, v11, v19
  s_waitcnt vmcnt(4)
  buffer_load_dwordx4 v[100:103], v3, s[12:15], s21 offen nt
  s_add_u32 s21, s21, 0x1000
  v_dot2_f32_bf16 v20, v80, v8, 0
  v_dot2_f32_bf16 v20, v81, v9, v20
  v_dot2_f32_bf16 v20, v82, v10, v20
  v_dot2_f32_bf16 v20, v83, v11, v20
  s_waitcnt vmcnt(4)
  buffer_load_dwordx4 v[104:107], v3, s[12:15], s21 offen nt
  s_add_u32 s21, s21, 0x1000
  v_dot2_f32_bf16 v21, v84, v8, 0
  v_dot2_f32_bf16 v21, v85, v9, v21
  v_dot2_f32_bf16 v21, v86, v10, v21
  v_dot2_f32_bf16 v21, v87, v11, v21
  v_add_f32_dpp v12, v12, v12 row_ror:8 row_mask:0xf bank_mask:0x3
  v_add_f32_dpp v12, v20, v20 row_ror:8 row_mask:0xf bank_mask:0xc
  s_waitcnt vmcnt(4)
  buffer_load_dwordx4 v[108:111], v3, s[12:15], s21 offen nt
  s_add_u32 s21, s21, 0x1000
  v_dot2_f32_bf16 v22, v88, v8, 0
  v_dot2_f32_bf16 v22, v89, v9, v22
  v_dot2_f32_bf16 v22, v90, v10, v22
  v_dot2_f32_bf16 v22, v91, v11, v22
  v_add_f32_dpp v13, v13, v13 row_ror:8 row_mask:0xf bank_mask:0x3
  v_add_f32_dpp v13, v21, v21 row_ror:8 row_mask:0xf bank_mask:0xc
  s_waitcnt vmcnt(4)
  buffer_load_dwordx4 v[48:51], v3, s[12:15], s21 offen nt
  s_add_u32 s21, s21, 0x1000
  v_dot2_f32_bf16 v23, v92, v8, 0
  v_dot2_f32_bf16 v23, v93, v9, v23
  v_dot2_f32_bf16 v23, v94, v10, v23
  v_dot2_f32_bf16 v23, v95, v11, v23
  v_add_f32_dpp v14, v14, v14 row_ror:8 row_mask:0xf bank_mask:0x3
  v_add_f32_dpp v14, v22, v22 row_ror:8 row_mask:0xf bank_mask:0xc
  s_waitcnt vmcnt(4)
  buffer_load_dwordx4 v[52:55], v3, s[12:15], s21 offen nt
  s_add_u32 s21, s21, 0x1000
  v_dot2_f32_bf16 v24, v96, v8, 0
  v_dot2_f32_bf16 v24, v97, v9, v24
  v_dot2_f32_bf16 v24, v98, v10, v24
  v_dot2_f32_bf16 v24, v99, v11, v24
  v_add_f32_dpp v15, v15, v15 row_ror:8 row_mask:0xf bank_mask:0x3
  v_add_f32_dpp v15, v23, v23 row_ror:8 row_mask:0xf bank_mask:0xc
  s_waitcnt vmcnt(4)
  buffer_load_dwordx4 v[56:59], v3, s[12:15], s21 offen nt
  s_add_u32 s21, s21, 0x1000
  v_dot2_f32_bf16 v25, v100, v8, 0
  v_dot2_f32_bf16 v25, v101, v9, v25
  v_dot2_f32_bf16 v25, v102, v10, v25
  v_dot2_f32_bf16 v25, v103, v11, v25
  v_add_f32_dpp v16, v16, v16 row_ror:8 row_mask:0xf bank_mask:0x3
  v_add_f32_dpp v16, v24, v24 row_ror:8 row_mask:0xf bank_mask:0xc
  s_waitcnt vmcnt(4)
  buffer_load_dwordx4 v[60:63], v3, s[12:15], s21 offen nt
  s_add_u32 s21, s21, 0x1000
  v_dot2_f32_bf16 v26, v104, v8, 0
  v_dot2_f32_bf16 v26, v105, v9, v26
  v_dot2_f32_bf16 v26, v106, v10, v26
  v_dot2_f32_bf16 v26, v107, v11, v26
  v_add_f32_dpp v17, v17, v17 row_ror:8 row_mask:0xf bank_mask:0x3
  v_add_f32_dpp v17, v25, v25 row_ror:8 row_mask:0xf bank_mask:0xc
  s_waitcnt vmcnt(4)
  buffer_load_dwordx4 v[64:67], v3, s[12:15], s21 offen nt
  s_add_u32 s21, s21, 0x1000
  v_dot2_f32_bf16 v27, v108, v8, 0
  v_dot2_f32_bf16 v27, v109, v9, v27
  v_dot2_f32_bf16 v27, v110, v10, v27
  v_dot2_f32_bf16 v27, v111, v11, v27
  v_add_f32_dpp v18, v18, v18 row_ror:8 row_mask:0xf bank_mask:0x3
  v_add_f32_dpp v18, v26, v26 row_ror:8 row_mask:0xf bank_mask:0xc
  s_nop 0
  v_add_f32_dpp v19, v19, v19 row_ror:8 row_mask:0xf bank_mask:0x3
  v_add_f32_dpp v19, v27, v27 row_ror:8 row_mask:0xf bank_mask:0xc
  v_add_f32_dpp v12, v12, v12 row_half_mirror row_mask:0xf bank_mask:0x5
  v_add_f32_dpp v12, v16, v16 row_half_mirror row_mask:0xf bank_mask:0xa
  v_add_f32_dpp v13, v13, v13 row_half_mirror row_mask:0xf bank_mask:0x5
  v_add_f32_dpp v13, v17, v17 row_half_mirror row_mask:0xf bank_mask:0xa
  v_add_f32_dpp v14, v14, v14 row_half_mirror row_mask:0xf bank_mask:0x5
  v_add_f32_dpp v14, v18, v18 row_half_mirror row_mask:0xf bank_mask:0xa
  v_add_f32_dpp v15, v15, v15 row_half_mirror row_mask:0xf bank_mask:0x5
  v_add_f32_dpp v15, v19, v19 row_half_mirror row_mask:0xf bank_mask:0xa
  s_nop 0
  v_add_f32_dpp v12, v12, v12 quad_perm:[2,3,0,1] row_mask:0xf bank_mask:0xf
  v_add_f32_dpp v13, v13, v13 quad_perm:[2,3,0,1] row_mask:0xf bank_mask:0xf
  v_add_f32_dpp v14, v14, v14 quad_perm:[2,3,0,1] row_mask:0xf bank_mask:0xf
  v_add_f32_dpp v15, v15, v15 quad_perm:[2,3,0,1] row_mask:0xf bank_mask:0xf
  v_cndmask_b32_e64 v12, v12, v14, s[26:27]
  v_cndmask_b32_e64 v13, v13, v15, s[26:27]
  s_nop 0
  v_add_f32_dpp v12, v12, v12 quad_perm:[1,0,3,2] row_mask:0xf bank_mask:0xf
  v_add_f32_dpp v13, v13, v13 quad_perm:[1,0,3,2] row_mask:0xf bank_mask:0xf
  v_cndmask_b32_e64 v12, v12, v13, s[24:25]
  v_cvt_pk_bf16_f32 v12, v12, v12
  v_and_b32 v12, 0xffff0000, v12
  v_mul_f32 v12, s28, v12
  v_cvt_pk_bf16_f32 v12, v12, v12
  v_and_b32 v12, 0xffff0000, v12
  v_max_f32 v5, v5, v12
  ds_write_b32 v4, v12 offset:0
  v_add_u32 v4, 0x100, v4
  s_mov_b32 s22, 10
L_klo:
  s_sub_u32 s34, 15, s22
  s_waitcnt lgkmcnt(1)
  v_readfirstlane_b32 s33, v47
  v_mov_b32 v45, s34
  ds_write_b32 v44, v45 offset:22576
  s_bitcmp1_b32 s33, s34
  s_cbranch_scc1 L_kup
  s_waitcnt vmcnt(4)
  buffer_load_dwordx4 v[68:71], v3, s[12:15], s21 offen nt
  s_add_u32 s21, s21, 0x1000
  v_dot2_f32_bf16 v12, v48, v8, 0
  v_dot2_f32_bf16 v12, v49, v9, v12
  v_dot2_f32_bf16 v12, v50, v10, v12
  v_dot2_f32_bf16 v12, v51, v11, v12
L_klo_k:
  s_waitcnt vmcnt(4)
  buffer_load_dwordx4 v[72:75], v3, s[12:15], s21 offen nt
  s_add_u32 s21, s21, 0x1000
  v_dot2_f32_bf16 v13, v52, v8, 0
  v_dot2_f32_bf16 v13, v53, v9, v13
  v_dot2_f32_bf16 v13, v54, v10, v13
  v_dot2_f32_bf16 v13, v55, v11, v13
  s_waitcnt vmcnt(4)
  buffer_load_dwordx4 v[76:79], v3, s[12:15], s21 offen nt
  s_add_u32 s21, s21, 0x1000
  v_dot2_f32_bf16 v14, v56, v8, 0
  v_dot2_f32_bf16 v14, v57, v9, v14
  v_dot2_f32_bf16 v14, v58, v10, v14
  v_dot2_f32_bf16 v14, v59, v11, v14
  s_waitcnt vmcnt(4)
  buffer_load_dwordx4 v[80:83], v3, s[12:15], s21 offen nt
  s_add_u32 s21, s21, 0x1000
  v_dot2_f32_bf16 v15, v60, v8, 0
  v_dot2_f32_bf16 v15, v61, v9, v15
  v_dot2_f32_bf16 v15, v62, v10, v15
  v_dot2_f32_bf16 v15, v63, v11, v15
  s_waitcnt vmcnt(4)
  buffer_load_dwordx4 v[84:87], v3, s[12:15], s21 offen nt
  s_add_u32 s21, s21, 0x1000
  v_dot2_f32_bf16 v16, v64, v8, 0
  v_dot2_f32_bf16 v16, v65, v9, v16
  v_dot2_f32_bf16 v16, v66, v10, v16
  v_dot2_f32_bf16 v16, v67, v11, v16
  s_waitcnt vmcnt(4)
  buffer_load_dwordx4 v[88:91], v3, s[12:15], s21 offen nt
  s_add_u32 s21, s21, 0x1000
  v_dot2_f32_bf16 v17, v68, v8, 0
  v_dot2_f32_bf16 v17, v69, v9, v17
  v_dot2_f32_bf16 v17, v70, v10, v17
  v_dot2_f32_bf16 v17, v71, v11, v17
  s_waitcnt vmcnt(4)
  buffer_load_dwordx4 v[92:95], v3, s[12:15], s21 offen nt
  s_add_u32 s21, s21, 0x1000
  v_dot2_f32_bf16 v18, v72, v8, 0
  v_dot2_f32_bf16 v18, v73, v9, v18
  v_dot2_f32_bf16 v18, v74, v10, v18
  v_dot2_f32_bf16 v18, v75, v11, v18
  s_waitcnt vmcnt(4)
  buffer_load_dwordx4 v[96:99], v3, s[12:15], s21 offen nt
  s_add_u32 s21, s21, 0x1000
  v_dot2_f32_bf16 v19, v76, v8, 0
  v_dot2_f32_bf16 v19, v77, v9, v19
  v_dot2_f32_bf16 v19, v78, v10, v19
  v_dot2_f32_bf16 v19, v79, v11, v19
  s_waitcnt vmcnt(4)
  buffer_load_dwordx4 v[100:103], v3, s[12:15], s21 offen nt
  s_add_u32 s21, s21, 0x1000
  v_dot2_f32_bf16 v20, v80, v8, 0
  v_dot2_f32_bf16 v20, v81, v9, v20
  v_dot2_f32_bf16 v20, v82, v10, v20
  v_dot2_f32_bf16 v20, v83, v11, v20
  s_waitcnt vmcnt(4)
  buffer_load_dwordx4 v[104:107], v3, s[12:15], s21 offen nt
  s_add_u32 s21, s21, 0x1000
  v_dot2_f32_bf16 v21, v84, v8, 0
  v_dot2_f32_bf16 v21, v85, v9, v21
  v_dot2_f32_bf16 v21, v86, v10, v21
  v_dot2_f32_bf16 v21, v87, v11, v21
  v_add_f32_dpp v12, v12, v12 row_ror:8 row_mask:0xf bank_mask:0x3
  v_add_f32_dpp v12, v20, v20 row_ror:8 row_mask:0xf bank_mask:0xc
  s_waitcnt vmcnt(4)
  buffer_load_dwordx4 v[108:111], v3, s[12:15], s21 offen nt
  s_add_u32 s21, s21, 0x1000
  v_dot2_f32_bf16 v22, v88, v8, 0
  v_dot2_f32_bf16 v22, v89, v9, v22
  v_dot2_f32_bf16 v22, v90, v10, v22
  v_dot2_f32_bf16 v22, v91, v11, v22
  v_add_f32_dpp v13, v13, v13 row_ror:8 row_mask:0xf bank_mask:0x3
  v_add_f32_dpp v13, v21, v21 row_ror:8 row_mask:0xf bank_mask:0xc
  s_waitcnt vmcnt(4)
  buffer_load_dwordx4 v[48:51], v3, s[12:15], s21 offen nt
  s_add_u32 s21, s21, 0x1000
  v_dot2_f32_bf16 v23, v92, v8, 0
  v_dot2_f32_bf16 v23, v93, v9, v23
  v_dot2_f32_bf16 v23, v94, v10, v23
  v_dot2_f32_bf16 v23, v95, v11, v23
  v_add_f32_dpp v14, v14, v14 row_ror:8 row_mask:0xf bank_mask:0x3
  v_add_f32_dpp v14, v22, v22 row_ror:8 row_mask:0xf bank_mask:0xc
  s_waitcnt vmcnt(4)
  buffer_load_dwordx4 v[52:55], v3, s[12:15], s21 offen nt
  s_add_u32 s21, s21, 0x1000
  v_dot2_f32_bf16 v24, v96, v8, 0
  v_dot2_f32_bf16 v24, v97, v9, v24
  v_dot2_f32_bf16 v24, v98, v10, v24
  v_dot2_f32_bf16 v24, v99, v11, v24
  v_add_f32_dpp v15, v15, v15 row_ror:8 row_mask:0xf bank_mask:0x3
  v_add_f32_dpp v15, v23, v23 row_ror:8 row_mask:0xf bank_mask:0xc
  s_waitcnt vmcnt(4)
  buffer_load_dwordx4 v[56:59], v3, s[12:15], s21 offen nt
  s_add_u32 s21, s21, 0x1000
  ds_read_b32 v47, v44 offset:22784
  v_dot2_f32_bf16 v25, v100, v8, 0
  v_dot2_f32_bf16 v25, v101, v9, v25
  v_dot2_f32_bf16 v25, v102, v10, v25
  v_dot2_f32_bf16 v25, v103, v11, v25
  v_add_f32_dpp v16, v16, v16 row_ror:8 row_mask:0xf bank_mask:0x3
  v_add_f32_dpp v16, v24, v24 row_ror:8 row_mask:0xf bank_mask:0xc
  s_waitcnt vmcnt(4)
  buffer_load_dwordx4 v[60:63], v3, s[12:15], s21 offen nt
  s_add_u32 s21, s21, 0x1000
  v_dot2_f32_bf16 v26, v104, v8, 0
  v_dot2_f32_bf16 v26, v105, v9, v26
  v_dot2_f32_bf16 v26, v106, v10, v26
  v_dot2_f32_bf16 v26, v107, v11, v26
  v_add_f32_dpp v17, v17, v17 row_ror:8 row_mask:0xf bank_mask:0x3
  v_add_f32_dpp v17, v25, v25 row_ror:8 row_mask:0xf bank_mask:0xc
  s_waitcnt vmcnt(4)
  buffer_load_dwordx4 v[64:67], v3, s[12:15], s21 offen nt
  s_add_u32 s21, s21, 0x1000
  v_dot2_f32_bf16 v27, v108, v8, 0
  v_dot2_f32_bf16 v27, v109, v9, v27
  v_dot2_f32_bf16 v27, v110, v10, v27
  v_dot2_f32_bf16 v27, v111, v11, v27
  v_add_f32_dpp v18, v18, v18 row_ror:8 row_mask:0xf bank_mask:0x3
  v_add_f32_dpp v18, v26, v26 row_ror:8 row_mask:0xf bank_mask:0xc
  s_nop 0
  v_add_f32_dpp v19, v19, v19 row_ror:8 row_mask:0xf bank_mask:0x3
  v_add_f32_dpp v19, v27, v27 row_ror:8 row_mask:0xf bank_mask:0xc
  v_add_f32_dpp v12, v12, v12 row_half_mirror row_mask:0xf bank_mask:0x5
  v_add_f32_dpp v12, v16, v16 row_half_mirror row_mask:0xf bank_mask:0xa
  v_add_f32_dpp v13, v13, v13 row_half_mirror row_mask:0xf bank_mask:0x5
  v_add_f32_dpp v13, v17, v17 row_half_mirror row_mask:0xf bank_mask:0xa
  v_add_f32_dpp v14, v14, v14 row_half_mirror row_mask:0xf bank_mask:0x5
  v_add_f32_dpp v14, v18, v18 row_half_mirror row_mask:0xf bank_mask:0xa
  v_add_f32_dpp v15, v15, v15 row_half_mirror row_mask:0xf bank_mask:0x5
  v_add_f32_dpp v15, v19, v19 row_half_mirror row_mask:0xf bank_mask:0xa
  s_nop 0
  v_add_f32_dpp v12, v12, v12 quad_perm:[2,3,0,1] row_mask:0xf bank_mask:0xf
  v_add_f32_dpp v13, v13, v13 quad_perm:[2,3,0,1] row_mask:0xf bank_mask:0xf
  v_add_f32_dpp v14, v14, v14 quad_perm:[2,3,0,1] row_mask:0xf bank_mask:0xf
  v_add_f32_dpp v15, v15, v15 quad_perm:[2,3,0,1] row_mask:0xf bank_mask:0xf
  v_cndmask_b32_e64 v12, v12, v14, s[26:27]
  v_cndmask_b32_e64 v13, v13, v15, s[26:27]
  s_nop 0
  v_add_f32_dpp v12, v12, v12 quad_perm:[1,0,3,2] row_mask:0xf bank_mask:0xf
  v_add_f32_dpp v13, v13, v13 quad_perm:[1,0,3,2] row_mask:0xf bank_mask:0xf
  v_cndmask_b32_e64 v12, v12, v13, s[24:25]
  v_cvt_pk_bf16_f32 v12, v12, v12
  v_and_b32 v12, 0xffff0000, v12
  v_mul_f32 v12, s28, v12
  v_cvt_pk_bf16_f32 v12, v12, v12
  v_and_b32 v12, 0xffff0000, v12
  v_max_f32 v5, v5, v12
  ds_write_b32 v4, v12 offset:0
  v_add_u32 v4, 0x100, v4
  s_sub_u32 s22, s22, 1
  s_cmp_lg_u32 s22, 0
  s_cbranch_scc1 L_klo
  s_branch L_kx
L_kup:
  buffer_load_dwordx4 v[68:71], v3, s[12:15], s21 offen nt
  s_add_u32 s21, s21, 0x1000
  s_branch L_khib
L_khi:
  s_sub_u32 s34, 15, s22
  s_waitcnt lgkmcnt(1)
  v_readfirstlane_b32 s33, v47
  v_mov_b32 v45, s34
  ds_write_b32 v44, v45 offset:22576
  s_bitcmp1_b32 s33, s34
  s_cbranch_scc0 L_kdn
L_khib:
  s_waitcnt vmcnt(5)
  buffer_load_dwordx4 v[72:75], v3, s[12:15], s21 offen nt
  s_add_u32 s21, s21, 0x1000
  v_dot2_f32_bf16 v12, v48, v8, 0
  v_dot2_f32_bf16 v12, v49, v9, v12
  v_dot2_f32_bf16 v12, v50, v10, v12
  v_dot2_f32_bf16 v12, v51, v11, v12
  s_waitcnt vmcnt(5)
  buffer_load_dwordx4 v[76:79], v3, s[12:15], s21 offen nt
  s_add_u32 s21, s21, 0x1000
  v_dot2_f32_bf16 v13, v52, v8, 0
  v_dot2_f32_bf16 v13, v53, v9, v13
  v_dot2_f32_bf16 v13, v54, v10, v13
  v_dot2_f32_bf16 v13, v55, v11, v13
  s_waitcnt vmcnt(5)
  buffer_load_dwordx4 v[80:83], v3, s[12:15], s21 offen nt
  s_add_u32 s21, s21, 0x1000
  v_dot2_f32_bf16 v14, v56, v8, 0
  v_dot2_f32_bf16 v14, v57, v9, v14
  v_dot2_f32_bf16 v14, v58, v10, v14
  v_dot2_f32_bf16 v14, v59, v11, v14
  s_waitcnt vmcnt(5)
  buffer_load_dwordx4 v[84:87], v3, s[12:15], s21 offen nt
  s_add_u32 s21, s21, 0x1000
  v_dot2_f32_bf16 v15, v60, v8, 0
  v_dot2_f32_bf16 v15, v61, v9, v15
  v_dot2_f32_bf16 v15, v62, v10, v15
  v_dot2_f32_bf16 v15, v63, v11, v15
  s_waitcnt vmcnt(5)
  buffer_load_dwordx4 v[88:91], v3, s[12:15], s21 offen nt
  s_add_u32 s21, s21, 0x1000
  v_dot2_f32_bf16 v16, v64, v8, 0
  v_dot2_f32_bf16 v16, v65, v9, v16
  v_dot2_f32_bf16 v16, v66, v10, v16
  v_dot2_f32_bf16 v16, v67, v11, v16
  s_waitcnt vmcnt(5)
  buffer_load_dwordx4 v[92:95], v3, s[12:15], s21 offen nt
  s_add_u32 s21, s21, 0x1000
  v_dot2_f32_bf16 v17, v68, v8, 0
  v_dot2_f32_bf16 v17, v69, v9, v17
  v_dot2_f32_bf16 v17, v70, v10, v17
  v_dot2_f32_bf16 v17, v71, v11, v17
  s_waitcnt vmcnt(5)
  buffer_load_dwordx4 v[96:99], v3, s[12:15], s21 offen nt
  s_add_u32 s21, s21, 0x1000
  v_dot2_f32_bf16 v18, v72, v8, 0
  v_dot2_f32_bf16 v18, v73, v9, v18
  v_dot2_f32_bf16 v18, v74, v10, v18
  v_dot2_f32_bf16 v18, v75, v11, v18
  s_waitcnt vmcnt(5)
  buffer_load_dwordx4 v[100:103], v3, s[12:15], s21 offen nt
  s_add_u32 s21, s21, 0x1000
  v_dot2_f32_bf16 v19, v76, v8, 0
  v_dot2_f32_bf16 v19, v77, v9, v19
  v_dot2_f32_bf16 v19, v78, v10, v19
  v_dot2_f32_bf16 v19, v79, v11, v19
  s_waitcnt vmcnt(5)
  buffer_load_dwordx4 v[104:107], v3, s[12:15], s21 offen nt
  s_add_u32 s21, s21, 0x1000
  v_dot2_f32_bf16 v20, v80, v8, 0
  v_dot2_f32_bf16 v20, v81, v9, v20
  v_dot2_f32_bf16 v20, v82, v10, v20
  v_dot2_f32_bf16 v20, v83, v11, v20
  s_waitcnt vmcnt(5)
  buffer_load_dwordx4 v[108:111], v3, s[12:15], s21 offen nt
  s_add_u32 s21, s21, 0x1000
  v_dot2_f32_bf16 v21, v84, v8, 0
  v_dot2_f32_bf16 v21, v85, v9, v21
  v_dot2_f32_bf16 v21, v86, v10, v21
  v_dot2_f32_bf16 v21, v87, v11, v21
  v_add_f32_dpp v12, v12, v12 row_ror:8 row_mask:0xf bank_mask:0x3
  v_add_f32_dpp v12, v20, v20 row_ror:8 row_mask:0xf bank_mask:0xc
  s_waitcnt vmcnt(5)
  buffer_load_dwordx4 v[48:51], v3, s[12:15], s21 offen nt
  s_add_u32 s21, s21, 0x1000
  v_dot2_f32_bf16 v22, v88, v8, 0
  v_dot2_f32_bf16 v22, v89, v9, v22
  v_dot2_f32_bf16 v22, v90, v10, v22
  v_dot2_f32_bf16 v22, v91, v11, v22
  v_add_f32_dpp v13, v13, v13 row_ror:8 row_mask:0xf bank_mask:0x3
  v_add_f32_dpp v13, v21, v21 row_ror:8 row_mask:0xf bank_mask:0xc
  s_waitcnt vmcnt(5)
  buffer_load_dwordx4 v[52:55], v3, s[12:15], s21 offen nt
  s_add_u32 s21, s21, 0x1000
  v_dot2_f32_bf16 v23, v92, v8, 0
  v_dot2_f32_bf16 v23, v93, v9, v23
  v_dot2_f32_bf16 v23, v94, v10, v23
  v_dot2_f32_bf16 v23, v95, v11, v23
  v_add_f32_dpp v14, v14, v14 row_ror:8 row_mask:0xf bank_mask:0x3
  v_add_f32_dpp v14, v22, v22 row_ror:8 row_mask:0xf bank_mask:0xc
  s_waitcnt vmcnt(5)
  buffer_load_dwordx4 v[56:59], v3, s[12:15], s21 offen nt
  s_add_u32 s21, s21, 0x1000
  v_dot2_f32_bf16 v24, v96, v8, 0
  v_dot2_f32_bf16 v24, v97, v9, v24
  v_dot2_f32_bf16 v24, v98, v10, v24
  v_dot2_f32_bf16 v24, v99, v11, v24
  v_add_f32_dpp v15, v15, v15 row_ror:8 row_mask:0xf bank_mask:0x3
  v_add_f32_dpp v15, v23, v23 row_ror:8 row_mask:0xf bank_mask:0xc
  s_waitcnt vmcnt(5)
  buffer_load_dwordx4 v[60:63], v3, s[12:15], s21 offen nt
  s_add_u32 s21, s21, 0x1000
  ds_read_b32 v47, v44 offset:22784
  v_dot2_f32_bf16 v25, v100, v8, 0
  v_dot2_f32_bf16 v25, v101, v9, v25
  v_dot2_f32_bf16 v25, v102, v10, v25
  v_dot2_f32_bf16 v25, v103, v11, v25
  v_add_f32_dpp v16, v16, v16 row_ror:8 row_mask:0xf bank_mask:0x3
  v_add_f32_dpp v16, v24, v24 row_ror:8 row_mask:0xf bank_mask:0xc
  s_waitcnt vmcnt(5)
  buffer_load_dwordx4 v[64:67], v3, s[12:15], s21 offen nt
  s_add_u32 s21, s21, 0x1000
  v_dot2_f32_bf16 v26, v104, v8, 0
  v_dot2_f32_bf16 v26, v105, v9, v26
  v_dot2_f32_bf16 v26, v106, v10, v26
  v_dot2_f32_bf16 v26, v107, v11, v26
  v_add_f32_dpp v17, v17, v17 row_ror:8 row_mask:0xf bank_mask:0x3
  v_add_f32_dpp v17, v25, v25 row_ror:8 row_mask:0xf bank_mask:0xc
  s_waitcnt vmcnt(5)
  buffer_load_dwordx4 v[68:71], v3, s[12:15], s21 offen nt
  s_add_u32 s21, s21, 0x1000
  v_dot2_f32_bf16 v27, v108, v8, 0
  v_dot2_f32_bf16 v27, v109, v9, v27
  v_dot2_f32_bf16 v27, v110, v10, v27
  v_dot2_f32_bf16 v27, v111, v11, v27
  v_add_f32_dpp v18, v18, v18 row_ror:8 row_mask:0xf bank_mask:0x3
  v_add_f32_dpp v18, v26, v26 row_ror:8 row_mask:0xf bank_mask:0xc
  s_nop 0
  v_add_f32_dpp v19, v19, v19 row_ror:8 row_mask:0xf bank_mask:0x3
  v_add_f32_dpp v19, v27, v27 row_ror:8 row_mask:0xf bank_mask:0xc
  v_add_f32_dpp v12, v12, v12 row_half_mirror row_mask:0xf bank_mask:0x5
  v_add_f32_dpp v12, v16, v16 row_half_mirror row_mask:0xf bank_mask:0xa
  v_add_f32_dpp v13, v13, v13 row_half_mirror row_mask:0xf bank_mask:0x5
  v_add_f32_dpp v13, v17, v17 row_half_mirror row_mask:0xf bank_mask:0xa
  v_add_f32_dpp v14, v14, v14 row_half_mirror row_mask:0xf bank_mask:0x5
  v_add_f32_dpp v14, v18, v18 row_half_mirror row_mask:0xf bank_mask:0xa
  v_add_f32_dpp v15, v15, v15 row_half_mirror row_mask:0xf bank_mask:0x5
  v_add_f32_dpp v15, v19, v19 row_half_mirror row_mask:0xf bank_mask:0xa
  s_nop 0
  v_add_f32_dpp v12, v12, v12 quad_perm:[2,3,0,1] row_mask:0xf bank_mask:0xf
  v_add_f32_dpp v13, v13, v13 quad_perm:[2,3,0,1] row_mask:0xf bank_mask:0xf
  v_add_f32_dpp v14, v14, v14 quad_perm:[2,3,0,1] row_mask:0xf bank_mask:0xf
  v_add_f32_dpp v15, v15, v15 quad_perm:[2,3,0,1] row_mask:0xf bank_mask:0xf
  v_cndmask_b32_e64 v12, v12, v14, s[26:27]
  v_cndmask_b32_e64 v13, v13, v15, s[26:27]
  s_nop 0
  v_add_f32_dpp v12, v12, v12 quad_perm:[1,0,3,2] row_mask:0xf bank_mask:0xf
  v_add_f32_dpp v13, v13, v13 quad_perm:[1,0,3,2] row_mask:0xf bank_mask:0xf
  v_cndmask_b32_e64 v12, v12, v13, s[24:25]
  v_cvt_pk_bf16_f32 v12, v12, v12
  v_and_b32 v12, 0xffff0000, v12
  v_mul_f32 v12, s28, v12
  v_cvt_pk_bf16_f32 v12, v12, v12
  v_and_b32 v12, 0xffff0000, v12
  v_max_f32 v5, v5, v12
  ds_write_b32 v4, v12 offset:0
  v_add_u32 v4, 0x100, v4
  s_sub_u32 s22, s22, 1
  s_cmp_lg_u32 s22, 0
  s_cbranch_scc1 L_khi
  s_branch L_kxh
L_kdn:
  s_waitcnt vmcnt(5)
  v_dot2_f32_bf16 v12, v48, v8, 0
  v_dot2_f32_bf16 v12, v49, v9, v12
  v_dot2_f32_bf16 v12, v50, v10, v12
  v_dot2_f32_bf16 v12, v51, v11, v12
  s_branch L_klo_k
L_kxh:
  s_waitcnt vmcnt(5)
  v_dot2_f32_bf16 v12, v48, v8, 0
  v_dot2_f32_bf16 v12, v49, v9, v12
  v_dot2_f32_bf16 v12, v50, v10, v12
  v_dot2_f32_bf16 v12, v51, v11, v12
  s_branch L_k15_k
L_kx:
  s_waitcnt vmcnt(4)
  buffer_load_dwordx4 v[68:71], v3, s[12:15], s21 offen nt
  s_add_u32 s21, s21, 0x1000
  v_dot2_f32_bf16 v12, v48, v8, 0
  v_dot2_f32_bf16 v12, v49, v9, v12
  v_dot2_f32_bf16 v12, v50, v10, v12
  v_dot2_f32_bf16 v12, v51, v11, v12
L_k15_k:
  s_waitcnt vmcnt(4)
  buffer_load_dwordx4 v[72:75], v3, s[12:15], s21 offen nt
  s_add_u32 s21, s21, 0x1000
  v_dot2_f32_bf16 v13, v52, v8, 0
  v_dot2_f32_bf16 v13, v53, v9, v13
  v_dot2_f32_bf16 v13, v54, v10, v13
  v_dot2_f32_bf16 v13, v55, v11, v13
  s_waitcnt vmcnt(4)
  buffer_load_dwordx4 v[76:79], v3, s[12:15], s21 offen nt
  s_add_u32 s21, s21, 0x1000
  v_dot2_f32_bf16 v14, v56, v8, 0
  v_dot2_f32_bf16 v14, v57, v9, v14
  v_dot2_f32_bf16 v14, v58, v10, v14
  v_dot2_f32_bf16 v14, v59, v11, v14
  s_waitcnt vmcnt(4)
  buffer_load_dwordx4 v[80:83], v3, s[12:15], s21 offen nt
  s_add_u32 s21, s21, 0x1000
  v_dot2_f32_bf16 v15, v60, v8, 0
  v_dot2_f32_bf16 v15, v61, v9, v15
  v_dot2_f32_bf16 v15, v62, v10, v15
  v_dot2_f32_bf16 v15, v63, v11, v15
  s_waitcnt vmcnt(4)
  buffer_load_dwordx4 v[84:87], v3, s[12:15], s21 offen nt
  s_add_u32 s21, s21, 0x1000
  v_dot2_f32_bf16 v16, v64, v8, 0
  v_dot2_f32_bf16 v16, v65, v9, v16
  v_dot2_f32_bf16 v16, v66, v10, v16
  v_dot2_f32_bf16 v16, v67, v11, v16
  s_waitcnt vmcnt(4)
  buffer_load_dwordx4 v[88:91], v3, s[12:15], s21 offen nt
  s_add_u32 s21, s21, 0x1000
  v_dot2_f32_bf16 v17, v68, v8, 0
  v_dot2_f32_bf16 v17, v69, v9, v17
  v_dot2_f32_bf16 v17, v70, v10, v17
  v_dot2_f32_bf16 v17, v71, v11, v17
  s_waitcnt vmcnt(4)
  buffer_load_dwordx4 v[92:95], v3, s[12:15], s21 offen nt
  s_add_u32 s21, s21, 0x1000
  v_dot2_f32_bf16 v18, v72, v8, 0
  v_dot2_f32_bf16 v18, v73, v9, v18
  v_dot2_f32_bf16 v18, v74, v10, v18
  v_dot2_f32_bf16 v18, v75, v11, v18
  s_waitcnt vmcnt(4)
  buffer_load_dwordx4 v[96:99], v3, s[12:15], s21 offen nt
  s_add_u32 s21, s21, 0x1000
  v_dot2_f32_bf16 v19, v76, v8, 0
  v_dot2_f32_bf16 v19, v77, v9, v19
  v_dot2_f32_bf16 v19, v78, v10, v19
  v_dot2_f32_bf16 v19, v79, v11, v19
  s_waitcnt vmcnt(4)
  buffer_load_dwordx4 v[100:103], v3, s[12:15], s21 offen nt
  s_add_u32 s21, s21, 0x1000
  v_dot2_f32_bf16 v20, v80, v8, 0
  v_dot2_f32_bf16 v20, v81, v9, v20
  v_dot2_f32_bf16 v20, v82, v10, v20
  v_dot2_f32_bf16 v20, v83, v11, v20
  s_waitcnt vmcnt(4)
  buffer_load_dwordx4 v[104:107], v3, s[12:15], s21 offen nt
  s_add_u32 s21, s21, 0x1000
  v_dot2_f32_bf16 v21, v84, v8, 0
  v_dot2_f32_bf16 v21, v85, v9, v21
  v_dot2_f32_bf16 v21, v86, v10, v21
  v_dot2_f32_bf16 v21, v87, v11, v21
  v_add_f32_dpp v12, v12, v12 row_ror:8 row_mask:0xf bank_mask:0x3
  v_add_f32_dpp v12, v20, v20 row_ror:8 row_mask:0xf bank_mask:0xc
  s_waitcnt vmcnt(4)
  buffer_load_dwordx4 v[108:111], v3, s[12:15], s21 offen nt
  s_add_u32 s21, s21, 0x1000
  v_dot2_f32_bf16 v22, v88, v8, 0
  v_dot2_f32_bf16 v22, v89, v9, v22
  v_dot2_f32_bf16 v22, v90, v10, v22
  v_dot2_f32_bf16 v22, v91, v11, v22
  v_add_f32_dpp v13, v13, v13 row_ror:8 row_mask:0xf bank_mask:0x3
  v_add_f32_dpp v13, v21, v21 row_ror:8 row_mask:0xf bank_mask:0xc
  s_waitcnt vmcnt(4)
  s_mov_b32 s21, s20
  buffer_load_dwordx4 v[48:51], v3, s[16:19], s21 offen nt
  s_add_u32 s21, s21, 0x1000
  v_dot2_f32_bf16 v23, v92, v8, 0
  v_dot2_f32_bf16 v23, v93, v9, v23
  v_dot2_f32_bf16 v23, v94, v10, v23
  v_dot2_f32_bf16 v23, v95, v11, v23
  v_add_f32_dpp v14, v14, v14 row_ror:8 row_mask:0xf bank_mask:0x3
  v_add_f32_dpp v14, v22, v22 row_ror:8 row_mask:0xf bank_mask:0xc
  s_waitcnt vmcnt(4)
  buffer_load_dwordx4 v[52:55], v3, s[16:19], s21 offen nt
  s_add_u32 s21, s21, 0x1000
  v_dot2_f32_bf16 v24, v96, v8, 0
  v_dot2_f32_bf16 v24, v97, v9, v24
  v_dot2_f32_bf16 v24, v98, v10, v24
  v_dot2_f32_bf16 v24, v99, v11, v24
  v_add_f32_dpp v15, v15, v15 row_ror:8 row_mask:0xf bank_mask:0x3
  v_add_f32_dpp v15, v23, v23 row_ror:8 row_mask:0xf bank_mask:0xc
  s_waitcnt vmcnt(4)
  buffer_load_dwordx4 v[56:59], v3, s[16:19], s21 offen nt
  s_add_u32 s21, s21, 0x1000
  v_dot2_f32_bf16 v25, v100, v8, 0
  v_dot2_f32_bf16 v25, v101, v9, v25
  v_dot2_f32_bf16 v25, v102, v10, v25
  v_dot2_f32_bf16 v25, v103, v11, v25
  v_add_f32_dpp v16, v16, v16 row_ror:8 row_mask:0xf bank_mask:0x3
  v_add_f32_dpp v16, v24, v24 row_ror:8 row_mask:0xf bank_mask:0xc
  s_waitcnt vmcnt(4)
  buffer_load_dwordx4 v[60:63], v3, s[16:19], s21 offen nt
  s_add_u32 s21, s21, 0x1000
  v_dot2_f32_bf16 v26, v104, v8, 0
  v_dot2_f32_bf16 v26, v105, v9, v26
  v_dot2_f32_bf16 v26, v106, v10, v26
  v_dot2_f32_bf16 v26, v107, v11, v26
  v_add_f32_dpp v17, v17, v17 row_ror:8 row_mask:0xf bank_mask:0x3
  v_add_f32_dpp v17, v25, v25 row_ror:8 row_mask:0xf bank_mask:0xc
  s_waitcnt vmcnt(4)
  buffer_load_dwordx4 v[64:67], v3, s[16:19], s21 offen nt
  s_add_u32 s21, s21, 0x1000
  v_dot2_f32_bf16 v27, v108, v8, 0
  v_dot2_f32_bf16 v27, v109, v9, v27
  v_dot2_f32_bf16 v27, v110, v10, v27
  v_dot2_f32_bf16 v27, v111, v11, v27
  v_add_f32_dpp v18, v18, v18 row_ror:8 row_mask:0xf bank_mask:0x3
  v_add_f32_dpp v18, v26, v26 row_ror:8 row_mask:0xf bank_mask:0xc
  s_nop 0
  v_add_f32_dpp v19, v19, v19 row_ror:8 row_mask:0xf bank_mask:0x3
  v_add_f32_dpp v19, v27, v27 row_ror:8 row_mask:0xf bank_mask:0xc
  v_add_f32_dpp v12, v12, v12 row_half_mirror row_mask:0xf bank_mask:0x5
  v_add_f32_dpp v12, v16, v16 row_half_mirror row_mask:0xf bank_mask:0xa
  v_add_f32_dpp v13, v13, v13 row_half_mirror row_mask:0xf bank_mask:0x5
  v_add_f32_dpp v13, v17, v17 row_half_mirror row_mask:0xf bank_mask:0xa
  v_add_f32_dpp v14, v14, v14 row_half_mirror row_mask:0xf bank_mask:0x5
  v_add_f32_dpp v14, v18, v18 row_half_mirror row_mask:0xf bank_mask:0xa
  v_add_f32_dpp v15, v15, v15 row_half_mirror row_mask:0xf bank_mask:0x5
  v_add_f32_dpp v15, v19, v19 row_half_mirror row_mask:0xf bank_mask:0xa
  s_nop 0
  v_add_f32_dpp v12, v12, v12 quad_perm:[2,3,0,1] row_mask:0xf bank_mask:0xf
  v_add_f32_dpp v13, v13, v13 quad_perm:[2,3,0,1] row_mask:0xf bank_mask:0xf
  v_add_f32_dpp v14, v14, v14 quad_perm:[2,3,0,1] row_mask:0xf bank_mask:0xf
  v_add_f32_dpp v15, v15, v15 quad_perm:[2,3,0,1] row_mask:0xf bank_mask:0xf
  v_cndmask_b32_e64 v12, v12, v14, s[26:27]
  v_cndmask_b32_e64 v13, v13, v15, s[26:27]
  s_nop 0
  v_add_f32_dpp v12, v12, v12 quad_perm:[1,0,3,2] row_mask:0xf bank_mask:0xf
  v_add_f32_dpp v13, v13, v13 quad_perm:[1,0,3,2] row_mask:0xf bank_mask:0xf
  v_cndmask_b32_e64 v12, v12, v13, s[24:25]
  v_cvt_pk_bf16_f32 v12, v12, v12
  v_and_b32 v12, 0xffff0000, v12
  v_mul_f32 v12, s28, v12
  v_cvt_pk_bf16_f32 v12, v12, v12
  v_and_b32 v12, 0xffff0000, v12
  v_max_f32 v5, v5, v12
  ds_write_b32 v4, v12 offset:0
  v_add_u32 v4, 0x100, v4
  buffer_load_dwordx4 v[68:71], v3, s[16:19], s21 offen nt
  s_add_u32 s21, s21, 0x1000
  buffer_load_dwordx4 v[72:75], v3, s[16:19], s21 offen nt
  s_add_u32 s21, s21, 0x1000
  buffer_load_dwordx4 v[76:79], v3, s[16:19], s21 offen nt
  s_add_u32 s21, s21, 0x1000
  v_add_u32 v4, 0xfffff000, v4
  ds_read_b32 v12, v4 offset:0
  ds_read_b32 v13, v4 offset:256
  ds_read_b32 v14, v4 offset:512
  ds_read_b32 v15, v4 offset:768
  ds_read_b32 v16, v4 offset:1024
  ds_read_b32 v17, v4 offset:1280
  ds_read_b32 v18, v4 offset:1536
  ds_read_b32 v19, v4 offset:1792
  ds_read_b32 v20, v4 offset:2048
  ds_read_b32 v21, v4 offset:2304
  ds_read_b32 v22, v4 offset:2560
  ds_read_b32 v23, v4 offset:2816
  ds_read_b32 v24, v4 offset:3072
  ds_read_b32 v25, v4 offset:3328
  ds_read_b32 v26, v4 offset:3584
  ds_read_b32 v27, v4 offset:3840
  s_nop 1
  v_max_f32_dpp v5, v5, v5 row_ror:8 row_mask:0xf bank_mask:0xf
  s_nop 1
  v_max_f32_dpp v5, v5, v5 row_ror:4 row_mask:0xf bank_mask:0xf
  s_nop 1
  v_max_f32_dpp v5, v5, v5 row_ror:2 row_mask:0xf bank_mask:0xf
  s_nop 1
  v_max_f32_dpp v5, v5, v5 row_ror:1 row_mask:0xf bank_mask:0xf
  v_mov_b32 v7, v5
  s_nop 1
  v_permlane16_swap_b32 v5, v7
  v_max_f32 v5, v5, v7
  v_mov_b32 v7, v5
  s_nop 1
  v_permlane32_swap_b32 v5, v7
  v_max_f32 v5, v5, v7
  v_mov_b32 v6, 0
  s_waitcnt lgkmcnt(15)
  v_sub_f32 v12, v12, v5
  v_mul_f32 v12, s29, v12
  v_exp_f32 v12, v12
  s_waitcnt lgkmcnt(14)
  v_sub_f32 v13, v13, v5
  v_mul_f32 v13, s29, v13
  v_exp_f32 v13, v13
  v_add_f32 v6, v6, v12
  v_cvt_pk_bf16_f32 v12, v12, 0
  s_waitcnt lgkmcnt(13)
  v_sub_f32 v14, v14, v5
  v_mul_f32 v14, s29, v14
  v_exp_f32 v14, v14
  v_add_f32 v6, v6, v13
  v_cvt_pk_bf16_f32 v13, v13, 0
  s_waitcnt lgkmcnt(12)
  v_sub_f32 v15, v15, v5
  v_mul_f32 v15, s29, v15
  v_exp_f32 v15, v15
  v_add_f32 v6, v6, v14
  v_cvt_pk_bf16_f32 v14, v14, 0
  s_waitcnt lgkmcnt(11)
  v_sub_f32 v16, v16, v5
  v_mul_f32 v16, s29, v16
  v_exp_f32 v16, v16
  v_add_f32 v6, v6, v15
  v_cvt_pk_bf16_f32 v15, v15, 0
  s_waitcnt lgkmcnt(10)
  v_sub_f32 v17, v17, v5
  v_mul_f32 v17, s29, v17
  v_exp_f32 v17, v17
  v_add_f32 v6, v6, v16
  v_cvt_pk_bf16_f32 v16, v16, 0
  s_waitcnt lgkmcnt(9)
  v_sub_f32 v18, v18, v5
  v_mul_f32 v18, s29, v18
  v_exp_f32 v18, v18
  v_add_f32 v6, v6, v17
  v_cvt_pk_bf16_f32 v17, v17, 0
  s_waitcnt lgkmcnt(8)
  v_sub_f32 v19, v19, v5
  v_mul_f32 v19, s29, v19
  v_exp_f32 v19, v19
  v_add_f32 v6, v6, v18
  v_cvt_pk_bf16_f32 v18, v18, 0
  s_waitcnt lgkmcnt(7)
  v_sub_f32 v20, v20, v5
  v_mul_f32 v20, s29, v20
  v_exp_f32 v20, v20
  v_add_f32 v6, v6, v19
  v_cvt_pk_bf16_f32 v19, v19, 0
  s_waitcnt lgkmcnt(6)
  v_sub_f32 v21, v21, v5
  v_mul_f32 v21, s29, v21
  v_exp_f32 v21, v21
  v_add_f32 v6, v6, v20
  v_cvt_pk_bf16_f32 v20, v20, 0
  s_waitcnt lgkmcnt(5)
  v_sub_f32 v22, v22, v5
  v_mul_f32 v22, s29, v22
  v_exp_f32 v22, v22
  v_add_f32 v6, v6, v21
  v_cvt_pk_bf16_f32 v21, v21, 0
  s_waitcnt lgkmcnt(4)
  v_sub_f32 v23, v23, v5
  v_mul_f32 v23, s29, v23
  v_exp_f32 v23, v23
  v_add_f32 v6, v6, v22
  v_cvt_pk_bf16_f32 v22, v22, 0
  s_waitcnt lgkmcnt(3)
  v_sub_f32 v24, v24, v5
  v_mul_f32 v24, s29, v24
  v_exp_f32 v24, v24
  v_add_f32 v6, v6, v23
  v_cvt_pk_bf16_f32 v23, v23, 0
  s_waitcnt lgkmcnt(2)
  v_sub_f32 v25, v25, v5
  v_mul_f32 v25, s29, v25
  v_exp_f32 v25, v25
  v_add_f32 v6, v6, v24
  v_cvt_pk_bf16_f32 v24, v24, 0
  s_waitcnt lgkmcnt(1)
  v_sub_f32 v26, v26, v5
  v_mul_f32 v26, s29, v26
  v_exp_f32 v26, v26
  v_add_f32 v6, v6, v25
  v_cvt_pk_bf16_f32 v25, v25, 0
  s_waitcnt lgkmcnt(0)
  v_sub_f32 v27, v27, v5
  v_mul_f32 v27, s29, v27
  v_exp_f32 v27, v27
  v_add_f32 v6, v6, v26
  v_cvt_pk_bf16_f32 v26, v26, 0
  s_nop 0
  v_add_f32 v6, v6, v27
  v_cvt_pk_bf16_f32 v27, v27, 0
  ds_write_b32 v4, v13 offset:256
  ds_write_b32 v4, v14 offset:512
  ds_write_b32 v4, v15 offset:768
  ds_write_b32 v4, v16 offset:1024
  ds_write_b32 v4, v17 offset:1280
  ds_write_b32 v4, v18 offset:1536
  ds_write_b32 v4, v19 offset:1792
  ds_write_b32 v4, v20 offset:2048
  ds_write_b32 v4, v21 offset:2304
  ds_write_b32 v4, v22 offset:2560
  ds_write_b32 v4, v23 offset:2816
  ds_write_b32 v4, v24 offset:3072
  ds_write_b32 v4, v25 offset:3328
  ds_write_b32 v4, v26 offset:3584
  ds_write_b32 v4, v27 offset:3840
  v_mov_b32 v36, v12
  v_lshlrev_b32 v37, 16, v12
  s_nop 1
  v_add_f32_dpp v6, v6, v6 row_ror:8 row_mask:0xf bank_mask:0xf
  s_nop 1
  v_add_f32_dpp v6, v6, v6 row_ror:4 row_mask:0xf bank_mask:0xf
  s_nop 1
  v_add_f32_dpp v6, v6, v6 row_ror:2 row_mask:0xf bank_mask:0xf
  s_nop 1
  v_add_f32_dpp v6, v6, v6 row_ror:1 row_mask:0xf bank_mask:0xf
  v_mov_b32 v7, v6
  s_nop 1
  v_permlane16_swap_b32 v6, v7
  v_add_f32 v6, v6, v7
  v_mov_b32 v7, v6
  s_nop 1
  v_permlane32_swap_b32 v6, v7
  v_add_f32 v6, v6, v7
  v_lshlrev_b32 v1, 1, v44
  v_mov_b32 v40, v5
  v_mov_b32 v41, v6
  v_mov_b32 v42, 1
  s_mov_b64 exec, 1
  ds_write_b64 v1, v[40:41] offset:22528
  ds_write_b32 v44, v42 offset:22560
  s_mov_b64 exec, -1
  v_mov_b32 v28, 0
  v_mov_b32 v29, 0
  v_mov_b32 v30, 0
  v_mov_b32 v31, 0
  v_mov_b32 v32, 0
  v_mov_b32 v33, 0
  v_mov_b32 v34, 0
  v_mov_b32 v35, 0
  s_nop 1
  v_add_u32 v4, 0x100, v4
  ds_read_b32 v38, v4 offset:0
  ds_read_b32 v47, v44 offset:22784
  s_waitcnt vmcnt(7)
  v_dot2c_f32_bf16_dpp v28, v36, v48 row_newbcast:0 row_mask:0xf bank_mask:0xf
  v_dot2c_f32_bf16_dpp v29, v37, v48 row_newbcast:0 row_mask:0xf bank_mask:0xf
  v_dot2c_f32_bf16_dpp v30, v36, v49 row_newbcast:0 row_mask:0xf bank_mask:0xf
  v_dot2c_f32_bf16_dpp v31, v37, v49 row_newbcast:0 row_mask:0xf bank_mask:0xf
  v_dot2c_f32_bf16_dpp v32, v36, v50 row_newbcast:0 row_mask:0xf bank_mask:0xf
  v_dot2c_f32_bf16_dpp v33, v37, v50 row_newbcast:0 row_mask:0xf bank_mask:0xf
  v_dot2c_f32_bf16_dpp v34, v36, v51 row_newbcast:0 row_mask:0xf bank_mask:0xf
  v_dot2c_f32_bf16_dpp v35, v37, v51 row_newbcast:0 row_mask:0xf bank_mask:0xf
  s_waitcnt vmcnt(6)
  v_dot2c_f32_bf16_dpp v28, v36, v52 row_newbcast:1 row_mask:0xf bank_mask:0xf
  v_dot2c_f32_bf16_dpp v29, v37, v52 row_newbcast:1 row_mask:0xf bank_mask:0xf
  v_dot2c_f32_bf16_dpp v30, v36, v53 row_newbcast:1 row_mask:0xf bank_mask:0xf
  v_dot2c_f32_bf16_dpp v31, v37, v53 row_newbcast:1 row_mask:0xf bank_mask:0xf
  v_dot2c_f32_bf16_dpp v32, v36, v54 row_newbcast:1 row_mask:0xf bank_mask:0xf
  v_dot2c_f32_bf16_dpp v33, v37, v54 row_newbcast:1 row_mask:0xf bank_mask:0xf
  v_dot2c_f32_bf16_dpp v34, v36, v55 row_newbcast:1 row_mask:0xf bank_mask:0xf
  v_dot2c_f32_bf16_dpp v35, v37, v55 row_newbcast:1 row_mask:0xf bank_mask:0xf
  s_waitcnt vmcnt(5)
  v_dot2c_f32_bf16_dpp v28, v36, v56 row_newbcast:2 row_mask:0xf bank_mask:0xf
  v_dot2c_f32_bf16_dpp v29, v37, v56 row_newbcast:2 row_mask:0xf bank_mask:0xf
  v_dot2c_f32_bf16_dpp v30, v36, v57 row_newbcast:2 row_mask:0xf bank_mask:0xf
  v_dot2c_f32_bf16_dpp v31, v37, v57 row_newbcast:2 row_mask:0xf bank_mask:0xf
  v_dot2c_f32_bf16_dpp v32, v36, v58 row_newbcast:2 row_mask:0xf bank_mask:0xf
  v_dot2c_f32_bf16_dpp v33, v37, v58 row_newbcast:2 row_mask:0xf bank_mask:0xf
  v_dot2c_f32_bf16_dpp v34, v36, v59 row_newbcast:2 row_mask:0xf bank_mask:0xf
  v_dot2c_f32_bf16_dpp v35, v37, v59 row_newbcast:2 row_mask:0xf bank_mask:0xf
  s_waitcnt vmcnt(4)
  buffer_load_dwordx4 v[80:83], v3, s[16:19], s21 offen nt
  s_add_u32 s21, s21, 0x1000
  v_dot2c_f32_bf16_dpp v28, v36, v60 row_newbcast:3 row_mask:0xf bank_mask:0xf
  v_dot2c_f32_bf16_dpp v29, v37, v60 row_newbcast:3 row_mask:0xf bank_mask:0xf
  v_dot2c_f32_bf16_dpp v30, v36, v61 row_newbcast:3 row_mask:0xf bank_mask:0xf
  v_dot2c_f32_bf16_dpp v31, v37, v61 row_newbcast:3 row_mask:0xf bank_mask:0xf
  v_dot2c_f32_bf16_dpp v32, v36, v62 row_newbcast:3 row_mask:0xf bank_mask:0xf
  v_dot2c_f32_bf16_dpp v33, v37, v62 row_newbcast:3 row_mask:0xf bank_mask:0xf
  v_dot2c_f32_bf16_dpp v34, v36, v63 row_newbcast:3 row_mask:0xf bank_mask:0xf
  v_dot2c_f32_bf16_dpp v35, v37, v63 row_newbcast:3 row_mask:0xf bank_mask:0xf
  s_waitcnt vmcnt(4)
  buffer_load_dwordx4 v[84:87], v3, s[16:19], s21 offen nt
  s_add_u32 s21, s21, 0x1000
  v_dot2c_f32_bf16_dpp v28, v36, v64 row_newbcast:4 row_mask:0xf bank_mask:0xf
  v_dot2c_f32_bf16_dpp v29, v37, v64 row_newbcast:4 row_mask:0xf bank_mask:0xf
  v_dot2c_f32_bf16_dpp v30, v36, v65 row_newbcast:4 row_mask:0xf bank_mask:0xf
  v_dot2c_f32_bf16_dpp v31, v37, v65 row_newbcast:4 row_mask:0xf bank_mask:0xf
  v_dot2c_f32_bf16_dpp v32, v36, v66 row_newbcast:4 row_mask:0xf bank_mask:0xf
  v_dot2c_f32_bf16_dpp v33, v37, v66 row_newbcast:4 row_mask:0xf bank_mask:0xf
  v_dot2c_f32_bf16_dpp v34, v36, v67 row_newbcast:4 row_mask:0xf bank_mask:0xf
  v_dot2c_f32_bf16_dpp v35, v37, v67 row_newbcast:4 row_mask:0xf bank_mask:0xf
  s_waitcnt vmcnt(4)
  buffer_load_dwordx4 v[88:91], v3, s[16:19], s21 offen nt
  s_add_u32 s21, s21, 0x1000
  v_dot2c_f32_bf16_dpp v28, v36, v68 row_newbcast:5 row_mask:0xf bank_mask:0xf
  v_dot2c_f32_bf16_dpp v29, v37, v68 row_newbcast:5 row_mask:0xf bank_mask:0xf
  v_dot2c_f32_bf16_dpp v30, v36, v69 row_newbcast:5 row_mask:0xf bank_mask:0xf
  v_dot2c_f32_bf16_dpp v31, v37, v69 row_newbcast:5 row_mask:0xf bank_mask:0xf
  v_dot2c_f32_bf16_dpp v32, v36, v70 row_newbcast:5 row_mask:0xf bank_mask:0xf
  v_dot2c_f32_bf16_dpp v33, v37, v70 row_newbcast:5 row_mask:0xf bank_mask:0xf
  v_dot2c_f32_bf16_dpp v34, v36, v71 row_newbcast:5 row_mask:0xf bank_mask:0xf
  v_dot2c_f32_bf16_dpp v35, v37, v71 row_newbcast:5 row_mask:0xf bank_mask:0xf
  s_waitcnt vmcnt(4)
  buffer_load_dwordx4 v[92:95], v3, s[16:19], s21 offen nt
  s_add_u32 s21, s21, 0x1000
  v_dot2c_f32_bf16_dpp v28, v36, v72 row_newbcast:6 row_mask:0xf bank_mask:0xf
  v_dot2c_f32_bf16_dpp v29, v37, v72 row_newbcast:6 row_mask:0xf bank_mask:0xf
  v_dot2c_f32_bf16_dpp v30, v36, v73 row_newbcast:6 row_mask:0xf bank_mask:0xf
  v_dot2c_f32_bf16_dpp v31, v37, v73 row_newbcast:6 row_mask:0xf bank_mask:0xf
  v_dot2c_f32_bf16_dpp v32, v36, v74 row_newbcast:6 row_mask:0xf bank_mask:0xf
  v_dot2c_f32_bf16_dpp v33, v37, v74 row_newbcast:6 row_mask:0xf bank_mask:0xf
  v_dot2c_f32_bf16_dpp v34, v36, v75 row_newbcast:6 row_mask:0xf bank_mask:0xf
  v_dot2c_f32_bf16_dpp v35, v37, v75 row_newbcast:6 row_mask:0xf bank_mask:0xf
  s_waitcnt vmcnt(4)
  buffer_load_dwordx4 v[96:99], v3, s[16:19], s21 offen nt
  s_add_u32 s21, s21, 0x1000
  v_dot2c_f32_bf16_dpp v28, v36, v76 row_newbcast:7 row_mask:0xf bank_mask:0xf
  v_dot2c_f32_bf16_dpp v29, v37, v76 row_newbcast:7 row_mask:0xf bank_mask:0xf
  v_dot2c_f32_bf16_dpp v30, v36, v77 row_newbcast:7 row_mask:0xf bank_mask:0xf
  v_dot2c_f32_bf16_dpp v31, v37, v77 row_newbcast:7 row_mask:0xf bank_mask:0xf
  v_dot2c_f32_bf16_dpp v32, v36, v78 row_newbcast:7 row_mask:0xf bank_mask:0xf
  v_dot2c_f32_bf16_dpp v33, v37, v78 row_newbcast:7 row_mask:0xf bank_mask:0xf
  v_dot2c_f32_bf16_dpp v34, v36, v79 row_newbcast:7 row_mask:0xf bank_mask:0xf
  v_dot2c_f32_bf16_dpp v35, v37, v79 row_newbcast:7 row_mask:0xf bank_mask:0xf
  s_waitcnt vmcnt(4)
  buffer_load_dwordx4 v[100:103], v3, s[16:19], s21 offen nt
  s_add_u32 s21, s21, 0x1000
  v_dot2c_f32_bf16_dpp v28, v36, v80 row_newbcast:8 row_mask:0xf bank_mask:0xf
  v_dot2c_f32_bf16_dpp v29, v37, v80 row_newbcast:8 row_mask:0xf bank_mask:0xf
  v_dot2c_f32_bf16_dpp v30, v36, v81 row_newbcast:8 row_mask:0xf bank_mask:0xf
  v_dot2c_f32_bf16_dpp v31, v37, v81 row_newbcast:8 row_mask:0xf bank_mask:0xf
  v_dot2c_f32_bf16_dpp v32, v36, v82 row_newbcast:8 row_mask:0xf bank_mask:0xf
  v_dot2c_f32_bf16_dpp v33, v37, v82 row_newbcast:8 row_mask:0xf bank_mask:0xf
  v_dot2c_f32_bf16_dpp v34, v36, v83 row_newbcast:8 row_mask:0xf bank_mask:0xf
  v_dot2c_f32_bf16_dpp v35, v37, v83 row_newbcast:8 row_mask:0xf bank_mask:0xf
  s_waitcnt vmcnt(4)
  buffer_load_dwordx4 v[104:107], v3, s[16:19], s21 offen nt
  s_add_u32 s21, s21, 0x1000
  v_dot2c_f32_bf16_dpp v28, v36, v84 row_newbcast:9 row_mask:0xf bank_mask:0xf
  v_dot2c_f32_bf16_dpp v29, v37, v84 row_newbcast:9 row_mask:0xf bank_mask:0xf
  v_dot2c_f32_bf16_dpp v30, v36, v85 row_newbcast:9 row_mask:0xf bank_mask:0xf
  v_dot2c_f32_bf16_dpp v31, v37, v85 row_newbcast:9 row_mask:0xf bank_mask:0xf
  v_dot2c_f32_bf16_dpp v32, v36, v86 row_newbcast:9 row_mask:0xf bank_mask:0xf
  v_dot2c_f32_bf16_dpp v33, v37, v86 row_newbcast:9 row_mask:0xf bank_mask:0xf
  v_dot2c_f32_bf16_dpp v34, v36, v87 row_newbcast:9 row_mask:0xf bank_mask:0xf
  v_dot2c_f32_bf16_dpp v35, v37, v87 row_newbcast:9 row_mask:0xf bank_mask:0xf
  s_waitcnt vmcnt(4)
  buffer_load_dwordx4 v[108:111], v3, s[16:19], s21 offen nt
  s_add_u32 s21, s21, 0x1000
  v_dot2c_f32_bf16_dpp v28, v36, v88 row_newbcast:10 row_mask:0xf bank_mask:0xf
  v_dot2c_f32_bf16_dpp v29, v37, v88 row_newbcast:10 row_mask:0xf bank_mask:0xf
  v_dot2c_f32_bf16_dpp v30, v36, v89 row_newbcast:10 row_mask:0xf bank_mask:0xf
  v_dot2c_f32_bf16_dpp v31, v37, v89 row_newbcast:10 row_mask:0xf bank_mask:0xf
  v_dot2c_f32_bf16_dpp v32, v36, v90 row_newbcast:10 row_mask:0xf bank_mask:0xf
  v_dot2c_f32_bf16_dpp v33, v37, v90 row_newbcast:10 row_mask:0xf bank_mask:0xf
  v_dot2c_f32_bf16_dpp v34, v36, v91 row_newbcast:10 row_mask:0xf bank_mask:0xf
  v_dot2c_f32_bf16_dpp v35, v37, v91 row_newbcast:10 row_mask:0xf bank_mask:0xf
  s_waitcnt vmcnt(4)
  buffer_load_dwordx4 v[48:51], v3, s[16:19], s21 offen nt
  s_add_u32 s21, s21, 0x1000
  v_dot2c_f32_bf16_dpp v28, v36, v92 row_newbcast:11 row_mask:0xf bank_mask:0xf
  v_dot2c_f32_bf16_dpp v29, v37, v92 row_newbcast:11 row_mask:0xf bank_mask:0xf
  v_dot2c_f32_bf16_dpp v30, v36, v93 row_newbcast:11 row_mask:0xf bank_mask:0xf
  v_dot2c_f32_bf16_dpp v31, v37, v93 row_newbcast:11 row_mask:0xf bank_mask:0xf
  v_dot2c_f32_bf16_dpp v32, v36, v94 row_newbcast:11 row_mask:0xf bank_mask:0xf
  v_dot2c_f32_bf16_dpp v33, v37, v94 row_newbcast:11 row_mask:0xf bank_mask:0xf
  v_dot2c_f32_bf16_dpp v34, v36, v95 row_newbcast:11 row_mask:0xf bank_mask:0xf
  v_dot2c_f32_bf16_dpp v35, v37, v95 row_newbcast:11 row_mask:0xf bank_mask:0xf
  s_waitcnt vmcnt(4)
  buffer_load_dwordx4 v[52:55], v3, s[16:19], s21 offen nt
  s_add_u32 s21, s21, 0x1000
  v_dot2c_f32_bf16_dpp v28, v36, v96 row_newbcast:12 row_mask:0xf bank_mask:0xf
  v_dot2c_f32_bf16_dpp v29, v37, v96 row_newbcast:12 row_mask:0xf bank_mask:0xf
  v_dot2c_f32_bf16_dpp v30, v36, v97 row_newbcast:12 row_mask:0xf bank_mask:0xf
  v_dot2c_f32_bf16_dpp v31, v37, v97 row_newbcast:12 row_mask:0xf bank_mask:0xf
  v_dot2c_f32_bf16_dpp v32, v36, v98 row_newbcast:12 row_mask:0xf bank_mask:0xf
  v_dot2c_f32_bf16_dpp v33, v37, v98 row_newbcast:12 row_mask:0xf bank_mask:0xf
  v_dot2c_f32_bf16_dpp v34, v36, v99 row_newbcast:12 row_mask:0xf bank_mask:0xf
  v_dot2c_f32_bf16_dpp v35, v37, v99 row_newbcast:12 row_mask:0xf bank_mask:0xf
  s_waitcnt vmcnt(4)
  buffer_load_dwordx4 v[56:59], v3, s[16:19], s21 offen nt
  s_add_u32 s21, s21, 0x1000
  v_dot2c_f32_bf16_dpp v28, v36, v100 row_newbcast:13 row_mask:0xf bank_mask:0xf
  v_dot2c_f32_bf16_dpp v29, v37, v100 row_newbcast:13 row_mask:0xf bank_mask:0xf
  v_dot2c_f32_bf16_dpp v30, v36, v101 row_newbcast:13 row_mask:0xf bank_mask:0xf
  v_dot2c_f32_bf16_dpp v31, v37, v101 row_newbcast:13 row_mask:0xf bank_mask:0xf
  v_dot2c_f32_bf16_dpp v32, v36, v102 row_newbcast:13 row_mask:0xf bank_mask:0xf
  v_dot2c_f32_bf16_dpp v33, v37, v102 row_newbcast:13 row_mask:0xf bank_mask:0xf
  v_dot2c_f32_bf16_dpp v34, v36, v103 row_newbcast:13 row_mask:0xf bank_mask:0xf
  v_dot2c_f32_bf16_dpp v35, v37, v103 row_newbcast:13 row_mask:0xf bank_mask:0xf
  s_waitcnt vmcnt(4)
  buffer_load_dwordx4 v[60:63], v3, s[16:19], s21 offen nt
  s_add_u32 s21, s21, 0x1000
  v_dot2c_f32_bf16_dpp v28, v36, v104 row_newbcast:14 row_mask:0xf bank_mask:0xf
  v_dot2c_f32_bf16_dpp v29, v37, v104 row_newbcast:14 row_mask:0xf bank_mask:0xf
  v_dot2c_f32_bf16_dpp v30, v36, v105 row_newbcast:14 row_mask:0xf bank_mask:0xf
  v_dot2c_f32_bf16_dpp v31, v37, v105 row_newbcast:14 row_mask:0xf bank_mask:0xf
  v_dot2c_f32_bf16_dpp v32, v36, v106 row_newbcast:14 row_mask:0xf bank_mask:0xf
  v_dot2c_f32_bf16_dpp v33, v37, v106 row_newbcast:14 row_mask:0xf bank_mask:0xf
  v_dot2c_f32_bf16_dpp v34, v36, v107 row_newbcast:14 row_mask:0xf bank_mask:0xf
  v_dot2c_f32_bf16_dpp v35, v37, v107 row_newbcast:14 row_mask:0xf bank_mask:0xf
  s_waitcnt vmcnt(4)
  buffer_load_dwordx4 v[64:67], v3, s[16:19], s21 offen nt
  s_add_u32 s21, s21, 0x1000
  v_dot2c_f32_bf16_dpp v28, v36, v108 row_newbcast:15 row_mask:0xf bank_mask:0xf
  v_dot2c_f32_bf16_dpp v29, v37, v108 row_newbcast:15 row_mask:0xf bank_mask:0xf
  v_dot2c_f32_bf16_dpp v30, v36, v109 row_newbcast:15 row_mask:0xf bank_mask:0xf
  v_dot2c_f32_bf16_dpp v31, v37, v109 row_newbcast:15 row_mask:0xf bank_mask:0xf
  v_dot2c_f32_bf16_dpp v32, v36, v110 row_newbcast:15 row_mask:0xf bank_mask:0xf
  v_dot2c_f32_bf16_dpp v33, v37, v110 row_newbcast:15 row_mask:0xf bank_mask:0xf
  v_dot2c_f32_bf16_dpp v34, v36, v111 row_newbcast:15 row_mask:0xf bank_mask:0xf
  v_dot2c_f32_bf16_dpp v35, v37, v111 row_newbcast:15 row_mask:0xf bank_mask:0xf
  s_waitcnt lgkmcnt(0)
  v_mov_b32 v36, v38
  v_lshlrev_b32 v37, 16, v38
  s_mov_b32 s22, 14
L_vlo:
  s_sub_u32 s34, 31, s22
  v_readfirstlane_b32 s33, v47
  v_add_u32 v4, 0x100, v4
  ds_read_b32 v38, v4 offset:0
  v_mov_b32 v45, s34
  ds_write_b32 v44, v45 offset:22576
  s_bitcmp1_b32 s33, s34
  s_cbranch_scc1 L_vup
  s_waitcnt vmcnt(4)
  buffer_load_dwordx4 v[68:71], v3, s[16:19], s21 offen nt
  s_add_u32 s21, s21, 0x1000
  v_dot2c_f32_bf16_dpp v28, v36, v48 row_newbcast:0 row_mask:0xf bank_mask:0xf
  v_dot2c_f32_bf16_dpp v29, v37, v48 row_newbcast:0 row_mask:0xf bank_mask:0xf
  v_dot2c_f32_bf16_dpp v30, v36, v49 row_newbcast:0 row_mask:0xf bank_mask:0xf
  v_dot2c_f32_bf16_dpp v31, v37, v49 row_newbcast:0 row_mask:0xf bank_mask:0xf
  v_dot2c_f32_bf16_dpp v32, v36, v50 row_newbcast:0 row_mask:0xf bank_mask:0xf
  v_dot2c_f32_bf16_dpp v33, v37, v50 row_newbcast:0 row_mask:0xf bank_mask:0xf
  v_dot2c_f32_bf16_dpp v34, v36, v51 row_newbcast:0 row_mask:0xf bank_mask:0xf
  v_dot2c_f32_bf16_dpp v35, v37, v51 row_newbcast:0 row_mask:0xf bank_mask:0xf
L_vlo_k:
  s_waitcnt vmcnt(4)
  buffer_load_dwordx4 v[72:75], v3, s[16:19], s21 offen nt
  s_add_u32 s21, s21, 0x1000
  v_dot2c_f32_bf16_dpp v28, v36, v52 row_newbcast:1 row_mask:0xf bank_mask:0xf
  v_dot2c_f32_bf16_dpp v29, v37, v52 row_newbcast:1 row_mask:0xf bank_mask:0xf
  v_dot2c_f32_bf16_dpp v30, v36, v53 row_newbcast:1 row_mask:0xf bank_mask:0xf
  v_dot2c_f32_bf16_dpp v31, v37, v53 row_newbcast:1 row_mask:0xf bank_mask:0xf
  v_dot2c_f32_bf16_dpp v32, v36, v54 row_newbcast:1 row_mask:0xf bank_mask:0xf
  v_dot2c_f32_bf16_dpp v33, v37, v54 row_newbcast:1 row_mask:0xf bank_mask:0xf
  v_dot2c_f32_bf16_dpp v34, v36, v55 row_newbcast:1 row_mask:0xf bank_mask:0xf
  v_dot2c_f32_bf16_dpp v35, v37, v55 row_newbcast:1 row_mask:0xf bank_mask:0xf
  s_waitcnt vmcnt(4)
  buffer_load_dwordx4 v[76:79], v3, s[16:19], s21 offen nt
  s_add_u32 s21, s21, 0x1000
  v_dot2c_f32_bf16_dpp v28, v36, v56 row_newbcast:2 row_mask:0xf bank_mask:0xf
  v_dot2c_f32_bf16_dpp v29, v37, v56 row_newbcast:2 row_mask:0xf bank_mask:0xf
  v_dot2c_f32_bf16_dpp v30, v36, v57 row_newbcast:2 row_mask:0xf bank_mask:0xf
  v_dot2c_f32_bf16_dpp v31, v37, v57 row_newbcast:2 row_mask:0xf bank_mask:0xf
  v_dot2c_f32_bf16_dpp v32, v36, v58 row_newbcast:2 row_mask:0xf bank_mask:0xf
  v_dot2c_f32_bf16_dpp v33, v37, v58 row_newbcast:2 row_mask:0xf bank_mask:0xf
  v_dot2c_f32_bf16_dpp v34, v36, v59 row_newbcast:2 row_mask:0xf bank_mask:0xf
  v_dot2c_f32_bf16_dpp v35, v37, v59 row_newbcast:2 row_mask:0xf bank_mask:0xf
  s_waitcnt vmcnt(4)
  buffer_load_dwordx4 v[80:83], v3, s[16:19], s21 offen nt
  s_add_u32 s21, s21, 0x1000
  v_dot2c_f32_bf16_dpp v28, v36, v60 row_newbcast:3 row_mask:0xf bank_mask:0xf
  v_dot2c_f32_bf16_dpp v29, v37, v60 row_newbcast:3 row_mask:0xf bank_mask:0xf
  v_dot2c_f32_bf16_dpp v30, v36, v61 row_newbcast:3 row_mask:0xf bank_mask:0xf
  v_dot2c_f32_bf16_dpp v31, v37, v61 row_newbcast:3 row_mask:0xf bank_mask:0xf
  v_dot2c_f32_bf16_dpp v32, v36, v62 row_newbcast:3 row_mask:0xf bank_mask:0xf
  v_dot2c_f32_bf16_dpp v33, v37, v62 row_newbcast:3 row_mask:0xf bank_mask:0xf
  v_dot2c_f32_bf16_dpp v34, v36, v63 row_newbcast:3 row_mask:0xf bank_mask:0xf
  v_dot2c_f32_bf16_dpp v35, v37, v63 row_newbcast:3 row_mask:0xf bank_mask:0xf
  s_waitcnt vmcnt(4)
  buffer_load_dwordx4 v[84:87], v3, s[16:19], s21 offen nt
  s_add_u32 s21, s21, 0x1000
  v_dot2c_f32_bf16_dpp v28, v36, v64 row_newbcast:4 row_mask:0xf bank_mask:0xf
  v_dot2c_f32_bf16_dpp v29, v37, v64 row_newbcast:4 row_mask:0xf bank_mask:0xf
  v_dot2c_f32_bf16_dpp v30, v36, v65 row_newbcast:4 row_mask:0xf bank_mask:0xf
  v_dot2c_f32_bf16_dpp v31, v37, v65 row_newbcast:4 row_mask:0xf bank_mask:0xf
  v_dot2c_f32_bf16_dpp v32, v36, v66 row_newbcast:4 row_mask:0xf bank_mask:0xf
  v_dot2c_f32_bf16_dpp v33, v37, v66 row_newbcast:4 row_mask:0xf bank_mask:0xf
  v_dot2c_f32_bf16_dpp v34, v36, v67 row_newbcast:4 row_mask:0xf bank_mask:0xf
  v_dot2c_f32_bf16_dpp v35, v37, v67 row_newbcast:4 row_mask:0xf bank_mask:0xf
  s_waitcnt vmcnt(4)
  buffer_load_dwordx4 v[88:91], v3, s[16:19], s21 offen nt
  s_add_u32 s21, s21, 0x1000
  v_dot2c_f32_bf16_dpp v28, v36, v68 row_newbcast:5 row_mask:0xf bank_mask:0xf
  v_dot2c_f32_bf16_dpp v29, v37, v68 row_newbcast:5 row_mask:0xf bank_mask:0xf
  v_dot2c_f32_bf16_dpp v30, v36, v69 row_newbcast:5 row_mask:0xf bank_mask:0xf
  v_dot2c_f32_bf16_dpp v31, v37, v69 row_newbcast:5 row_mask:0xf bank_mask:0xf
  v_dot2c_f32_bf16_dpp v32, v36, v70 row_newbcast:5 row_mask:0xf bank_mask:0xf
  v_dot2c_f32_bf16_dpp v33, v37, v70 row_newbcast:5 row_mask:0xf bank_mask:0xf
  v_dot2c_f32_bf16_dpp v34, v36, v71 row_newbcast:5 row_mask:0xf bank_mask:0xf
  v_dot2c_f32_bf16_dpp v35, v37, v71 row_newbcast:5 row_mask:0xf bank_mask:0xf
  s_waitcnt vmcnt(4)
  buffer_load_dwordx4 v[92:95], v3, s[16:19], s21 offen nt
  s_add_u32 s21, s21, 0x1000
  v_dot2c_f32_bf16_dpp v28, v36, v72 row_newbcast:6 row_mask:0xf bank_mask:0xf
  v_dot2c_f32_bf16_dpp v29, v37, v72 row_newbcast:6 row_mask:0xf bank_mask:0xf
  v_dot2c_f32_bf16_dpp v30, v36, v73 row_newbcast:6 row_mask:0xf bank_mask:0xf
  v_dot2c_f32_bf16_dpp v31, v37, v73 row_newbcast:6 row_mask:0xf bank_mask:0xf
  v_dot2c_f32_bf16_dpp v32, v36, v74 row_newbcast:6 row_mask:0xf bank_mask:0xf
  v_dot2c_f32_bf16_dpp v33, v37, v74 row_newbcast:6 row_mask:0xf bank_mask:0xf
  v_dot2c_f32_bf16_dpp v34, v36, v75 row_newbcast:6 row_mask:0xf bank_mask:0xf
  v_dot2c_f32_bf16_dpp v35, v37, v75 row_newbcast:6 row_mask:0xf bank_mask:0xf
  s_waitcnt vmcnt(4)
  buffer_load_dwordx4 v[96:99], v3, s[16:19], s21 offen nt
  s_add_u32 s21, s21, 0x1000
  v_dot2c_f32_bf16_dpp v28, v36, v76 row_newbcast:7 row_mask:0xf bank_mask:0xf
  v_dot2c_f32_bf16_dpp v29, v37, v76 row_newbcast:7 row_mask:0xf bank_mask:0xf
  v_dot2c_f32_bf16_dpp v30, v36, v77 row_newbcast:7 row_mask:0xf bank_mask:0xf
  v_dot2c_f32_bf16_dpp v31, v37, v77 row_newbcast:7 row_mask:0xf bank_mask:0xf
  v_dot2c_f32_bf16_dpp v32, v36, v78 row_newbcast:7 row_mask:0xf bank_mask:0xf
  v_dot2c_f32_bf16_dpp v33, v37, v78 row_newbcast:7 row_mask:0xf bank_mask:0xf
  v_dot2c_f32_bf16_dpp v34, v36, v79 row_newbcast:7 row_mask:0xf bank_mask:0xf
  v_dot2c_f32_bf16_dpp v35, v37, v79 row_newbcast:7 row_mask:0xf bank_mask:0xf
  s_waitcnt vmcnt(4)
  buffer_load_dwordx4 v[100:103], v3, s[16:19], s21 offen nt
  s_add_u32 s21, s21, 0x1000
  v_dot2c_f32_bf16_dpp v28, v36, v80 row_newbcast:8 row_mask:0xf bank_mask:0xf
  v_dot2c_f32_bf16_dpp v29, v37, v80 row_newbcast:8 row_mask:0xf bank_mask:0xf
  v_dot2c_f32_bf16_dpp v30, v36, v81 row_newbcast:8 row_mask:0xf bank_mask:0xf
  v_dot2c_f32_bf16_dpp v31, v37, v81 row_newbcast:8 row_mask:0xf bank_mask:0xf
  v_dot2c_f32_bf16_dpp v32, v36, v82 row_newbcast:8 row_mask:0xf bank_mask:0xf
  v_dot2c_f32_bf16_dpp v33, v37, v82 row_newbcast:8 row_mask:0xf bank_mask:0xf
  v_dot2c_f32_bf16_dpp v34, v36, v83 row_newbcast:8 row_mask:0xf bank_mask:0xf
  v_dot2c_f32_bf16_dpp v35, v37, v83 row_newbcast:8 row_mask:0xf bank_mask:0xf
  s_waitcnt vmcnt(4)
  buffer_load_dwordx4 v[104:107], v3, s[16:19], s21 offen nt
  s_add_u32 s21, s21, 0x1000
  v_dot2c_f32_bf16_dpp v28, v36, v84 row_newbcast:9 row_mask:0xf bank_mask:0xf
  v_dot2c_f32_bf16_dpp v29, v37, v84 row_newbcast:9 row_mask:0xf bank_mask:0xf
  v_dot2c_f32_bf16_dpp v30, v36, v85 row_newbcast:9 row_mask:0xf bank_mask:0xf
  v_dot2c_f32_bf16_dpp v31, v37, v85 row_newbcast:9 row_mask:0xf bank_mask:0xf
  v_dot2c_f32_bf16_dpp v32, v36, v86 row_newbcast:9 row_mask:0xf bank_mask:0xf
  v_dot2c_f32_bf16_dpp v33, v37, v86 row_newbcast:9 row_mask:0xf bank_mask:0xf
  v_dot2c_f32_bf16_dpp v34, v36, v87 row_newbcast:9 row_mask:0xf bank_mask:0xf
  v_dot2c_f32_bf16_dpp v35, v37, v87 row_newbcast:9 row_mask:0xf bank_mask:0xf
  s_waitcnt vmcnt(4)
  buffer_load_dwordx4 v[108:111], v3, s[16:19], s21 offen nt
  s_add_u32 s21, s21, 0x1000
  v_dot2c_f32_bf16_dpp v28, v36, v88 row_newbcast:10 row_mask:0xf bank_mask:0xf
  v_dot2c_f32_bf16_dpp v29, v37, v88 row_newbcast:10 row_mask:0xf bank_mask:0xf
  v_dot2c_f32_bf16_dpp v30, v36, v89 row_newbcast:10 row_mask:0xf bank_mask:0xf
  v_dot2c_f32_bf16_dpp v31, v37, v89 row_newbcast:10 row_mask:0xf bank_mask:0xf
  v_dot2c_f32_bf16_dpp v32, v36, v90 row_newbcast:10 row_mask:0xf bank_mask:0xf
  v_dot2c_f32_bf16_dpp v33, v37, v90 row_newbcast:10 row_mask:0xf bank_mask:0xf
  v_dot2c_f32_bf16_dpp v34, v36, v91 row_newbcast:10 row_mask:0xf bank_mask:0xf
  v_dot2c_f32_bf16_dpp v35, v37, v91 row_newbcast:10 row_mask:0xf bank_mask:0xf
  s_waitcnt vmcnt(4)
  buffer_load_dwordx4 v[48:51], v3, s[16:19], s21 offen nt
  s_add_u32 s21, s21, 0x1000
  v_dot2c_f32_bf16_dpp v28, v36, v92 row_newbcast:11 row_mask:0xf bank_mask:0xf
  v_dot2c_f32_bf16_dpp v29, v37, v92 row_newbcast:11 row_mask:0xf bank_mask:0xf
  v_dot2c_f32_bf16_dpp v30, v36, v93 row_newbcast:11 row_mask:0xf bank_mask:0xf
  v_dot2c_f32_bf16_dpp v31, v37, v93 row_newbcast:11 row_mask:0xf bank_mask:0xf
  v_dot2c_f32_bf16_dpp v32, v36, v94 row_newbcast:11 row_mask:0xf bank_mask:0xf
  v_dot2c_f32_bf16_dpp v33, v37, v94 row_newbcast:11 row_mask:0xf bank_mask:0xf
  v_dot2c_f32_bf16_dpp v34, v36, v95 row_newbcast:11 row_mask:0xf bank_mask:0xf
  v_dot2c_f32_bf16_dpp v35, v37, v95 row_newbcast:11 row_mask:0xf bank_mask:0xf
  s_waitcnt vmcnt(4)
  buffer_load_dwordx4 v[52:55], v3, s[16:19], s21 offen nt
  s_add_u32 s21, s21, 0x1000
  v_dot2c_f32_bf16_dpp v28, v36, v96 row_newbcast:12 row_mask:0xf bank_mask:0xf
  v_dot2c_f32_bf16_dpp v29, v37, v96 row_newbcast:12 row_mask:0xf bank_mask:0xf
  v_dot2c_f32_bf16_dpp v30, v36, v97 row_newbcast:12 row_mask:0xf bank_mask:0xf
  v_dot2c_f32_bf16_dpp v31, v37, v97 row_newbcast:12 row_mask:0xf bank_mask:0xf
  v_dot2c_f32_bf16_dpp v32, v36, v98 row_newbcast:12 row_mask:0xf bank_mask:0xf
  v_dot2c_f32_bf16_dpp v33, v37, v98 row_newbcast:12 row_mask:0xf bank_mask:0xf
  v_dot2c_f32_bf16_dpp v34, v36, v99 row_newbcast:12 row_mask:0xf bank_mask:0xf
  v_dot2c_f32_bf16_dpp v35, v37, v99 row_newbcast:12 row_mask:0xf bank_mask:0xf
  s_waitcnt vmcnt(4)
  buffer_load_dwordx4 v[56:59], v3, s[16:19], s21 offen nt
  s_add_u32 s21, s21, 0x1000
  ds_read_b32 v47, v44 offset:22784
  v_dot2c_f32_bf16_dpp v28, v36, v100 row_newbcast:13 row_mask:0xf bank_mask:0xf
  v_dot2c_f32_bf16_dpp v29, v37, v100 row_newbcast:13 row_mask:0xf bank_mask:0xf
  v_dot2c_f32_bf16_dpp v30, v36, v101 row_newbcast:13 row_mask:0xf bank_mask:0xf
  v_dot2c_f32_bf16_dpp v31, v37, v101 row_newbcast:13 row_mask:0xf bank_mask:0xf
  v_dot2c_f32_bf16_dpp v32, v36, v102 row_newbcast:13 row_mask:0xf bank_mask:0xf
  v_dot2c_f32_bf16_dpp v33, v37, v102 row_newbcast:13 row_mask:0xf bank_mask:0xf
  v_dot2c_f32_bf16_dpp v34, v36, v103 row_newbcast:13 row_mask:0xf bank_mask:0xf
  v_dot2c_f32_bf16_dpp v35, v37, v103 row_newbcast:13 row_mask:0xf bank_mask:0xf
  s_waitcnt vmcnt(4)
  buffer_load_dwordx4 v[60:63], v3, s[16:19], s21 offen nt
  s_add_u32 s21, s21, 0x1000
  v_dot2c_f32_bf16_dpp v28, v36, v104 row_newbcast:14 row_mask:0xf bank_mask:0xf
  v_dot2c_f32_bf16_dpp v29, v37, v104 row_newbcast:14 row_mask:0xf bank_mask:0xf
  v_dot2c_f32_bf16_dpp v30, v36, v105 row_newbcast:14 row_mask:0xf bank_mask:0xf
  v_dot2c_f32_bf16_dpp v31, v37, v105 row_newbcast:14 row_mask:0xf bank_mask:0xf
  v_dot2c_f32_bf16_dpp v32, v36, v106 row_newbcast:14 row_mask:0xf bank_mask:0xf
  v_dot2c_f32_bf16_dpp v33, v37, v106 row_newbcast:14 row_mask:0xf bank_mask:0xf
  v_dot2c_f32_bf16_dpp v34, v36, v107 row_newbcast:14 row_mask:0xf bank_mask:0xf
  v_dot2c_f32_bf16_dpp v35, v37, v107 row_newbcast:14 row_mask:0xf bank_mask:0xf
  s_waitcnt vmcnt(4)
  buffer_load_dwordx4 v[64:67], v3, s[16:19], s21 offen nt
  s_add_u32 s21, s21, 0x1000
  v_dot2c_f32_bf16_dpp v28, v36, v108 row_newbcast:15 row_mask:0xf bank_mask:0xf
  v_dot2c_f32_bf16_dpp v29, v37, v108 row_newbcast:15 row_mask:0xf bank_mask:0xf
  v_dot2c_f32_bf16_dpp v30, v36, v109 row_newbcast:15 row_mask:0xf bank_mask:0xf
  v_dot2c_f32_bf16_dpp v31, v37, v109 row_newbcast:15 row_mask:0xf bank_mask:0xf
  v_dot2c_f32_bf16_dpp v32, v36, v110 row_newbcast:15 row_mask:0xf bank_mask:0xf
  v_dot2c_f32_bf16_dpp v33, v37, v110 row_newbcast:15 row_mask:0xf bank_mask:0xf
  v_dot2c_f32_bf16_dpp v34, v36, v111 row_newbcast:15 row_mask:0xf bank_mask:0xf
  v_dot2c_f32_bf16_dpp v35, v37, v111 row_newbcast:15 row_mask:0xf bank_mask:0xf
  s_waitcnt lgkmcnt(0)
  v_mov_b32 v36, v38
  v_lshlrev_b32 v37, 16, v38
  s_sub_u32 s22, s22, 1
  s_cmp_lg_u32 s22, 0
  s_cbranch_scc1 L_vlo
  s_branch L_vx
L_vup:
  buffer_load_dwordx4 v[68:71], v3, s[16:19], s21 offen nt
  s_add_u32 s21, s21, 0x1000
  s_branch L_vhib
L_vhi:
  s_sub_u32 s34, 31, s22
  v_readfirstlane_b32 s33, v47
  v_add_u32 v4, 0x100, v4
  ds_read_b32 v38, v4 offset:0
  v_mov_b32 v45, s34
  ds_write_b32 v44, v45 offset:22576
  s_bitcmp1_b32 s33, s34
  s_cbranch_scc0 L_vdn
L_vhib:
  s_waitcnt vmcnt(5)
  buffer_load_dwordx4 v[72:75], v3, s[16:19], s21 offen nt
  s_add_u32 s21, s21, 0x1000
  v_dot2c_f32_bf16_dpp v28, v36, v48 row_newbcast:0 row_mask:0xf bank_mask:0xf
  v_dot2c_f32_bf16_dpp v29, v37, v48 row_newbcast:0 row_mask:0xf bank_mask:0xf
  v_dot2c_f32_bf16_dpp v30, v36, v49 row_newbcast:0 row_mask:0xf bank_mask:0xf
  v_dot2c_f32_bf16_dpp v31, v37, v49 row_newbcast:0 row_mask:0xf bank_mask:0xf
  v_dot2c_f32_bf16_dpp v32, v36, v50 row_newbcast:0 row_mask:0xf bank_mask:0xf
  v_dot2c_f32_bf16_dpp v33, v37, v50 row_newbcast:0 row_mask:0xf bank_mask:0xf
  v_dot2c_f32_bf16_dpp v34, v36, v51 row_newbcast:0 row_mask:0xf bank_mask:0xf
  v_dot2c_f32_bf16_dpp v35, v37, v51 row_newbcast:0 row_mask:0xf bank_mask:0xf
  s_waitcnt vmcnt(5)
  buffer_load_dwordx4 v[76:79], v3, s[16:19], s21 offen nt
  s_add_u32 s21, s21, 0x1000
  v_dot2c_f32_bf16_dpp v28, v36, v52 row_newbcast:1 row_mask:0xf bank_mask:0xf
  v_dot2c_f32_bf16_dpp v29, v37, v52 row_newbcast:1 row_mask:0xf bank_mask:0xf
  v_dot2c_f32_bf16_dpp v30, v36, v53 row_newbcast:1 row_mask:0xf bank_mask:0xf
  v_dot2c_f32_bf16_dpp v31, v37, v53 row_newbcast:1 row_mask:0xf bank_mask:0xf
  v_dot2c_f32_bf16_dpp v32, v36, v54 row_newbcast:1 row_mask:0xf bank_mask:0xf
  v_dot2c_f32_bf16_dpp v33, v37, v54 row_newbcast:1 row_mask:0xf bank_mask:0xf
  v_dot2c_f32_bf16_dpp v34, v36, v55 row_newbcast:1 row_mask:0xf bank_mask:0xf
  v_dot2c_f32_bf16_dpp v35, v37, v55 row_newbcast:1 row_mask:0xf bank_mask:0xf
  s_waitcnt vmcnt(5)
  buffer_load_dwordx4 v[80:83], v3, s[16:19], s21 offen nt
  s_add_u32 s21, s21, 0x1000
  v_dot2c_f32_bf16_dpp v28, v36, v56 row_newbcast:2 row_mask:0xf bank_mask:0xf
  v_dot2c_f32_bf16_dpp v29, v37, v56 row_newbcast:2 row_mask:0xf bank_mask:0xf
  v_dot2c_f32_bf16_dpp v30, v36, v57 row_newbcast:2 row_mask:0xf bank_mask:0xf
  v_dot2c_f32_bf16_dpp v31, v37, v57 row_newbcast:2 row_mask:0xf bank_mask:0xf
  v_dot2c_f32_bf16_dpp v32, v36, v58 row_newbcast:2 row_mask:0xf bank_mask:0xf
  v_dot2c_f32_bf16_dpp v33, v37, v58 row_newbcast:2 row_mask:0xf bank_mask:0xf
  v_dot2c_f32_bf16_dpp v34, v36, v59 row_newbcast:2 row_mask:0xf bank_mask:0xf
  v_dot2c_f32_bf16_dpp v35, v37, v59 row_newbcast:2 row_mask:0xf bank_mask:0xf
  s_waitcnt vmcnt(5)
  buffer_load_dwordx4 v[84:87], v3, s[16:19], s21 offen nt
  s_add_u32 s21, s21, 0x1000
  v_dot2c_f32_bf16_dpp v28, v36, v60 row_newbcast:3 row_mask:0xf bank_mask:0xf
  v_dot2c_f32_bf16_dpp v29, v37, v60 row_newbcast:3 row_mask:0xf bank_mask:0xf
  v_dot2c_f32_bf16_dpp v30, v36, v61 row_newbcast:3 row_mask:0xf bank_mask:0xf
  v_dot2c_f32_bf16_dpp v31, v37, v61 row_newbcast:3 row_mask:0xf bank_mask:0xf
  v_dot2c_f32_bf16_dpp v32, v36, v62 row_newbcast:3 row_mask:0xf bank_mask:0xf
  v_dot2c_f32_bf16_dpp v33, v37, v62 row_newbcast:3 row_mask:0xf bank_mask:0xf
  v_dot2c_f32_bf16_dpp v34, v36, v63 row_newbcast:3 row_mask:0xf bank_mask:0xf
  v_dot2c_f32_bf16_dpp v35, v37, v63 row_newbcast:3 row_mask:0xf bank_mask:0xf
  s_waitcnt vmcnt(5)
  buffer_load_dwordx4 v[88:91], v3, s[16:19], s21 offen nt
  s_add_u32 s21, s21, 0x1000
  v_dot2c_f32_bf16_dpp v28, v36, v64 row_newbcast:4 row_mask:0xf bank_mask:0xf
  v_dot2c_f32_bf16_dpp v29, v37, v64 row_newbcast:4 row_mask:0xf bank_mask:0xf
  v_dot2c_f32_bf16_dpp v30, v36, v65 row_newbcast:4 row_mask:0xf bank_mask:0xf
  v_dot2c_f32_bf16_dpp v31, v37, v65 row_newbcast:4 row_mask:0xf bank_mask:0xf
  v_dot2c_f32_bf16_dpp v32, v36, v66 row_newbcast:4 row_mask:0xf bank_mask:0xf
  v_dot2c_f32_bf16_dpp v33, v37, v66 row_newbcast:4 row_mask:0xf bank_mask:0xf
  v_dot2c_f32_bf16_dpp v34, v36, v67 row_newbcast:4 row_mask:0xf bank_mask:0xf
  v_dot2c_f32_bf16_dpp v35, v37, v67 row_newbcast:4 row_mask:0xf bank_mask:0xf
  s_waitcnt vmcnt(5)
  buffer_load_dwordx4 v[92:95], v3, s[16:19], s21 offen nt
  s_add_u32 s21, s21, 0x1000
  v_dot2c_f32_bf16_dpp v28, v36, v68 row_newbcast:5 row_mask:0xf bank_mask:0xf
  v_dot2c_f32_bf16_dpp v29, v37, v68 row_newbcast:5 row_mask:0xf bank_mask:0xf
  v_dot2c_f32_bf16_dpp v30, v36, v69 row_newbcast:5 row_mask:0xf bank_mask:0xf
  v_dot2c_f32_bf16_dpp v31, v37, v69 row_newbcast:5 row_mask:0xf bank_mask:0xf
  v_dot2c_f32_bf16_dpp v32, v36, v70 row_newbcast:5 row_mask:0xf bank_mask:0xf
  v_dot2c_f32_bf16_dpp v33, v37, v70 row_newbcast:5 row_mask:0xf bank_mask:0xf
  v_dot2c_f32_bf16_dpp v34, v36, v71 row_newbcast:5 row_mask:0xf bank_mask:0xf
  v_dot2c_f32_bf16_dpp v35, v37, v71 row_newbcast:5 row_mask:0xf bank_mask:0xf
  s_waitcnt vmcnt(5)
  buffer_load_dwordx4 v[96:99], v3, s[16:19], s21 offen nt
  s_add_u32 s21, s21, 0x1000
  v_dot2c_f32_bf16_dpp v28, v36, v72 row_newbcast:6 row_mask:0xf bank_mask:0xf
  v_dot2c_f32_bf16_dpp v29, v37, v72 row_newbcast:6 row_mask:0xf bank_mask:0xf
  v_dot2c_f32_bf16_dpp v30, v36, v73 row_newbcast:6 row_mask:0xf bank_mask:0xf
  v_dot2c_f32_bf16_dpp v31, v37, v73 row_newbcast:6 row_mask:0xf bank_mask:0xf
  v_dot2c_f32_bf16_dpp v32, v36, v74 row_newbcast:6 row_mask:0xf bank_mask:0xf
  v_dot2c_f32_bf16_dpp v33, v37, v74 row_newbcast:6 row_mask:0xf bank_mask:0xf
  v_dot2c_f32_bf16_dpp v34, v36, v75 row_newbcast:6 row_mask:0xf bank_mask:0xf
  v_dot2c_f32_bf16_dpp v35, v37, v75 row_newbcast:6 row_mask:0xf bank_mask:0xf
  s_waitcnt vmcnt(5)
  buffer_load_dwordx4 v[100:103], v3, s[16:19], s21 offen nt
  s_add_u32 s21, s21, 0x1000
  v_dot2c_f32_bf16_dpp v28, v36, v76 row_newbcast:7 row_mask:0xf bank_mask:0xf
  v_dot2c_f32_bf16_dpp v29, v37, v76 row_newbcast:7 row_mask:0xf bank_mask:0xf
  v_dot2c_f32_bf16_dpp v30, v36, v77 row_newbcast:7 row_mask:0xf bank_mask:0xf
  v_dot2c_f32_bf16_dpp v31, v37, v77 row_newbcast:7 row_mask:0xf bank_mask:0xf
  v_dot2c_f32_bf16_dpp v32, v36, v78 row_newbcast:7 row_mask:0xf bank_mask:0xf
  v_dot2c_f32_bf16_dpp v33, v37, v78 row_newbcast:7 row_mask:0xf bank_mask:0xf
  v_dot2c_f32_bf16_dpp v34, v36, v79 row_newbcast:7 row_mask:0xf bank_mask:0xf
  v_dot2c_f32_bf16_dpp v35, v37, v79 row_newbcast:7 row_mask:0xf bank_mask:0xf
  s_waitcnt vmcnt(5)
  buffer_load_dwordx4 v[104:107], v3, s[16:19], s21 offen nt
  s_add_u32 s21, s21, 0x1000
  v_dot2c_f32_bf16_dpp v28, v36, v80 row_newbcast:8 row_mask:0xf bank_mask:0xf
  v_dot2c_f32_bf16_dpp v29, v37, v80 row_newbcast:8 row_mask:0xf bank_mask:0xf
  v_dot2c_f32_bf16_dpp v30, v36, v81 row_newbcast:8 row_mask:0xf bank_mask:0xf
  v_dot2c_f32_bf16_dpp v31, v37, v81 row_newbcast:8 row_mask:0xf bank_mask:0xf
  v_dot2c_f32_bf16_dpp v32, v36, v82 row_newbcast:8 row_mask:0xf bank_mask:0xf
  v_dot2c_f32_bf16_dpp v33, v37, v82 row_newbcast:8 row_mask:0xf bank_mask:0xf
  v_dot2c_f32_bf16_dpp v34, v36, v83 row_newbcast:8 row_mask:0xf bank_mask:0xf
  v_dot2c_f32_bf16_dpp v35, v37, v83 row_newbcast:8 row_mask:0xf bank_mask:0xf
  s_waitcnt vmcnt(5)
  buffer_load_dwordx4 v[108:111], v3, s[16:19], s21 offen nt
  s_add_u32 s21, s21, 0x1000
  v_dot2c_f32_bf16_dpp v28, v36, v84 row_newbcast:9 row_mask:0xf bank_mask:0xf
  v_dot2c_f32_bf16_dpp v29, v37, v84 row_newbcast:9 row_mask:0xf bank_mask:0xf
  v_dot2c_f32_bf16_dpp v30, v36, v85 row_newbcast:9 row_mask:0xf bank_mask:0xf
  v_dot2c_f32_bf16_dpp v31, v37, v85 row_newbcast:9 row_mask:0xf bank_mask:0xf
  v_dot2c_f32_bf16_dpp v32, v36, v86 row_newbcast:9 row_mask:0xf bank_mask:0xf
  v_dot2c_f32_bf16_dpp v33, v37, v86 row_newbcast:9 row_mask:0xf bank_mask:0xf
  v_dot2c_f32_bf16_dpp v34, v36, v87 row_newbcast:9 row_mask:0xf bank_mask:0xf
  v_dot2c_f32_bf16_dpp v35, v37, v87 row_newbcast:9 row_mask:0xf bank_mask:0xf
  s_waitcnt vmcnt(5)
  buffer_load_dwordx4 v[48:51], v3, s[16:19], s21 offen nt
  s_add_u32 s21, s21, 0x1000
  v_dot2c_f32_bf16_dpp v28, v36, v88 row_newbcast:10 row_mask:0xf bank_mask:0xf
  v_dot2c_f32_bf16_dpp v29, v37, v88 row_newbcast:10 row_mask:0xf bank_mask:0xf
  v_dot2c_f32_bf16_dpp v30, v36, v89 row_newbcast:10 row_mask:0xf bank_mask:0xf
  v_dot2c_f32_bf16_dpp v31, v37, v89 row_newbcast:10 row_mask:0xf bank_mask:0xf
  v_dot2c_f32_bf16_dpp v32, v36, v90 row_newbcast:10 row_mask:0xf bank_mask:0xf
  v_dot2c_f32_bf16_dpp v33, v37, v90 row_newbcast:10 row_mask:0xf bank_mask:0xf
  v_dot2c_f32_bf16_dpp v34, v36, v91 row_newbcast:10 row_mask:0xf bank_mask:0xf
  v_dot2c_f32_bf16_dpp v35, v37, v91 row_newbcast:10 row_mask:0xf bank_mask:0xf
  s_waitcnt vmcnt(5)
  buffer_load_dwordx4 v[52:55], v3, s[16:19], s21 offen nt
  s_add_u32 s21, s21, 0x1000
  v_dot2c_f32_bf16_dpp v28, v36, v92 row_newbcast:11 row_mask:0xf bank_mask:0xf
  v_dot2c_f32_bf16_dpp v29, v37, v92 row_newbcast:11 row_mask:0xf bank_mask:0xf
  v_dot2c_f32_bf16_dpp v30, v36, v93 row_newbcast:11 row_mask:0xf bank_mask:0xf
  v_dot2c_f32_bf16_dpp v31, v37, v93 row_newbcast:11 row_mask:0xf bank_mask:0xf
  v_dot2c_f32_bf16_dpp v32, v36, v94 row_newbcast:11 row_mask:0xf bank_mask:0xf
  v_dot2c_f32_bf16_dpp v33, v37, v94 row_newbcast:11 row_mask:0xf bank_mask:0xf
  v_dot2c_f32_bf16_dpp v34, v36, v95 row_newbcast:11 row_mask:0xf bank_mask:0xf
  v_dot2c_f32_bf16_dpp v35, v37, v95 row_newbcast:11 row_mask:0xf bank_mask:0xf
  s_waitcnt vmcnt(5)
  buffer_load_dwordx4 v[56:59], v3, s[16:19], s21 offen nt
  s_add_u32 s21, s21, 0x1000
  v_dot2c_f32_bf16_dpp v28, v36, v96 row_newbcast:12 row_mask:0xf bank_mask:0xf
  v_dot2c_f32_bf16_dpp v29, v37, v96 row_newbcast:12 row_mask:0xf bank_mask:0xf
  v_dot2c_f32_bf16_dpp v30, v36, v97 row_newbcast:12 row_mask:0xf bank_mask:0xf
  v_dot2c_f32_bf16_dpp v31, v37, v97 row_newbcast:12 row_mask:0xf bank_mask:0xf
  v_dot2c_f32_bf16_dpp v32, v36, v98 row_newbcast:12 row_mask:0xf bank_mask:0xf
  v_dot2c_f32_bf16_dpp v33, v37, v98 row_newbcast:12 row_mask:0xf bank_mask:0xf
  v_dot2c_f32_bf16_dpp v34, v36, v99 row_newbcast:12 row_mask:0xf bank_mask:0xf
  v_dot2c_f32_bf16_dpp v35, v37, v99 row_newbcast:12 row_mask:0xf bank_mask:0xf
  s_waitcnt vmcnt(5)
  buffer_load_dwordx4 v[60:63], v3, s[16:19], s21 offen nt
  s_add_u32 s21, s21, 0x1000
  ds_read_b32 v47, v44 offset:22784
  v_dot2c_f32_bf16_dpp v28, v36, v100 row_newbcast:13 row_mask:0xf bank_mask:0xf
  v_dot2c_f32_bf16_dpp v29, v37, v100 row_newbcast:13 row_mask:0xf bank_mask:0xf
  v_dot2c_f32_bf16_dpp v30, v36, v101 row_newbcast:13 row_mask:0xf bank_mask:0xf
  v_dot2c_f32_bf16_dpp v31, v37, v101 row_newbcast:13 row_mask:0xf bank_mask:0xf
  v_dot2c_f32_bf16_dpp v32, v36, v102 row_newbcast:13 row_mask:0xf bank_mask:0xf
  v_dot2c_f32_bf16_dpp v33, v37, v102 row_newbcast:13 row_mask:0xf bank_mask:0xf
  v_dot2c_f32_bf16_dpp v34, v36, v103 row_newbcast:13 row_mask:0xf bank_mask:0xf
  v_dot2c_f32_bf16_dpp v35, v37, v103 row_newbcast:13 row_mask:0xf bank_mask:0xf
  s_waitcnt vmcnt(5)
  buffer_load_dwordx4 v[64:67], v3, s[16:19], s21 offen nt
  s_add_u32 s21, s21, 0x1000
  v_dot2c_f32_bf16_dpp v28, v36, v104 row_newbcast:14 row_mask:0xf bank_mask:0xf
  v_dot2c_f32_bf16_dpp v29, v37, v104 row_newbcast:14 row_mask:0xf bank_mask:0xf
  v_dot2c_f32_bf16_dpp v30, v36, v105 row_newbcast:14 row_mask:0xf bank_mask:0xf
  v_dot2c_f32_bf16_dpp v31, v37, v105 row_newbcast:14 row_mask:0xf bank_mask:0xf
  v_dot2c_f32_bf16_dpp v32, v36, v106 row_newbcast:14 row_mask:0xf bank_mask:0xf
  v_dot2c_f32_bf16_dpp v33, v37, v106 row_newbcast:14 row_mask:0xf bank_mask:0xf
  v_dot2c_f32_bf16_dpp v34, v36, v107 row_newbcast:14 row_mask:0xf bank_mask:0xf
  v_dot2c_f32_bf16_dpp v35, v37, v107 row_newbcast:14 row_mask:0xf bank_mask:0xf
  s_waitcnt vmcnt(5)
  buffer_load_dwordx4 v[68:71], v3, s[16:19], s21 offen nt
  s_add_u32 s21, s21, 0x1000
  v_dot2c_f32_bf16_dpp v28, v36, v108 row_newbcast:15 row_mask:0xf bank_mask:0xf
  v_dot2c_f32_bf16_dpp v29, v37, v108 row_newbcast:15 row_mask:0xf bank_mask:0xf
  v_dot2c_f32_bf16_dpp v30, v36, v109 row_newbcast:15 row_mask:0xf bank_mask:0xf
  v_dot2c_f32_bf16_dpp v31, v37, v109 row_newbcast:15 row_mask:0xf bank_mask:0xf
  v_dot2c_f32_bf16_dpp v32, v36, v110 row_newbcast:15 row_mask:0xf bank_mask:0xf
  v_dot2c_f32_bf16_dpp v33, v37, v110 row_newbcast:15 row_mask:0xf bank_mask:0xf
  v_dot2c_f32_bf16_dpp v34, v36, v111 row_newbcast:15 row_mask:0xf bank_mask:0xf
  v_dot2c_f32_bf16_dpp v35, v37, v111 row_newbcast:15 row_mask:0xf bank_mask:0xf
  s_waitcnt lgkmcnt(0)
  v_mov_b32 v36, v38
  v_lshlrev_b32 v37, 16, v38
  s_sub_u32 s22, s22, 1
  s_cmp_lg_u32 s22, 0
  s_cbranch_scc1 L_vhi
  s_branch L_vxh
L_vdn:
  s_waitcnt vmcnt(5)
  v_dot2c_f32_bf16_dpp v28, v36, v48 row_newbcast:0 row_mask:0xf bank_mask:0xf
  v_dot2c_f32_bf16_dpp v29, v37, v48 row_newbcast:0 row_mask:0xf bank_mask:0xf
  v_dot2c_f32_bf16_dpp v30, v36, v49 row_newbcast:0 row_mask:0xf bank_mask:0xf
  v_dot2c_f32_bf16_dpp v31, v37, v49 row_newbcast:0 row_mask:0xf bank_mask:0xf
  v_dot2c_f32_bf16_dpp v32, v36, v50 row_newbcast:0 row_mask:0xf bank_mask:0xf
  v_dot2c_f32_bf16_dpp v33, v37, v50 row_newbcast:0 row_mask:0xf bank_mask:0xf
  v_dot2c_f32_bf16_dpp v34, v36, v51 row_newbcast:0 row_mask:0xf bank_mask:0xf
  v_dot2c_f32_bf16_dpp v35, v37, v51 row_newbcast:0 row_mask:0xf bank_mask:0xf
  s_branch L_vlo_k
L_vxh:
  s_waitcnt vmcnt(5)
  buffer_load_dwordx4 v[72:75], v3, s[16:19], s21 offen nt
  s_add_u32 s21, s21, 0x1000
  buffer_load_dwordx4 v[76:79], v3, s[16:19], s21 offen nt
  s_add_u32 s21, s21, 0x1000
  buffer_load_dwordx4 v[80:83], v3, s[16:19], s21 offen nt
  s_add_u32 s21, s21, 0x1000
  buffer_load_dwordx4 v[84:87], v3, s[16:19], s21 offen nt
  s_add_u32 s21, s21, 0x1000
  buffer_load_dwordx4 v[88:91], v3, s[16:19], s21 offen nt
  s_add_u32 s21, s21, 0x1000
  v_dot2c_f32_bf16_dpp v28, v36, v48 row_newbcast:0 row_mask:0xf bank_mask:0xf
  v_dot2c_f32_bf16_dpp v29, v37, v48 row_newbcast:0 row_mask:0xf bank_mask:0xf
  v_dot2c_f32_bf16_dpp v30, v36, v49 row_newbcast:0 row_mask:0xf bank_mask:0xf
  v_dot2c_f32_bf16_dpp v31, v37, v49 row_newbcast:0 row_mask:0xf bank_mask:0xf
  v_dot2c_f32_bf16_dpp v32, v36, v50 row_newbcast:0 row_mask:0xf bank_mask:0xf
  v_dot2c_f32_bf16_dpp v33, v37, v50 row_newbcast:0 row_mask:0xf bank_mask:0xf
  v_dot2c_f32_bf16_dpp v34, v36, v51 row_newbcast:0 row_mask:0xf bank_mask:0xf
  v_dot2c_f32_bf16_dpp v35, v37, v51 row_newbcast:0 row_mask:0xf bank_mask:0xf
  s_branch L_v15_k
L_vx:
  s_waitcnt vmcnt(4)
  buffer_load_dwordx4 v[68:71], v3, s[16:19], s21 offen nt
  s_add_u32 s21, s21, 0x1000
  buffer_load_dwordx4 v[72:75], v3, s[16:19], s21 offen nt
  s_add_u32 s21, s21, 0x1000
  buffer_load_dwordx4 v[76:79], v3, s[16:19], s21 offen nt
  s_add_u32 s21, s21, 0x1000
  buffer_load_dwordx4 v[80:83], v3, s[16:19], s21 offen nt
  s_add_u32 s21, s21, 0x1000
  buffer_load_dwordx4 v[84:87], v3, s[16:19], s21 offen nt
  s_add_u32 s21, s21, 0x1000
  buffer_load_dwordx4 v[88:91], v3, s[16:19], s21 offen nt
  s_add_u32 s21, s21, 0x1000
  v_dot2c_f32_bf16_dpp v28, v36, v48 row_newbcast:0 row_mask:0xf bank_mask:0xf
  v_dot2c_f32_bf16_dpp v29, v37, v48 row_newbcast:0 row_mask:0xf bank_mask:0xf
  v_dot2c_f32_bf16_dpp v30, v36, v49 row_newbcast:0 row_mask:0xf bank_mask:0xf
  v_dot2c_f32_bf16_dpp v31, v37, v49 row_newbcast:0 row_mask:0xf bank_mask:0xf
  v_dot2c_f32_bf16_dpp v32, v36, v50 row_newbcast:0 row_mask:0xf bank_mask:0xf
  v_dot2c_f32_bf16_dpp v33, v37, v50 row_newbcast:0 row_mask:0xf bank_mask:0xf
  v_dot2c_f32_bf16_dpp v34, v36, v51 row_newbcast:0 row_mask:0xf bank_mask:0xf
  v_dot2c_f32_bf16_dpp v35, v37, v51 row_newbcast:0 row_mask:0xf bank_mask:0xf
L_v15_k:
  s_waitcnt vmcnt(9)
  buffer_load_dwordx4 v[92:95], v3, s[16:19], s21 offen nt
  s_add_u32 s21, s21, 0x1000
  v_dot2c_f32_bf16_dpp v28, v36, v52 row_newbcast:1 row_mask:0xf bank_mask:0xf
  v_dot2c_f32_bf16_dpp v29, v37, v52 row_newbcast:1 row_mask:0xf bank_mask:0xf
  v_dot2c_f32_bf16_dpp v30, v36, v53 row_newbcast:1 row_mask:0xf bank_mask:0xf
  v_dot2c_f32_bf16_dpp v31, v37, v53 row_newbcast:1 row_mask:0xf bank_mask:0xf
  v_dot2c_f32_bf16_dpp v32, v36, v54 row_newbcast:1 row_mask:0xf bank_mask:0xf
  v_dot2c_f32_bf16_dpp v33, v37, v54 row_newbcast:1 row_mask:0xf bank_mask:0xf
  v_dot2c_f32_bf16_dpp v34, v36, v55 row_newbcast:1 row_mask:0xf bank_mask:0xf
  v_dot2c_f32_bf16_dpp v35, v37, v55 row_newbcast:1 row_mask:0xf bank_mask:0xf
  s_waitcnt vmcnt(9)
  buffer_load_dwordx4 v[96:99], v3, s[16:19], s21 offen nt
  s_add_u32 s21, s21, 0x1000
  v_dot2c_f32_bf16_dpp v28, v36, v56 row_newbcast:2 row_mask:0xf bank_mask:0xf
  v_dot2c_f32_bf16_dpp v29, v37, v56 row_newbcast:2 row_mask:0xf bank_mask:0xf
  v_dot2c_f32_bf16_dpp v30, v36, v57 row_newbcast:2 row_mask:0xf bank_mask:0xf
  v_dot2c_f32_bf16_dpp v31, v37, v57 row_newbcast:2 row_mask:0xf bank_mask:0xf
  v_dot2c_f32_bf16_dpp v32, v36, v58 row_newbcast:2 row_mask:0xf bank_mask:0xf
  v_dot2c_f32_bf16_dpp v33, v37, v58 row_newbcast:2 row_mask:0xf bank_mask:0xf
  v_dot2c_f32_bf16_dpp v34, v36, v59 row_newbcast:2 row_mask:0xf bank_mask:0xf
  v_dot2c_f32_bf16_dpp v35, v37, v59 row_newbcast:2 row_mask:0xf bank_mask:0xf
  s_waitcnt vmcnt(9)
  buffer_load_dwordx4 v[100:103], v3, s[16:19], s21 offen nt
  s_add_u32 s21, s21, 0x1000
  v_dot2c_f32_bf16_dpp v28, v36, v60 row_newbcast:3 row_mask:0xf bank_mask:0xf
  v_dot2c_f32_bf16_dpp v29, v37, v60 row_newbcast:3 row_mask:0xf bank_mask:0xf
  v_dot2c_f32_bf16_dpp v30, v36, v61 row_newbcast:3 row_mask:0xf bank_mask:0xf
  v_dot2c_f32_bf16_dpp v31, v37, v61 row_newbcast:3 row_mask:0xf bank_mask:0xf
  v_dot2c_f32_bf16_dpp v32, v36, v62 row_newbcast:3 row_mask:0xf bank_mask:0xf
  v_dot2c_f32_bf16_dpp v33, v37, v62 row_newbcast:3 row_mask:0xf bank_mask:0xf
  v_dot2c_f32_bf16_dpp v34, v36, v63 row_newbcast:3 row_mask:0xf bank_mask:0xf
  v_dot2c_f32_bf16_dpp v35, v37, v63 row_newbcast:3 row_mask:0xf bank_mask:0xf
  s_waitcnt vmcnt(9)
  buffer_load_dwordx4 v[104:107], v3, s[16:19], s21 offen nt
  s_add_u32 s21, s21, 0x1000
  v_dot2c_f32_bf16_dpp v28, v36, v64 row_newbcast:4 row_mask:0xf bank_mask:0xf
  v_dot2c_f32_bf16_dpp v29, v37, v64 row_newbcast:4 row_mask:0xf bank_mask:0xf
  v_dot2c_f32_bf16_dpp v30, v36, v65 row_newbcast:4 row_mask:0xf bank_mask:0xf
  v_dot2c_f32_bf16_dpp v31, v37, v65 row_newbcast:4 row_mask:0xf bank_mask:0xf
  v_dot2c_f32_bf16_dpp v32, v36, v66 row_newbcast:4 row_mask:0xf bank_mask:0xf
  v_dot2c_f32_bf16_dpp v33, v37, v66 row_newbcast:4 row_mask:0xf bank_mask:0xf
  v_dot2c_f32_bf16_dpp v34, v36, v67 row_newbcast:4 row_mask:0xf bank_mask:0xf
  v_dot2c_f32_bf16_dpp v35, v37, v67 row_newbcast:4 row_mask:0xf bank_mask:0xf
  s_waitcnt vmcnt(9)
  buffer_load_dwordx4 v[108:111], v3, s[16:19], s21 offen nt
  s_add_u32 s21, s21, 0x1000
  v_dot2c_f32_bf16_dpp v28, v36, v68 row_newbcast:5 row_mask:0xf bank_mask:0xf
  v_dot2c_f32_bf16_dpp v29, v37, v68 row_newbcast:5 row_mask:0xf bank_mask:0xf
  v_dot2c_f32_bf16_dpp v30, v36, v69 row_newbcast:5 row_mask:0xf bank_mask:0xf
  v_dot2c_f32_bf16_dpp v31, v37, v69 row_newbcast:5 row_mask:0xf bank_mask:0xf
  v_dot2c_f32_bf16_dpp v32, v36, v70 row_newbcast:5 row_mask:0xf bank_mask:0xf
  v_dot2c_f32_bf16_dpp v33, v37, v70 row_newbcast:5 row_mask:0xf bank_mask:0xf
  v_dot2c_f32_bf16_dpp v34, v36, v71 row_newbcast:5 row_mask:0xf bank_mask:0xf
  v_dot2c_f32_bf16_dpp v35, v37, v71 row_newbcast:5 row_mask:0xf bank_mask:0xf
  s_waitcnt vmcnt(9)
  v_dot2c_f32_bf16_dpp v28, v36, v72 row_newbcast:6 row_mask:0xf bank_mask:0xf
  v_dot2c_f32_bf16_dpp v29, v37, v72 row_newbcast:6 row_mask:0xf bank_mask:0xf
  v_dot2c_f32_bf16_dpp v30, v36, v73 row_newbcast:6 row_mask:0xf bank_mask:0xf
  v_dot2c_f32_bf16_dpp v31, v37, v73 row_newbcast:6 row_mask:0xf bank_mask:0xf
  v_dot2c_f32_bf16_dpp v32, v36, v74 row_newbcast:6 row_mask:0xf bank_mask:0xf
  v_dot2c_f32_bf16_dpp v33, v37, v74 row_newbcast:6 row_mask:0xf bank_mask:0xf
  v_dot2c_f32_bf16_dpp v34, v36, v75 row_newbcast:6 row_mask:0xf bank_mask:0xf
  v_dot2c_f32_bf16_dpp v35, v37, v75 row_newbcast:6 row_mask:0xf bank_mask:0xf
  s_waitcnt vmcnt(8)
  v_dot2c_f32_bf16_dpp v28, v36, v76 row_newbcast:7 row_mask:0xf bank_mask:0xf
  v_dot2c_f32_bf16_dpp v29, v37, v76 row_newbcast:7 row_mask:0xf bank_mask:0xf
  v_dot2c_f32_bf16_dpp v30, v36, v77 row_newbcast:7 row_mask:0xf bank_mask:0xf
  v_dot2c_f32_bf16_dpp v31, v37, v77 row_newbcast:7 row_mask:0xf bank_mask:0xf
  v_dot2c_f32_bf16_dpp v32, v36, v78 row_newbcast:7 row_mask:0xf bank_mask:0xf
  v_dot2c_f32_bf16_dpp v33, v37, v78 row_newbcast:7 row_mask:0xf bank_mask:0xf
  v_dot2c_f32_bf16_dpp v34, v36, v79 row_newbcast:7 row_mask:0xf bank_mask:0xf
  v_dot2c_f32_bf16_dpp v35, v37, v79 row_newbcast:7 row_mask:0xf bank_mask:0xf
  s_waitcnt vmcnt(7)
  v_dot2c_f32_bf16_dpp v28, v36, v80 row_newbcast:8 row_mask:0xf bank_mask:0xf
  v_dot2c_f32_bf16_dpp v29, v37, v80 row_newbcast:8 row_mask:0xf bank_mask:0xf
  v_dot2c_f32_bf16_dpp v30, v36, v81 row_newbcast:8 row_mask:0xf bank_mask:0xf
  v_dot2c_f32_bf16_dpp v31, v37, v81 row_newbcast:8 row_mask:0xf bank_mask:0xf
  v_dot2c_f32_bf16_dpp v32, v36, v82 row_newbcast:8 row_mask:0xf bank_mask:0xf
  v_dot2c_f32_bf16_dpp v33, v37, v82 row_newbcast:8 row_mask:0xf bank_mask:0xf
  v_dot2c_f32_bf16_dpp v34, v36, v83 row_newbcast:8 row_mask:0xf bank_mask:0xf
  v_dot2c_f32_bf16_dpp v35, v37, v83 row_newbcast:8 row_mask:0xf bank_mask:0xf
  s_waitcnt vmcnt(6)
  v_dot2c_f32_bf16_dpp v28, v36, v84 row_newbcast:9 row_mask:0xf bank_mask:0xf
  v_dot2c_f32_bf16_dpp v29, v37, v84 row_newbcast:9 row_mask:0xf bank_mask:0xf
  v_dot2c_f32_bf16_dpp v30, v36, v85 row_newbcast:9 row_mask:0xf bank_mask:0xf
  v_dot2c_f32_bf16_dpp v31, v37, v85 row_newbcast:9 row_mask:0xf bank_mask:0xf
  v_dot2c_f32_bf16_dpp v32, v36, v86 row_newbcast:9 row_mask:0xf bank_mask:0xf
  v_dot2c_f32_bf16_dpp v33, v37, v86 row_newbcast:9 row_mask:0xf bank_mask:0xf
  v_dot2c_f32_bf16_dpp v34, v36, v87 row_newbcast:9 row_mask:0xf bank_mask:0xf
  v_dot2c_f32_bf16_dpp v35, v37, v87 row_newbcast:9 row_mask:0xf bank_mask:0xf
  s_waitcnt vmcnt(5)
  v_dot2c_f32_bf16_dpp v28, v36, v88 row_newbcast:10 row_mask:0xf bank_mask:0xf
  v_dot2c_f32_bf16_dpp v29, v37, v88 row_newbcast:10 row_mask:0xf bank_mask:0xf
  v_dot2c_f32_bf16_dpp v30, v36, v89 row_newbcast:10 row_mask:0xf bank_mask:0xf
  v_dot2c_f32_bf16_dpp v31, v37, v89 row_newbcast:10 row_mask:0xf bank_mask:0xf
  v_dot2c_f32_bf16_dpp v32, v36, v90 row_newbcast:10 row_mask:0xf bank_mask:0xf
  v_dot2c_f32_bf16_dpp v33, v37, v90 row_newbcast:10 row_mask:0xf bank_mask:0xf
  v_dot2c_f32_bf16_dpp v34, v36, v91 row_newbcast:10 row_mask:0xf bank_mask:0xf
  v_dot2c_f32_bf16_dpp v35, v37, v91 row_newbcast:10 row_mask:0xf bank_mask:0xf
  s_waitcnt vmcnt(4)
  v_dot2c_f32_bf16_dpp v28, v36, v92 row_newbcast:11 row_mask:0xf bank_mask:0xf
  v_dot2c_f32_bf16_dpp v29, v37, v92 row_newbcast:11 row_mask:0xf bank_mask:0xf
  v_dot2c_f32_bf16_dpp v30, v36, v93 row_newbcast:11 row_mask:0xf bank_mask:0xf
  v_dot2c_f32_bf16_dpp v31, v37, v93 row_newbcast:11 row_mask:0xf bank_mask:0xf
  v_dot2c_f32_bf16_dpp v32, v36, v94 row_newbcast:11 row_mask:0xf bank_mask:0xf
  v_dot2c_f32_bf16_dpp v33, v37, v94 row_newbcast:11 row_mask:0xf bank_mask:0xf
  v_dot2c_f32_bf16_dpp v34, v36, v95 row_newbcast:11 row_mask:0xf bank_mask:0xf
  v_dot2c_f32_bf16_dpp v35, v37, v95 row_newbcast:11 row_mask:0xf bank_mask:0xf
  s_waitcnt vmcnt(3)
  v_dot2c_f32_bf16_dpp v28, v36, v96 row_newbcast:12 row_mask:0xf bank_mask:0xf
  v_dot2c_f32_bf16_dpp v29, v37, v96 row_newbcast:12 row_mask:0xf bank_mask:0xf
  v_dot2c_f32_bf16_dpp v30, v36, v97 row_newbcast:12 row_mask:0xf bank_mask:0xf
  v_dot2c_f32_bf16_dpp v31, v37, v97 row_newbcast:12 row_mask:0xf bank_mask:0xf
  v_dot2c_f32_bf16_dpp v32, v36, v98 row_newbcast:12 row_mask:0xf bank_mask:0xf
  v_dot2c_f32_bf16_dpp v33, v37, v98 row_newbcast:12 row_mask:0xf bank_mask:0xf
  v_dot2c_f32_bf16_dpp v34, v36, v99 row_newbcast:12 row_mask:0xf bank_mask:0xf
  v_dot2c_f32_bf16_dpp v35, v37, v99 row_newbcast:12 row_mask:0xf bank_mask:0xf
  s_waitcnt vmcnt(2)
  v_dot2c_f32_bf16_dpp v28, v36, v100 row_newbcast:13 row_mask:0xf bank_mask:0xf
  v_dot2c_f32_bf16_dpp v29, v37, v100 row_newbcast:13 row_mask:0xf bank_mask:0xf
  v_dot2c_f32_bf16_dpp v30, v36, v101 row_newbcast:13 row_mask:0xf bank_mask:0xf
  v_dot2c_f32_bf16_dpp v31, v37, v101 row_newbcast:13 row_mask:0xf bank_mask:0xf
  v_dot2c_f32_bf16_dpp v32, v36, v102 row_newbcast:13 row_mask:0xf bank_mask:0xf
  v_dot2c_f32_bf16_dpp v33, v37, v102 row_newbcast:13 row_mask:0xf bank_mask:0xf
  v_dot2c_f32_bf16_dpp v34, v36, v103 row_newbcast:13 row_mask:0xf bank_mask:0xf
  v_dot2c_f32_bf16_dpp v35, v37, v103 row_newbcast:13 row_mask:0xf bank_mask:0xf
  s_waitcnt vmcnt(1)
  v_dot2c_f32_bf16_dpp v28, v36, v104 row_newbcast:14 row_mask:0xf bank_mask:0xf
  v_dot2c_f32_bf16_dpp v29, v37, v104 row_newbcast:14 row_mask:0xf bank_mask:0xf
  v_dot2c_f32_bf16_dpp v30, v36, v105 row_newbcast:14 row_mask:0xf bank_mask:0xf
  v_dot2c_f32_bf16_dpp v31, v37, v105 row_newbcast:14 row_mask:0xf bank_mask:0xf
  v_dot2c_f32_bf16_dpp v32, v36, v106 row_newbcast:14 row_mask:0xf bank_mask:0xf
  v_dot2c_f32_bf16_dpp v33, v37, v106 row_newbcast:14 row_mask:0xf bank_mask:0xf
  v_dot2c_f32_bf16_dpp v34, v36, v107 row_newbcast:14 row_mask:0xf bank_mask:0xf
  v_dot2c_f32_bf16_dpp v35, v37, v107 row_newbcast:14 row_mask:0xf bank_mask:0xf
  s_waitcnt vmcnt(0)
  v_dot2c_f32_bf16_dpp v28, v36, v108 row_newbcast:15 row_mask:0xf bank_mask:0xf
  v_dot2c_f32_bf16_dpp v29, v37, v108 row_newbcast:15 row_mask:0xf bank_mask:0xf
  v_dot2c_f32_bf16_dpp v30, v36, v109 row_newbcast:15 row_mask:0xf bank_mask:0xf
  v_dot2c_f32_bf16_dpp v31, v37, v109 row_newbcast:15 row_mask:0xf bank_mask:0xf
  v_dot2c_f32_bf16_dpp v32, v36, v110 row_newbcast:15 row_mask:0xf bank_mask:0xf
  v_dot2c_f32_bf16_dpp v33, v37, v110 row_newbcast:15 row_mask:0xf bank_mask:0xf
  v_dot2c_f32_bf16_dpp v34, v36, v111 row_newbcast:15 row_mask:0xf bank_mask:0xf
  v_dot2c_f32_bf16_dpp v35, v37, v111 row_newbcast:15 row_mask:0xf bank_mask:0xf
  v_lshrrev_b32 v1, 4, v2
  v_and_b32 v7, 15, v2
  v_lshlrev_b32 v1, 3, v1
  v_lshl_add_u32 v1, v7, 5, v1
  s_lshl_b32 s30, s3, 9
  v_add_u32 v1, s30, v1
  v_permlane32_swap_b32 v28, v32
  v_permlane32_swap_b32 v29, v33
  v_permlane32_swap_b32 v30, v34
  v_permlane32_swap_b32 v31, v35
  v_add_f32 v28, v28, v32
  v_add_f32 v29, v29, v33
  v_add_f32 v30, v30, v34
  v_add_f32 v31, v31, v35
  s_nop 0
  v_permlane16_swap_b32 v28, v30
  v_permlane16_swap_b32 v29, v31
  v_add_f32 v28, v28, v30
  v_add_f32 v29, v29, v31
  ds_write_b64 v1, v[28:29] offset:18432
  s_waitcnt lgkmcnt(0)
  s_barrier
  s_endpgm
L_helper:
  s_load_dwordx2 s[44:45], s[0:1], 0
  s_load_dwordx2 s[46:47], s[0:1], 24
  s_load_dwordx2 s[50:51], s[0:1], 88
  s_sub_u32 s63, s3, 4
  s_cmp_eq_u32 s63, 3
  s_cbranch_scc0 L_nopf_1
  s_getpc_b64 s[90:91]
L_pc_ref:
  s_sub_u32 s90, s90, L_pc_ref-recurrent_scan__mha_block_cached__geglu_ffn__decode_kernel
  s_subb_u32 s91, s91, 0
  s_lshr_b32 s84, s2, 3
  s_lshl_b32 s84, s84, 10
  v_lshlrev_b32 v10, 4, v2
  v_add_u32 v10, s84, v10
  v_min_u32 v13, L_code_end-recurrent_scan__mha_block_cached__geglu_ffn__decode_kernel-16, v10
  global_load_dwordx4 v[196:199], v13, s[90:91]
  v_add_u32 v10, 0x8000, v10
  v_min_u32 v13, L_code_end-recurrent_scan__mha_block_cached__geglu_ffn__decode_kernel-16, v10
  global_load_dwordx4 v[196:199], v13, s[90:91]
  v_add_u32 v10, 0x8000, v10
L_nopf_1:
  s_and_b32 s61, s2, 7
  s_bfe_u32 s84, s2, 0x20003
  s_lshl_b32 s84, s84, 3
  s_add_u32 s61, s61, s84
  s_lshr_b32 s62, s2, 6
  s_and_b32 s4, s2, 7
  s_lshl_b32 s4, s4, 3
  s_bfe_u32 s84, s2, 0x30003
  s_add_u32 s4, s4, s84
  s_and_b32 s5, s2, 7
  s_mul_i32 s5, s5, 6
  s_add_u32 s5, s5, s84
  s_cmp_ge_u32 s84, 6
  s_cselect_b32 s5, 63, s5
  s_and_b32 s84, s84, 3
  s_cmp_lg_u32 s84, s62
  s_cselect_b32 s5, 63, s5
  v_lshrrev_b32 v3, 4, v2
  v_and_b32 v4, 15, v2
  s_lshl_b32 s85, s62, 10
  v_lshlrev_b32 v5, 4, v2
  v_add_u32 v5, s85, v5
  s_lshl_b32 s86, s63, 7
  v_lshl_add_u32 v6, v4, 2, v3
  v_add_u32 v6, s86, v6
  v_lshlrev_b32 v7, 1, v6
  v_add_u32 v7, s85, v7
  v_add_u32 v8, s86, v3
  v_lshlrev_b32 v8, 13, v8
  s_lshl_b32 s87, s61, 8
  v_lshl_add_u32 v10, v4, 4, s87
  v_add_u32 v8, v8, v10
  s_lshl_b32 s89, s62, 7
  s_add_u32 s89, s89, 983040
  s_waitcnt lgkmcnt(0)
  s_load_dword s6, s[50:51], s89
  s_mov_b32 s12, s44
  s_mov_b32 s13, s45
  s_mov_b32 s14, 4096
  s_mov_b32 s15, 0x20000
  s_mov_b32 s16, s46
  s_mov_b32 s17, s47
  s_mov_b32 s18, 4194304
  s_mov_b32 s19, 0x20000
  buffer_load_dwordx4 v[24:27], v5, s[12:15], 0 offen
  buffer_load_ushort v28, v7, s[12:15], 0 offen
  buffer_load_ushort v29, v7, s[12:15], 0 offen offset:128
  s_mov_b32 s88, 0
  buffer_load_dwordx4 v[64:67], v8, s[16:19], s88 offen
  s_add_u32 s88, s88, 0x8000
  buffer_load_dwordx4 v[68:71], v8, s[16:19], s88 offen
  s_add_u32 s88, s88, 0x8000
  buffer_load_dwordx4 v[72:75], v8, s[16:19], s88 offen
  s_add_u32 s88, s88, 0x8000
  s_mov_b32 s40, s50
  s_mov_b32 s41, s51
  s_mov_b32 s42, 1310720
  s_mov_b32 s43, 0x20000
  v_mov_b32 v12, 0
  s_cmp_lt_u32 s5, 43
  s_cselect_b32 s84, 1344, 0
  v_mov_b32 v15, s84
  v_lshlrev_b32 v13, 2, v2
  s_mov_b64 exec, 15
  ds_write_b32 v13, v12 offset:22560
  ds_write_b32 v13, v12 offset:22576
  ds_write_b32 v13, v15 offset:22784
  s_mov_b64 exec, -1
  s_waitcnt vmcnt(3)
  v_lshlrev_b32 v36, 16, v24
  v_and_b32 v37, 0xffff0000, v24
  v_lshlrev_b32 v38, 16, v25
  v_and_b32 v39, 0xffff0000, v25
  v_lshlrev_b32 v40, 16, v26
  v_and_b32 v41, 0xffff0000, v26
  v_lshlrev_b32 v42, 16, v27
  v_and_b32 v43, 0xffff0000, v27
  v_add_f32 v44, v36, v37
  v_add_f32 v44, v44, v38
  v_add_f32 v44, v44, v39
  v_add_f32 v44, v44, v40
  v_add_f32 v44, v44, v41
  v_add_f32 v44, v44, v42
  v_add_f32 v44, v44, v43
  s_nop 1
  v_add_f32_dpp v44, v44, v44 row_ror:8 row_mask:0xf bank_mask:0xf
  s_nop 1
  v_add_f32_dpp v44, v44, v44 row_ror:4 row_mask:0xf bank_mask:0xf
  s_nop 1
  v_add_f32_dpp v44, v44, v44 row_ror:2 row_mask:0xf bank_mask:0xf
  s_nop 1
  v_add_f32_dpp v44, v44, v44 row_ror:1 row_mask:0xf bank_mask:0xf
  v_mov_b32 v45, v44
  s_nop 1
  v_permlane16_swap_b32 v44, v45
  v_add_f32 v44, v44, v45
  v_mov_b32 v45, v44
  s_nop 1
  v_permlane32_swap_b32 v44, v45
  v_add_f32 v44, v44, v45
  v_mul_f32 v44, 0x3b000000, v44
  v_sub_f32 v36, v36, v44
  v_sub_f32 v37, v37, v44
  v_sub_f32 v38, v38, v44
  v_sub_f32 v39, v39, v44
  v_sub_f32 v40, v40, v44
  v_sub_f32 v41, v41, v44
  v_sub_f32 v42, v42, v44
  v_sub_f32 v43, v43, v44
  v_mul_f32 v46, v36, v36
  v_fmac_f32 v46, v37, v37
  v_fmac_f32 v46, v38, v38
  v_fmac_f32 v46, v39, v39
  v_fmac_f32 v46, v40, v40
  v_fmac_f32 v46, v41, v41
  v_fmac_f32 v46, v42, v42
  v_fmac_f32 v46, v43, v43
  s_nop 1
  v_add_f32_dpp v46, v46, v46 row_ror:8 row_mask:0xf bank_mask:0xf
  s_nop 1
  v_add_f32_dpp v46, v46, v46 row_ror:4 row_mask:0xf bank_mask:0xf
  s_nop 1
  v_add_f32_dpp v46, v46, v46 row_ror:2 row_mask:0xf bank_mask:0xf
  s_nop 1
  v_add_f32_dpp v46, v46, v46 row_ror:1 row_mask:0xf bank_mask:0xf
  v_mov_b32 v45, v46
  s_nop 1
  v_permlane16_swap_b32 v46, v45
  v_add_f32 v46, v46, v45
  v_mov_b32 v45, v46
  s_nop 1
  v_permlane32_swap_b32 v46, v45
  v_add_f32 v46, v46, v45
  v_mul_f32 v46, 0x3b000000, v46
  v_cvt_pk_bf16_f32 v44, v44, v44
  v_and_b32 v44, 0xffff0000, v44
  v_cvt_pk_bf16_f32 v46, v46, v46
  v_and_b32 v46, 0xffff0000, v46
  v_add_f32 v46, 0x3727c5ac, v46
  v_cvt_pk_bf16_f32 v46, v46, v46
  v_and_b32 v46, 0xffff0000, v46
  v_sqrt_f32 v47, v46
  s_nop 0
  v_rcp_f32 v45, v47
  v_fma_f32 v48, -v47, v47, v46
  v_mul_f32 v45, 0.5, v45
  v_fmac_f32 v47, v48, v45
  v_cvt_pk_bf16_f32 v47, v47, v47
  v_and_b32 v47, 0xffff0000, v47
  v_rcp_f32 v45, v47
  v_lshlrev_b32 v28, 16, v28
  v_sub_f32 v28, v28, v44
  v_cvt_pk_bf16_f32 v28, v28, v28
  v_and_b32 v28, 0xffff0000, v28
  v_mul_f32 v48, v28, v45
  v_fma_f32 v49, -v48, v47, v28
  v_fmac_f32 v48, v49, v45
  v_cvt_pk_bf16_f32 v28, v48, 0
  v_lshlrev_b32 v29, 16, v29
  v_sub_f32 v29, v29, v44
  v_cvt_pk_bf16_f32 v29, v29, v29
  v_and_b32 v29, 0xffff0000, v29
  v_mul_f32 v48, v29, v45
  v_fma_f32 v49, -v48, v47, v29
  v_fmac_f32 v48, v49, v45
  v_cvt_pk_bf16_f32 v29, v48, 0
  v_lshlrev_b32 v30, 16, v28
  v_lshlrev_b32 v31, 16, v29
  v_lshlrev_b32 v10, 2, v6
  ds_write_b32 v10, v28 offset:20480
  ds_write_b32 v10, v29 offset:20736
  v_mov_b32 v16, 0
  v_mov_b32 v17, 0
  v_mov_b32 v18, 0
  v_mov_b32 v19, 0
  v_mov_b32 v20, 0
  v_mov_b32 v21, 0
  v_mov_b32 v22, 0
  v_mov_b32 v23, 0
  s_waitcnt vmcnt(2)
  buffer_load_dwordx4 v[76:79], v8, s[16:19], s88 offen
  s_add_u32 s88, s88, 0x8000
  v_dot2c_f32_bf16_dpp v16, v28, v64 row_newbcast:0 row_mask:0xf bank_mask:0xf
  v_dot2c_f32_bf16_dpp v17, v30, v64 row_newbcast:0 row_mask:0xf bank_mask:0xf
  v_dot2c_f32_bf16_dpp v18, v28, v65 row_newbcast:0 row_mask:0xf bank_mask:0xf
  v_dot2c_f32_bf16_dpp v19, v30, v65 row_newbcast:0 row_mask:0xf bank_mask:0xf
  v_dot2c_f32_bf16_dpp v20, v28, v66 row_newbcast:0 row_mask:0xf bank_mask:0xf
  v_dot2c_f32_bf16_dpp v21, v30, v66 row_newbcast:0 row_mask:0xf bank_mask:0xf
  v_dot2c_f32_bf16_dpp v22, v28, v67 row_newbcast:0 row_mask:0xf bank_mask:0xf
  v_dot2c_f32_bf16_dpp v23, v30, v67 row_newbcast:0 row_mask:0xf bank_mask:0xf
  s_waitcnt vmcnt(2)
  buffer_load_dwordx4 v[80:83], v8, s[16:19], s88 offen
  s_add_u32 s88, s88, 0x8000
  v_dot2c_f32_bf16_dpp v16, v28, v68 row_newbcast:1 row_mask:0xf bank_mask:0xf
  v_dot2c_f32_bf16_dpp v17, v30, v68 row_newbcast:1 row_mask:0xf bank_mask:0xf
  v_dot2c_f32_bf16_dpp v18, v28, v69 row_newbcast:1 row_mask:0xf bank_mask:0xf
  v_dot2c_f32_bf16_dpp v19, v30, v69 row_newbcast:1 row_mask:0xf bank_mask:0xf
  v_dot2c_f32_bf16_dpp v20, v28, v70 row_newbcast:1 row_mask:0xf bank_mask:0xf
  v_dot2c_f32_bf16_dpp v21, v30, v70 row_newbcast:1 row_mask:0xf bank_mask:0xf
  v_dot2c_f32_bf16_dpp v22, v28, v71 row_newbcast:1 row_mask:0xf bank_mask:0xf
  v_dot2c_f32_bf16_dpp v23, v30, v71 row_newbcast:1 row_mask:0xf bank_mask:0xf
  s_waitcnt vmcnt(2)
  buffer_load_dwordx4 v[84:87], v8, s[16:19], s88 offen
  s_add_u32 s88, s88, 0x8000
  v_dot2c_f32_bf16_dpp v16, v28, v72 row_newbcast:2 row_mask:0xf bank_mask:0xf
  v_dot2c_f32_bf16_dpp v17, v30, v72 row_newbcast:2 row_mask:0xf bank_mask:0xf
  v_dot2c_f32_bf16_dpp v18, v28, v73 row_newbcast:2 row_mask:0xf bank_mask:0xf
  v_dot2c_f32_bf16_dpp v19, v30, v73 row_newbcast:2 row_mask:0xf bank_mask:0xf
  v_dot2c_f32_bf16_dpp v20, v28, v74 row_newbcast:2 row_mask:0xf bank_mask:0xf
  v_dot2c_f32_bf16_dpp v21, v30, v74 row_newbcast:2 row_mask:0xf bank_mask:0xf
  v_dot2c_f32_bf16_dpp v22, v28, v75 row_newbcast:2 row_mask:0xf bank_mask:0xf
  v_dot2c_f32_bf16_dpp v23, v30, v75 row_newbcast:2 row_mask:0xf bank_mask:0xf
  s_waitcnt vmcnt(2)
  buffer_load_dwordx4 v[88:91], v8, s[16:19], s88 offen
  s_add_u32 s88, s88, 0x8000
  v_dot2c_f32_bf16_dpp v16, v28, v76 row_newbcast:3 row_mask:0xf bank_mask:0xf
  v_dot2c_f32_bf16_dpp v17, v30, v76 row_newbcast:3 row_mask:0xf bank_mask:0xf
  v_dot2c_f32_bf16_dpp v18, v28, v77 row_newbcast:3 row_mask:0xf bank_mask:0xf
  v_dot2c_f32_bf16_dpp v19, v30, v77 row_newbcast:3 row_mask:0xf bank_mask:0xf
  v_dot2c_f32_bf16_dpp v20, v28, v78 row_newbcast:3 row_mask:0xf bank_mask:0xf
  v_dot2c_f32_bf16_dpp v21, v30, v78 row_newbcast:3 row_mask:0xf bank_mask:0xf
  v_dot2c_f32_bf16_dpp v22, v28, v79 row_newbcast:3 row_mask:0xf bank_mask:0xf
  v_dot2c_f32_bf16_dpp v23, v30, v79 row_newbcast:3 row_mask:0xf bank_mask:0xf
  s_waitcnt vmcnt(2)
  buffer_load_dwordx4 v[92:95], v8, s[16:19], s88 offen
  s_add_u32 s88, s88, 0x8000
  v_dot2c_f32_bf16_dpp v16, v28, v80 row_newbcast:4 row_mask:0xf bank_mask:0xf
  v_dot2c_f32_bf16_dpp v17, v30, v80 row_newbcast:4 row_mask:0xf bank_mask:0xf
  v_dot2c_f32_bf16_dpp v18, v28, v81 row_newbcast:4 row_mask:0xf bank_mask:0xf
  v_dot2c_f32_bf16_dpp v19, v30, v81 row_newbcast:4 row_mask:0xf bank_mask:0xf
  v_dot2c_f32_bf16_dpp v20, v28, v82 row_newbcast:4 row_mask:0xf bank_mask:0xf
  v_dot2c_f32_bf16_dpp v21, v30, v82 row_newbcast:4 row_mask:0xf bank_mask:0xf
  v_dot2c_f32_bf16_dpp v22, v28, v83 row_newbcast:4 row_mask:0xf bank_mask:0xf
  v_dot2c_f32_bf16_dpp v23, v30, v83 row_newbcast:4 row_mask:0xf bank_mask:0xf
  s_waitcnt vmcnt(2)
  buffer_load_dwordx4 v[96:99], v8, s[16:19], s88 offen
  s_add_u32 s88, s88, 0x8000
  v_dot2c_f32_bf16_dpp v16, v28, v84 row_newbcast:5 row_mask:0xf bank_mask:0xf
  v_dot2c_f32_bf16_dpp v17, v30, v84 row_newbcast:5 row_mask:0xf bank_mask:0xf
  v_dot2c_f32_bf16_dpp v18, v28, v85 row_newbcast:5 row_mask:0xf bank_mask:0xf
  v_dot2c_f32_bf16_dpp v19, v30, v85 row_newbcast:5 row_mask:0xf bank_mask:0xf
  v_dot2c_f32_bf16_dpp v20, v28, v86 row_newbcast:5 row_mask:0xf bank_mask:0xf
  v_dot2c_f32_bf16_dpp v21, v30, v86 row_newbcast:5 row_mask:0xf bank_mask:0xf
  v_dot2c_f32_bf16_dpp v22, v28, v87 row_newbcast:5 row_mask:0xf bank_mask:0xf
  v_dot2c_f32_bf16_dpp v23, v30, v87 row_newbcast:5 row_mask:0xf bank_mask:0xf
  s_waitcnt vmcnt(2)
  buffer_load_dwordx4 v[100:103], v8, s[16:19], s88 offen
  s_add_u32 s88, s88, 0x8000
  v_dot2c_f32_bf16_dpp v16, v28, v88 row_newbcast:6 row_mask:0xf bank_mask:0xf
  v_dot2c_f32_bf16_dpp v17, v30, v88 row_newbcast:6 row_mask:0xf bank_mask:0xf
  v_dot2c_f32_bf16_dpp v18, v28, v89 row_newbcast:6 row_mask:0xf bank_mask:0xf
  v_dot2c_f32_bf16_dpp v19, v30, v89 row_newbcast:6 row_mask:0xf bank_mask:0xf
  v_dot2c_f32_bf16_dpp v20, v28, v90 row_newbcast:6 row_mask:0xf bank_mask:0xf
  v_dot2c_f32_bf16_dpp v21, v30, v90 row_newbcast:6 row_mask:0xf bank_mask:0xf
  v_dot2c_f32_bf16_dpp v22, v28, v91 row_newbcast:6 row_mask:0xf bank_mask:0xf
  v_dot2c_f32_bf16_dpp v23, v30, v91 row_newbcast:6 row_mask:0xf bank_mask:0xf
  s_waitcnt vmcnt(2)
  buffer_load_dwordx4 v[104:107], v8, s[16:19], s88 offen
  s_add_u32 s88, s88, 0x8000
  v_dot2c_f32_bf16_dpp v16, v28, v92 row_newbcast:7 row_mask:0xf bank_mask:0xf
  v_dot2c_f32_bf16_dpp v17, v30, v92 row_newbcast:7 row_mask:0xf bank_mask:0xf
  v_dot2c_f32_bf16_dpp v18, v28, v93 row_newbcast:7 row_mask:0xf bank_mask:0xf
  v_dot2c_f32_bf16_dpp v19, v30, v93 row_newbcast:7 row_mask:0xf bank_mask:0xf
  v_dot2c_f32_bf16_dpp v20, v28, v94 row_newbcast:7 row_mask:0xf bank_mask:0xf
  v_dot2c_f32_bf16_dpp v21, v30, v94 row_newbcast:7 row_mask:0xf bank_mask:0xf
  v_dot2c_f32_bf16_dpp v22, v28, v95 row_newbcast:7 row_mask:0xf bank_mask:0xf
  v_dot2c_f32_bf16_dpp v23, v30, v95 row_newbcast:7 row_mask:0xf bank_mask:0xf
  s_waitcnt vmcnt(2)
  buffer_load_dwordx4 v[108:111], v8, s[16:19], s88 offen
  s_add_u32 s88, s88, 0x8000
  v_dot2c_f32_bf16_dpp v16, v28, v96 row_newbcast:8 row_mask:0xf bank_mask:0xf
  v_dot2c_f32_bf16_dpp v17, v30, v96 row_newbcast:8 row_mask:0xf bank_mask:0xf
  v_dot2c_f32_bf16_dpp v18, v28, v97 row_newbcast:8 row_mask:0xf bank_mask:0xf
  v_dot2c_f32_bf16_dpp v19, v30, v97 row_newbcast:8 row_mask:0xf bank_mask:0xf
  v_dot2c_f32_bf16_dpp v20, v28, v98 row_newbcast:8 row_mask:0xf bank_mask:0xf
  v_dot2c_f32_bf16_dpp v21, v30, v98 row_newbcast:8 row_mask:0xf bank_mask:0xf
  v_dot2c_f32_bf16_dpp v22, v28, v99 row_newbcast:8 row_mask:0xf bank_mask:0xf
  v_dot2c_f32_bf16_dpp v23, v30, v99 row_newbcast:8 row_mask:0xf bank_mask:0xf
  s_waitcnt vmcnt(2)
  buffer_load_dwordx4 v[112:115], v8, s[16:19], s88 offen
  s_add_u32 s88, s88, 0x8000
  v_dot2c_f32_bf16_dpp v16, v28, v100 row_newbcast:9 row_mask:0xf bank_mask:0xf
  v_dot2c_f32_bf16_dpp v17, v30, v100 row_newbcast:9 row_mask:0xf bank_mask:0xf
  v_dot2c_f32_bf16_dpp v18, v28, v101 row_newbcast:9 row_mask:0xf bank_mask:0xf
  v_dot2c_f32_bf16_dpp v19, v30, v101 row_newbcast:9 row_mask:0xf bank_mask:0xf
  v_dot2c_f32_bf16_dpp v20, v28, v102 row_newbcast:9 row_mask:0xf bank_mask:0xf
  v_dot2c_f32_bf16_dpp v21, v30, v102 row_newbcast:9 row_mask:0xf bank_mask:0xf
  v_dot2c_f32_bf16_dpp v22, v28, v103 row_newbcast:9 row_mask:0xf bank_mask:0xf
  v_dot2c_f32_bf16_dpp v23, v30, v103 row_newbcast:9 row_mask:0xf bank_mask:0xf
  s_waitcnt vmcnt(2)
  buffer_load_dwordx4 v[116:119], v8, s[16:19], s88 offen
  s_add_u32 s88, s88, 0x8000
  v_dot2c_f32_bf16_dpp v16, v28, v104 row_newbcast:10 row_mask:0xf bank_mask:0xf
  v_dot2c_f32_bf16_dpp v17, v30, v104 row_newbcast:10 row_mask:0xf bank_mask:0xf
  v_dot2c_f32_bf16_dpp v18, v28, v105 row_newbcast:10 row_mask:0xf bank_mask:0xf
  v_dot2c_f32_bf16_dpp v19, v30, v105 row_newbcast:10 row_mask:0xf bank_mask:0xf
  v_dot2c_f32_bf16_dpp v20, v28, v106 row_newbcast:10 row_mask:0xf bank_mask:0xf
  v_dot2c_f32_bf16_dpp v21, v30, v106 row_newbcast:10 row_mask:0xf bank_mask:0xf
  v_dot2c_f32_bf16_dpp v22, v28, v107 row_newbcast:10 row_mask:0xf bank_mask:0xf
  v_dot2c_f32_bf16_dpp v23, v30, v107 row_newbcast:10 row_mask:0xf bank_mask:0xf
  s_waitcnt vmcnt(2)
  buffer_load_dwordx4 v[120:123], v8, s[16:19], s88 offen
  s_add_u32 s88, s88, 0x8000
  v_dot2c_f32_bf16_dpp v16, v28, v108 row_newbcast:11 row_mask:0xf bank_mask:0xf
  v_dot2c_f32_bf16_dpp v17, v30, v108 row_newbcast:11 row_mask:0xf bank_mask:0xf
  v_dot2c_f32_bf16_dpp v18, v28, v109 row_newbcast:11 row_mask:0xf bank_mask:0xf
  v_dot2c_f32_bf16_dpp v19, v30, v109 row_newbcast:11 row_mask:0xf bank_mask:0xf
  v_dot2c_f32_bf16_dpp v20, v28, v110 row_newbcast:11 row_mask:0xf bank_mask:0xf
  v_dot2c_f32_bf16_dpp v21, v30, v110 row_newbcast:11 row_mask:0xf bank_mask:0xf
  v_dot2c_f32_bf16_dpp v22, v28, v111 row_newbcast:11 row_mask:0xf bank_mask:0xf
  v_dot2c_f32_bf16_dpp v23, v30, v111 row_newbcast:11 row_mask:0xf bank_mask:0xf
  s_waitcnt vmcnt(2)
  buffer_load_dwordx4 v[124:127], v8, s[16:19], s88 offen
  s_add_u32 s88, s88, 0x8000
  v_dot2c_f32_bf16_dpp v16, v28, v112 row_newbcast:12 row_mask:0xf bank_mask:0xf
  v_dot2c_f32_bf16_dpp v17, v30, v112 row_newbcast:12 row_mask:0xf bank_mask:0xf
  v_dot2c_f32_bf16_dpp v18, v28, v113 row_newbcast:12 row_mask:0xf bank_mask:0xf
  v_dot2c_f32_bf16_dpp v19, v30, v113 row_newbcast:12 row_mask:0xf bank_mask:0xf
  v_dot2c_f32_bf16_dpp v20, v28, v114 row_newbcast:12 row_mask:0xf bank_mask:0xf
  v_dot2c_f32_bf16_dpp v21, v30, v114 row_newbcast:12 row_mask:0xf bank_mask:0xf
  v_dot2c_f32_bf16_dpp v22, v28, v115 row_newbcast:12 row_mask:0xf bank_mask:0xf
  v_dot2c_f32_bf16_dpp v23, v30, v115 row_newbcast:12 row_mask:0xf bank_mask:0xf
  s_waitcnt vmcnt(2)
  buffer_load_dwordx4 v[128:131], v8, s[16:19], s88 offen
  s_add_u32 s88, s88, 0x8000
  v_dot2c_f32_bf16_dpp v16, v28, v116 row_newbcast:13 row_mask:0xf bank_mask:0xf
  v_dot2c_f32_bf16_dpp v17, v30, v116 row_newbcast:13 row_mask:0xf bank_mask:0xf
  v_dot2c_f32_bf16_dpp v18, v28, v117 row_newbcast:13 row_mask:0xf bank_mask:0xf
  v_dot2c_f32_bf16_dpp v19, v30, v117 row_newbcast:13 row_mask:0xf bank_mask:0xf
  v_dot2c_f32_bf16_dpp v20, v28, v118 row_newbcast:13 row_mask:0xf bank_mask:0xf
  v_dot2c_f32_bf16_dpp v21, v30, v118 row_newbcast:13 row_mask:0xf bank_mask:0xf
  v_dot2c_f32_bf16_dpp v22, v28, v119 row_newbcast:13 row_mask:0xf bank_mask:0xf
  v_dot2c_f32_bf16_dpp v23, v30, v119 row_newbcast:13 row_mask:0xf bank_mask:0xf
  s_waitcnt vmcnt(2)
  buffer_load_dwordx4 v[132:135], v8, s[16:19], s88 offen
  s_add_u32 s88, s88, 0x8000
  v_dot2c_f32_bf16_dpp v16, v28, v120 row_newbcast:14 row_mask:0xf bank_mask:0xf
  v_dot2c_f32_bf16_dpp v17, v30, v120 row_newbcast:14 row_mask:0xf bank_mask:0xf
  v_dot2c_f32_bf16_dpp v18, v28, v121 row_newbcast:14 row_mask:0xf bank_mask:0xf
  v_dot2c_f32_bf16_dpp v19, v30, v121 row_newbcast:14 row_mask:0xf bank_mask:0xf
  v_dot2c_f32_bf16_dpp v20, v28, v122 row_newbcast:14 row_mask:0xf bank_mask:0xf
  v_dot2c_f32_bf16_dpp v21, v30, v122 row_newbcast:14 row_mask:0xf bank_mask:0xf
  v_dot2c_f32_bf16_dpp v22, v28, v123 row_newbcast:14 row_mask:0xf bank_mask:0xf
  v_dot2c_f32_bf16_dpp v23, v30, v123 row_newbcast:14 row_mask:0xf bank_mask:0xf
  s_waitcnt vmcnt(2)
  buffer_load_dwordx4 v[136:139], v8, s[16:19], s88 offen
  s_add_u32 s88, s88, 0x8000
  v_dot2c_f32_bf16_dpp v16, v28, v124 row_newbcast:15 row_mask:0xf bank_mask:0xf
  v_dot2c_f32_bf16_dpp v17, v30, v124 row_newbcast:15 row_mask:0xf bank_mask:0xf
  v_dot2c_f32_bf16_dpp v18, v28, v125 row_newbcast:15 row_mask:0xf bank_mask:0xf
  v_dot2c_f32_bf16_dpp v19, v30, v125 row_newbcast:15 row_mask:0xf bank_mask:0xf
  v_dot2c_f32_bf16_dpp v20, v28, v126 row_newbcast:15 row_mask:0xf bank_mask:0xf
  v_dot2c_f32_bf16_dpp v21, v30, v126 row_newbcast:15 row_mask:0xf bank_mask:0xf
  v_dot2c_f32_bf16_dpp v22, v28, v127 row_newbcast:15 row_mask:0xf bank_mask:0xf
  v_dot2c_f32_bf16_dpp v23, v30, v127 row_newbcast:15 row_mask:0xf bank_mask:0xf
  s_waitcnt vmcnt(2)
  buffer_load_dwordx4 v[140:143], v8, s[16:19], s88 offen
  s_add_u32 s88, s88, 0x8000
  v_dot2c_f32_bf16_dpp v16, v29, v128 row_newbcast:0 row_mask:0xf bank_mask:0xf
  v_dot2c_f32_bf16_dpp v17, v31, v128 row_newbcast:0 row_mask:0xf bank_mask:0xf
  v_dot2c_f32_bf16_dpp v18, v29, v129 row_newbcast:0 row_mask:0xf bank_mask:0xf
  v_dot2c_f32_bf16_dpp v19, v31, v129 row_newbcast:0 row_mask:0xf bank_mask:0xf
  v_dot2c_f32_bf16_dpp v20, v29, v130 row_newbcast:0 row_mask:0xf bank_mask:0xf
  v_dot2c_f32_bf16_dpp v21, v31, v130 row_newbcast:0 row_mask:0xf bank_mask:0xf
  v_dot2c_f32_bf16_dpp v22, v29, v131 row_newbcast:0 row_mask:0xf bank_mask:0xf
  v_dot2c_f32_bf16_dpp v23, v31, v131 row_newbcast:0 row_mask:0xf bank_mask:0xf
  s_waitcnt vmcnt(2)
  buffer_load_dwordx4 v[144:147], v8, s[16:19], s88 offen
  s_add_u32 s88, s88, 0x8000
  v_dot2c_f32_bf16_dpp v16, v29, v132 row_newbcast:1 row_mask:0xf bank_mask:0xf
  v_dot2c_f32_bf16_dpp v17, v31, v132 row_newbcast:1 row_mask:0xf bank_mask:0xf
  v_dot2c_f32_bf16_dpp v18, v29, v133 row_newbcast:1 row_mask:0xf bank_mask:0xf
  v_dot2c_f32_bf16_dpp v19, v31, v133 row_newbcast:1 row_mask:0xf bank_mask:0xf
  v_dot2c_f32_bf16_dpp v20, v29, v134 row_newbcast:1 row_mask:0xf bank_mask:0xf
  v_dot2c_f32_bf16_dpp v21, v31, v134 row_newbcast:1 row_mask:0xf bank_mask:0xf
  v_dot2c_f32_bf16_dpp v22, v29, v135 row_newbcast:1 row_mask:0xf bank_mask:0xf
  v_dot2c_f32_bf16_dpp v23, v31, v135 row_newbcast:1 row_mask:0xf bank_mask:0xf
  s_waitcnt vmcnt(2)
  buffer_load_dwordx4 v[148:151], v8, s[16:19], s88 offen
  s_add_u32 s88, s88, 0x8000
  v_dot2c_f32_bf16_dpp v16, v29, v136 row_newbcast:2 row_mask:0xf bank_mask:0xf
  v_dot2c_f32_bf16_dpp v17, v31, v136 row_newbcast:2 row_mask:0xf bank_mask:0xf
  v_dot2c_f32_bf16_dpp v18, v29, v137 row_newbcast:2 row_mask:0xf bank_mask:0xf
  v_dot2c_f32_bf16_dpp v19, v31, v137 row_newbcast:2 row_mask:0xf bank_mask:0xf
  v_dot2c_f32_bf16_dpp v20, v29, v138 row_newbcast:2 row_mask:0xf bank_mask:0xf
  v_dot2c_f32_bf16_dpp v21, v31, v138 row_newbcast:2 row_mask:0xf bank_mask:0xf
  v_dot2c_f32_bf16_dpp v22, v29, v139 row_newbcast:2 row_mask:0xf bank_mask:0xf
  v_dot2c_f32_bf16_dpp v23, v31, v139 row_newbcast:2 row_mask:0xf bank_mask:0xf
  s_waitcnt vmcnt(2)
  buffer_load_dwordx4 v[152:155], v8, s[16:19], s88 offen
  s_add_u32 s88, s88, 0x8000
  v_dot2c_f32_bf16_dpp v16, v29, v140 row_newbcast:3 row_mask:0xf bank_mask:0xf
  v_dot2c_f32_bf16_dpp v17, v31, v140 row_newbcast:3 row_mask:0xf bank_mask:0xf
  v_dot2c_f32_bf16_dpp v18, v29, v141 row_newbcast:3 row_mask:0xf bank_mask:0xf
  v_dot2c_f32_bf16_dpp v19, v31, v141 row_newbcast:3 row_mask:0xf bank_mask:0xf
  v_dot2c_f32_bf16_dpp v20, v29, v142 row_newbcast:3 row_mask:0xf bank_mask:0xf
  v_dot2c_f32_bf16_dpp v21, v31, v142 row_newbcast:3 row_mask:0xf bank_mask:0xf
  v_dot2c_f32_bf16_dpp v22, v29, v143 row_newbcast:3 row_mask:0xf bank_mask:0xf
  v_dot2c_f32_bf16_dpp v23, v31, v143 row_newbcast:3 row_mask:0xf bank_mask:0xf
  s_waitcnt vmcnt(2)
  buffer_load_dwordx4 v[156:159], v8, s[16:19], s88 offen
  s_add_u32 s88, s88, 0x8000
  v_dot2c_f32_bf16_dpp v16, v29, v144 row_newbcast:4 row_mask:0xf bank_mask:0xf
  v_dot2c_f32_bf16_dpp v17, v31, v144 row_newbcast:4 row_mask:0xf bank_mask:0xf
  v_dot2c_f32_bf16_dpp v18, v29, v145 row_newbcast:4 row_mask:0xf bank_mask:0xf
  v_dot2c_f32_bf16_dpp v19, v31, v145 row_newbcast:4 row_mask:0xf bank_mask:0xf
  v_dot2c_f32_bf16_dpp v20, v29, v146 row_newbcast:4 row_mask:0xf bank_mask:0xf
  v_dot2c_f32_bf16_dpp v21, v31, v146 row_newbcast:4 row_mask:0xf bank_mask:0xf
  v_dot2c_f32_bf16_dpp v22, v29, v147 row_newbcast:4 row_mask:0xf bank_mask:0xf
  v_dot2c_f32_bf16_dpp v23, v31, v147 row_newbcast:4 row_mask:0xf bank_mask:0xf
  s_waitcnt vmcnt(2)
  buffer_load_dwordx4 v[160:163], v8, s[16:19], s88 offen
  s_add_u32 s88, s88, 0x8000
  v_dot2c_f32_bf16_dpp v16, v29, v148 row_newbcast:5 row_mask:0xf bank_mask:0xf
  v_dot2c_f32_bf16_dpp v17, v31, v148 row_newbcast:5 row_mask:0xf bank_mask:0xf
  v_dot2c_f32_bf16_dpp v18, v29, v149 row_newbcast:5 row_mask:0xf bank_mask:0xf
  v_dot2c_f32_bf16_dpp v19, v31, v149 row_newbcast:5 row_mask:0xf bank_mask:0xf
  v_dot2c_f32_bf16_dpp v20, v29, v150 row_newbcast:5 row_mask:0xf bank_mask:0xf
  v_dot2c_f32_bf16_dpp v21, v31, v150 row_newbcast:5 row_mask:0xf bank_mask:0xf
  v_dot2c_f32_bf16_dpp v22, v29, v151 row_newbcast:5 row_mask:0xf bank_mask:0xf
  v_dot2c_f32_bf16_dpp v23, v31, v151 row_newbcast:5 row_mask:0xf bank_mask:0xf
  s_waitcnt vmcnt(2)
  buffer_load_dwordx4 v[164:167], v8, s[16:19], s88 offen
  s_add_u32 s88, s88, 0x8000
  v_dot2c_f32_bf16_dpp v16, v29, v152 row_newbcast:6 row_mask:0xf bank_mask:0xf
  v_dot2c_f32_bf16_dpp v17, v31, v152 row_newbcast:6 row_mask:0xf bank_mask:0xf
  v_dot2c_f32_bf16_dpp v18, v29, v153 row_newbcast:6 row_mask:0xf bank_mask:0xf
  v_dot2c_f32_bf16_dpp v19, v31, v153 row_newbcast:6 row_mask:0xf bank_mask:0xf
  v_dot2c_f32_bf16_dpp v20, v29, v154 row_newbcast:6 row_mask:0xf bank_mask:0xf
  v_dot2c_f32_bf16_dpp v21, v31, v154 row_newbcast:6 row_mask:0xf bank_mask:0xf
  v_dot2c_f32_bf16_dpp v22, v29, v155 row_newbcast:6 row_mask:0xf bank_mask:0xf
  v_dot2c_f32_bf16_dpp v23, v31, v155 row_newbcast:6 row_mask:0xf bank_mask:0xf
  s_waitcnt vmcnt(2)
  buffer_load_dwordx4 v[168:171], v8, s[16:19], s88 offen
  s_add_u32 s88, s88, 0x8000
  v_dot2c_f32_bf16_dpp v16, v29, v156 row_newbcast:7 row_mask:0xf bank_mask:0xf
  v_dot2c_f32_bf16_dpp v17, v31, v156 row_newbcast:7 row_mask:0xf bank_mask:0xf
  v_dot2c_f32_bf16_dpp v18, v29, v157 row_newbcast:7 row_mask:0xf bank_mask:0xf
  v_dot2c_f32_bf16_dpp v19, v31, v157 row_newbcast:7 row_mask:0xf bank_mask:0xf
  v_dot2c_f32_bf16_dpp v20, v29, v158 row_newbcast:7 row_mask:0xf bank_mask:0xf
  v_dot2c_f32_bf16_dpp v21, v31, v158 row_newbcast:7 row_mask:0xf bank_mask:0xf
  v_dot2c_f32_bf16_dpp v22, v29, v159 row_newbcast:7 row_mask:0xf bank_mask:0xf
  v_dot2c_f32_bf16_dpp v23, v31, v159 row_newbcast:7 row_mask:0xf bank_mask:0xf
  s_waitcnt vmcnt(2)
  buffer_load_dwordx4 v[172:175], v8, s[16:19], s88 offen
  s_add_u32 s88, s88, 0x8000
  v_dot2c_f32_bf16_dpp v16, v29, v160 row_newbcast:8 row_mask:0xf bank_mask:0xf
  v_dot2c_f32_bf16_dpp v17, v31, v160 row_newbcast:8 row_mask:0xf bank_mask:0xf
  v_dot2c_f32_bf16_dpp v18, v29, v161 row_newbcast:8 row_mask:0xf bank_mask:0xf
  v_dot2c_f32_bf16_dpp v19, v31, v161 row_newbcast:8 row_mask:0xf bank_mask:0xf
  v_dot2c_f32_bf16_dpp v20, v29, v162 row_newbcast:8 row_mask:0xf bank_mask:0xf
  v_dot2c_f32_bf16_dpp v21, v31, v162 row_newbcast:8 row_mask:0xf bank_mask:0xf
  v_dot2c_f32_bf16_dpp v22, v29, v163 row_newbcast:8 row_mask:0xf bank_mask:0xf
  v_dot2c_f32_bf16_dpp v23, v31, v163 row_newbcast:8 row_mask:0xf bank_mask:0xf
  s_waitcnt vmcnt(2)
  buffer_load_dwordx4 v[176:179], v8, s[16:19], s88 offen
  s_add_u32 s88, s88, 0x8000
  v_dot2c_f32_bf16_dpp v16, v29, v164 row_newbcast:9 row_mask:0xf bank_mask:0xf
  v_dot2c_f32_bf16_dpp v17, v31, v164 row_newbcast:9 row_mask:0xf bank_mask:0xf
  v_dot2c_f32_bf16_dpp v18, v29, v165 row_newbcast:9 row_mask:0xf bank_mask:0xf
  v_dot2c_f32_bf16_dpp v19, v31, v165 row_newbcast:9 row_mask:0xf bank_mask:0xf
  v_dot2c_f32_bf16_dpp v20, v29, v166 row_newbcast:9 row_mask:0xf bank_mask:0xf
  v_dot2c_f32_bf16_dpp v21, v31, v166 row_newbcast:9 row_mask:0xf bank_mask:0xf
  v_dot2c_f32_bf16_dpp v22, v29, v167 row_newbcast:9 row_mask:0xf bank_mask:0xf
  v_dot2c_f32_bf16_dpp v23, v31, v167 row_newbcast:9 row_mask:0xf bank_mask:0xf
  s_waitcnt vmcnt(2)
  buffer_load_dwordx4 v[180:183], v8, s[16:19], s88 offen
  s_add_u32 s88, s88, 0x8000
  v_dot2c_f32_bf16_dpp v16, v29, v168 row_newbcast:10 row_mask:0xf bank_mask:0xf
  v_dot2c_f32_bf16_dpp v17, v31, v168 row_newbcast:10 row_mask:0xf bank_mask:0xf
  v_dot2c_f32_bf16_dpp v18, v29, v169 row_newbcast:10 row_mask:0xf bank_mask:0xf
  v_dot2c_f32_bf16_dpp v19, v31, v169 row_newbcast:10 row_mask:0xf bank_mask:0xf
  v_dot2c_f32_bf16_dpp v20, v29, v170 row_newbcast:10 row_mask:0xf bank_mask:0xf
  v_dot2c_f32_bf16_dpp v21, v31, v170 row_newbcast:10 row_mask:0xf bank_mask:0xf
  v_dot2c_f32_bf16_dpp v22, v29, v171 row_newbcast:10 row_mask:0xf bank_mask:0xf
  v_dot2c_f32_bf16_dpp v23, v31, v171 row_newbcast:10 row_mask:0xf bank_mask:0xf
  s_waitcnt vmcnt(2)
  buffer_load_dwordx4 v[184:187], v8, s[16:19], s88 offen
  s_add_u32 s88, s88, 0x8000
  v_dot2c_f32_bf16_dpp v16, v29, v172 row_newbcast:11 row_mask:0xf bank_mask:0xf
  v_dot2c_f32_bf16_dpp v17, v31, v172 row_newbcast:11 row_mask:0xf bank_mask:0xf
  v_dot2c_f32_bf16_dpp v18, v29, v173 row_newbcast:11 row_mask:0xf bank_mask:0xf
  v_dot2c_f32_bf16_dpp v19, v31, v173 row_newbcast:11 row_mask:0xf bank_mask:0xf
  v_dot2c_f32_bf16_dpp v20, v29, v174 row_newbcast:11 row_mask:0xf bank_mask:0xf
  v_dot2c_f32_bf16_dpp v21, v31, v174 row_newbcast:11 row_mask:0xf bank_mask:0xf
  v_dot2c_f32_bf16_dpp v22, v29, v175 row_newbcast:11 row_mask:0xf bank_mask:0xf
  v_dot2c_f32_bf16_dpp v23, v31, v175 row_newbcast:11 row_mask:0xf bank_mask:0xf
  s_waitcnt vmcnt(2)
  buffer_load_dwordx4 v[188:191], v8, s[16:19], s88 offen
  v_dot2c_f32_bf16_dpp v16, v29, v176 row_newbcast:12 row_mask:0xf bank_mask:0xf
  v_dot2c_f32_bf16_dpp v17, v31, v176 row_newbcast:12 row_mask:0xf bank_mask:0xf
  v_dot2c_f32_bf16_dpp v18, v29, v177 row_newbcast:12 row_mask:0xf bank_mask:0xf
  v_dot2c_f32_bf16_dpp v19, v31, v177 row_newbcast:12 row_mask:0xf bank_mask:0xf
  v_dot2c_f32_bf16_dpp v20, v29, v178 row_newbcast:12 row_mask:0xf bank_mask:0xf
  v_dot2c_f32_bf16_dpp v21, v31, v178 row_newbcast:12 row_mask:0xf bank_mask:0xf
  v_dot2c_f32_bf16_dpp v22, v29, v179 row_newbcast:12 row_mask:0xf bank_mask:0xf
  v_dot2c_f32_bf16_dpp v23, v31, v179 row_newbcast:12 row_mask:0xf bank_mask:0xf
  s_waitcnt vmcnt(2)
  v_dot2c_f32_bf16_dpp v16, v29, v180 row_newbcast:13 row_mask:0xf bank_mask:0xf
  v_dot2c_f32_bf16_dpp v17, v31, v180 row_newbcast:13 row_mask:0xf bank_mask:0xf
  v_dot2c_f32_bf16_dpp v18, v29, v181 row_newbcast:13 row_mask:0xf bank_mask:0xf
  v_dot2c_f32_bf16_dpp v19, v31, v181 row_newbcast:13 row_mask:0xf bank_mask:0xf
  v_dot2c_f32_bf16_dpp v20, v29, v182 row_newbcast:13 row_mask:0xf bank_mask:0xf
  v_dot2c_f32_bf16_dpp v21, v31, v182 row_newbcast:13 row_mask:0xf bank_mask:0xf
  v_dot2c_f32_bf16_dpp v22, v29, v183 row_newbcast:13 row_mask:0xf bank_mask:0xf
  v_dot2c_f32_bf16_dpp v23, v31, v183 row_newbcast:13 row_mask:0xf bank_mask:0xf
  s_waitcnt vmcnt(1)
  v_dot2c_f32_bf16_dpp v16, v29, v184 row_newbcast:14 row_mask:0xf bank_mask:0xf
  v_dot2c_f32_bf16_dpp v17, v31, v184 row_newbcast:14 row_mask:0xf bank_mask:0xf
  v_dot2c_f32_bf16_dpp v18, v29, v185 row_newbcast:14 row_mask:0xf bank_mask:0xf
  v_dot2c_f32_bf16_dpp v19, v31, v185 row_newbcast:14 row_mask:0xf bank_mask:0xf
  v_dot2c_f32_bf16_dpp v20, v29, v186 row_newbcast:14 row_mask:0xf bank_mask:0xf
  v_dot2c_f32_bf16_dpp v21, v31, v186 row_newbcast:14 row_mask:0xf bank_mask:0xf
  v_dot2c_f32_bf16_dpp v22, v29, v187 row_newbcast:14 row_mask:0xf bank_mask:0xf
  v_dot2c_f32_bf16_dpp v23, v31, v187 row_newbcast:14 row_mask:0xf bank_mask:0xf
  s_waitcnt vmcnt(0)
  v_dot2c_f32_bf16_dpp v16, v29, v188 row_newbcast:15 row_mask:0xf bank_mask:0xf
  v_dot2c_f32_bf16_dpp v17, v31, v188 row_newbcast:15 row_mask:0xf bank_mask:0xf
  v_dot2c_f32_bf16_dpp v18, v29, v189 row_newbcast:15 row_mask:0xf bank_mask:0xf
  v_dot2c_f32_bf16_dpp v19, v31, v189 row_newbcast:15 row_mask:0xf bank_mask:0xf
  v_dot2c_f32_bf16_dpp v20, v29, v190 row_newbcast:15 row_mask:0xf bank_mask:0xf
  v_dot2c_f32_bf16_dpp v21, v31, v190 row_newbcast:15 row_mask:0xf bank_mask:0xf
  v_dot2c_f32_bf16_dpp v22, v29, v191 row_newbcast:15 row_mask:0xf bank_mask:0xf
  v_dot2c_f32_bf16_dpp v23, v31, v191 row_newbcast:15 row_mask:0xf bank_mask:0xf
  v_lshlrev_b32 v11, 3, v3
  v_lshl_add_u32 v11, v4, 5, v11
  s_lshl_b32 s84, s63, 9
  v_add_u32 v10, s84, v11
  v_permlane32_swap_b32 v16, v20
  v_permlane32_swap_b32 v17, v21
  v_permlane32_swap_b32 v18, v22
  v_permlane32_swap_b32 v19, v23
  v_add_f32 v16, v16, v20
  v_add_f32 v17, v17, v21
  v_add_f32 v18, v18, v22
  v_add_f32 v19, v19, v23
  s_nop 0
  v_permlane16_swap_b32 v16, v18
  v_permlane16_swap_b32 v17, v19
  v_add_f32 v16, v16, v18
  v_add_f32 v17, v17, v19
  ds_write_b64 v10, v[16:17] offset:16384
  s_waitcnt lgkmcnt(0)
  s_barrier
  s_load_dwordx8 s[52:59], s[0:1], 48
  s_load_dwordx2 s[46:47], s[0:1], 32
  s_add_u32 s6, s6, 1
  s_and_b32 s84, s6, 0xff
  v_mov_b32 v12, s84
  s_movk_i32 s7, 0xff
  v_mov_b32 v32, 0
  s_cmp_eq_u32 s63, 2
  s_cbranch_scc0 L_noctl0_2
  s_waitcnt lgkmcnt(0)
  v_mov_b32 v10, 0
  ds_read_b32 v24, v10 offset:22784
  s_and_b32 s86, s6, 0xffff
  s_lshl_b32 s93, s86, 16
  v_lshlrev_b32 v25, 2, v2
  v_and_b32 v31, 7, v2
  s_lshr_b32 s84, s2, 3
  s_and_b32 s85, s2, 7
  s_sub_u32 s85, s84, s85
  v_add_u32 v32, s85, v31
  v_lshrrev_b32 v33, 3, v2
  v_lshl_add_u32 v32, v33, 2, v32
  v_and_b32 v32, 7, v32
  s_and_b32 s84, s84, 24
  v_or_b32 v32, s84, v32
  v_lshl_add_u32 v32, v32, 3, v31
  v_lshlrev_b32 v32, 7, v32
  s_waitcnt lgkmcnt(0)
  v_readfirstlane_b32 s92, v24
L_noctl0_2:
  v_lshrrev_b32 v9, 3, v2
  s_lshl_b32 s84, s62, 9
  s_lshl_b32 s85, s4, 3
  s_add_u32 s84, s84, s85
  v_add_u32 v9, s84, v9
  v_lshlrev_b32 v9, 1, v9
  buffer_load_ushort v14, v9, s[12:15], 0 offen
  s_waitcnt lgkmcnt(0)
  s_mov_b32 s16, s46
  s_mov_b32 s17, s47
  s_mov_b32 s18, 4194304
  s_mov_b32 s19, 0x20000
  s_mov_b32 s20, s52
  s_mov_b32 s21, s53
  s_mov_b32 s22, 1409024
  s_mov_b32 s23, 0x20000
  s_mov_b32 s24, s54
  s_mov_b32 s25, s55
  s_mov_b32 s26, 1409024
  s_mov_b32 s27, 0x20000
  s_mov_b32 s28, s56
  s_mov_b32 s29, s57
  s_mov_b32 s30, 1409024
  s_mov_b32 s31, 0x20000
  s_mov_b32 s32, s58
  s_mov_b32 s33, s59
  s_mov_b32 s34, 4096
  s_mov_b32 s35, 0x20000
  s_cmp_eq_u32 s63, 3
  s_cbranch_scc0 L_noffn_3
  s_cmp_ge_u32 s5, 43
  s_cbranch_scc1 L_noffn_3
  s_load_dword s52, s[50:51], 0xf0000
  s_load_dword s53, s[50:51], 0xf0080
  s_load_dword s54, s[50:51], 0xf0100
  s_load_dword s55, s[50:51], 0xf0180
  v_lshlrev_b32 v50, 4, v2
  v_lshlrev_b32 v51, 5, v2
  s_mov_b32 s87, 4
L_ln4_4:
  buffer_load_dwordx4 v[24:27], v50, s[12:15], 0 offen
  s_waitcnt vmcnt(0)
  v_lshlrev_b32 v36, 16, v24
  v_and_b32 v37, 0xffff0000, v24
  v_lshlrev_b32 v38, 16, v25
  v_and_b32 v39, 0xffff0000, v25
  v_lshlrev_b32 v40, 16, v26
  v_and_b32 v41, 0xffff0000, v26
  v_lshlrev_b32 v42, 16, v27
  v_and_b32 v43, 0xffff0000, v27
  v_add_f32 v44, v36, v37
  v_add_f32 v44, v44, v38
  v_add_f32 v44, v44, v39
  v_add_f32 v44, v44, v40
  v_add_f32 v44, v44, v41
  v_add_f32 v44, v44, v42
  v_add_f32 v44, v44, v43
  s_nop 1
  v_add_f32_dpp v44, v44, v44 row_ror:8 row_mask:0xf bank_mask:0xf
  s_nop 1
  v_add_f32_dpp v44, v44, v44 row_ror:4 row_mask:0xf bank_mask:0xf
  s_nop 1
  v_add_f32_dpp v44, v44, v44 row_ror:2 row_mask:0xf bank_mask:0xf
  s_nop 1
  v_add_f32_dpp v44, v44, v44 row_ror:1 row_mask:0xf bank_mask:0xf
  v_mov_b32 v45, v44
  s_nop 1
  v_permlane16_swap_b32 v44, v45
  v_add_f32 v44, v44, v45
  v_mov_b32 v45, v44
  s_nop 1
  v_permlane32_swap_b32 v44, v45
  v_add_f32 v44, v44, v45
  v_mul_f32 v44, 0x3b000000, v44
  v_sub_f32 v36, v36, v44
  v_sub_f32 v37, v37, v44
  v_sub_f32 v38, v38, v44
  v_sub_f32 v39, v39, v44
  v_sub_f32 v40, v40, v44
  v_sub_f32 v41, v41, v44
  v_sub_f32 v42, v42, v44
  v_sub_f32 v43, v43, v44
  v_mul_f32 v46, v36, v36
  v_fmac_f32 v46, v37, v37
  v_fmac_f32 v46, v38, v38
  v_fmac_f32 v46, v39, v39
  v_fmac_f32 v46, v40, v40
  v_fmac_f32 v46, v41, v41
  v_fmac_f32 v46, v42, v42
  v_fmac_f32 v46, v43, v43
  s_nop 1
  v_add_f32_dpp v46, v46, v46 row_ror:8 row_mask:0xf bank_mask:0xf
  s_nop 1
  v_add_f32_dpp v46, v46, v46 row_ror:4 row_mask:0xf bank_mask:0xf
  s_nop 1
  v_add_f32_dpp v46, v46, v46 row_ror:2 row_mask:0xf bank_mask:0xf
  s_nop 1
  v_add_f32_dpp v46, v46, v46 row_ror:1 row_mask:0xf bank_mask:0xf
  v_mov_b32 v45, v46
  s_nop 1
  v_permlane16_swap_b32 v46, v45
  v_add_f32 v46, v46, v45
  v_mov_b32 v45, v46
  s_nop 1
  v_permlane32_swap_b32 v46, v45
  v_add_f32 v46, v46, v45
  v_mul_f32 v46, 0x3b000000, v46
  v_cvt_pk_bf16_f32 v44, v44, v44
  v_and_b32 v44, 0xffff0000, v44
  v_cvt_pk_bf16_f32 v46, v46, v46
  v_and_b32 v46, 0xffff0000, v46
  v_add_f32 v46, 0x3727c5ac, v46
  v_cvt_pk_bf16_f32 v46, v46, v46
  v_and_b32 v46, 0xffff0000, v46
  v_sqrt_f32 v47, v46
  s_nop 0
  v_rcp_f32 v45, v47
  v_fma_f32 v48, -v47, v47, v46
  v_mul_f32 v45, 0.5, v45
  v_fmac_f32 v47, v48, v45
  v_cvt_pk_bf16_f32 v47, v47, v47
  v_and_b32 v47, 0xffff0000, v47
  v_rcp_f32 v45, v47
  v_lshlrev_b32 v52, 16, v24
  v_and_b32 v53, 0xffff0000, v24
  v_lshlrev_b32 v54, 16, v25
  v_and_b32 v55, 0xffff0000, v25
  v_lshlrev_b32 v56, 16, v26
  v_and_b32 v57, 0xffff0000, v26
  v_lshlrev_b32 v58, 16, v27
  v_and_b32 v59, 0xffff0000, v27
  v_sub_f32 v52, v52, v44
  v_cvt_pk_bf16_f32 v52, v52, v52
  v_and_b32 v52, 0xffff0000, v52
  v_mul_f32 v48, v52, v45
  v_fma_f32 v49, -v48, v47, v52
  v_fmac_f32 v48, v49, v45
  v_cvt_pk_bf16_f32 v52, v48, 0
  v_sub_f32 v53, v53, v44
  v_cvt_pk_bf16_f32 v53, v53, v53
  v_and_b32 v53, 0xffff0000, v53
  v_mul_f32 v48, v53, v45
  v_fma_f32 v49, -v48, v47, v53
  v_fmac_f32 v48, v49, v45
  v_cvt_pk_bf16_f32 v53, v48, 0
  v_sub_f32 v54, v54, v44
  v_cvt_pk_bf16_f32 v54, v54, v54
  v_and_b32 v54, 0xffff0000, v54
  v_mul_f32 v48, v54, v45
  v_fma_f32 v49, -v48, v47, v54
  v_fmac_f32 v48, v49, v45
  v_cvt_pk_bf16_f32 v54, v48, 0
  v_sub_f32 v55, v55, v44
  v_cvt_pk_bf16_f32 v55, v55, v55
  v_and_b32 v55, 0xffff0000, v55
  v_mul_f32 v48, v55, v45
  v_fma_f32 v49, -v48, v47, v55
  v_fmac_f32 v48, v49, v45
  v_cvt_pk_bf16_f32 v55, v48, 0
  v_sub_f32 v56, v56, v44
  v_cvt_pk_bf16_f32 v56, v56, v56
  v_and_b32 v56, 0xffff0000, v56
  v_mul_f32 v48, v56, v45
  v_fma_f32 v49, -v48, v47, v56
  v_fmac_f32 v48, v49, v45
  v_cvt_pk_bf16_f32 v56, v48, 0
  v_sub_f32 v57, v57, v44
  v_cvt_pk_bf16_f32 v57, v57, v57
  v_and_b32 v57, 0xffff0000, v57
  v_mul_f32 v48, v57, v45
  v_fma_f32 v49, -v48, v47, v57
  v_fmac_f32 v48, v49, v45
  v_cvt_pk_bf16_f32 v57, v48, 0
  v_sub_f32 v58, v58, v44
  v_cvt_pk_bf16_f32 v58, v58, v58
  v_and_b32 v58, 0xffff0000, v58
  v_mul_f32 v48, v58, v45
  v_fma_f32 v49, -v48, v47, v58
  v_fmac_f32 v48, v49, v45
  v_cvt_pk_bf16_f32 v58, v48, 0
  v_sub_f32 v59, v59, v44
  v_cvt_pk_bf16_f32 v59, v59, v59
  v_and_b32 v59, 0xffff0000, v59
  v_mul_f32 v48, v59, v45
  v_fma_f32 v49, -v48, v47, v59
  v_fmac_f32 v48, v49, v45
  v_cvt_pk_bf16_f32 v59, v48, 0
  ds_write_b128 v51, v[52:55] offset:24576
  ds_write_b128 v51, v[56:59] offset:24592
  v_add_u32 v50, 0x400, v50
  v_add_u32 v51, 0x800, v51
  s_sub_u32 s87, s87, 1
  s_cmp_lg_u32 s87, 0
  s_cbranch_scc1 L_ln4_4
  v_mov_b32 v64, 0
  v_mov_b32 v96, 0
  v_mov_b32 v65, 0
  v_mov_b32 v97, 0
  v_mov_b32 v66, 0
  v_mov_b32 v98, 0
  v_mov_b32 v67, 0
  v_mov_b32 v99, 0
  v_mov_b32 v68, 0
  v_mov_b32 v100, 0
  v_mov_b32 v69, 0
  v_mov_b32 v101, 0
  v_mov_b32 v70, 0
  v_mov_b32 v102, 0
  v_mov_b32 v71, 0
  v_mov_b32 v103, 0
  v_mov_b32 v72, 0
  v_mov_b32 v104, 0
  v_mov_b32 v73, 0
  v_mov_b32 v105, 0
  v_mov_b32 v74, 0
  v_mov_b32 v106, 0
  v_mov_b32 v75, 0
  v_mov_b32 v107, 0
  v_mov_b32 v76, 0
  v_mov_b32 v108, 0
  v_mov_b32 v77, 0
  v_mov_b32 v109, 0
  v_mov_b32 v78, 0
  v_mov_b32 v110, 0
  v_mov_b32 v79, 0
  v_mov_b32 v111, 0
  v_mov_b32 v80, 0
  v_mov_b32 v112, 0
  v_mov_b32 v81, 0
  v_mov_b32 v113, 0
  v_mov_b32 v82, 0
  v_mov_b32 v114, 0
  v_mov_b32 v83, 0
  v_mov_b32 v115, 0
  v_mov_b32 v84, 0
  v_mov_b32 v116, 0
  v_mov_b32 v85, 0
  v_mov_b32 v117, 0
  v_mov_b32 v86, 0
  v_mov_b32 v118, 0
  v_mov_b32 v87, 0
  v_mov_b32 v119, 0
  v_mov_b32 v88, 0
  v_mov_b32 v120, 0
  v_mov_b32 v89, 0
  v_mov_b32 v121, 0
  v_mov_b32 v90, 0
  v_mov_b32 v122, 0
  v_mov_b32 v91, 0
  v_mov_b32 v123, 0
  v_mov_b32 v92, 0
  v_mov_b32 v124, 0
  v_mov_b32 v93, 0
  v_mov_b32 v125, 0
  v_mov_b32 v94, 0
  v_mov_b32 v126, 0
  v_mov_b32 v95, 0
  v_mov_b32 v127, 0
  v_lshrrev_b32 v60, 2, v2
  s_movk_i32 s84, 2752
  v_mul_lo_u32 v61, v60, s84
  v_and_b32 v62, 3, v2
  v_lshl_add_u32 v61, v62, 4, v61
  s_lshl_b32 s85, s5, 6
  v_add_u32 v61, s85, v61
  v_lshlrev_b32 v60, 2, v60
  s_mov_b32 s88, 0
  s_mov_b32 s87, 8
  s_waitcnt lgkmcnt(0)
L_f1_5:
  buffer_load_dwordx4 v[200:203], v61, s[20:23], s88 offen
  buffer_load_dwordx4 v[204:207], v61, s[24:27], s88 offen
  s_add_u32 s88, s88, 44032
  buffer_load_dwordx4 v[208:211], v61, s[20:23], s88 offen
  buffer_load_dwordx4 v[212:215], v61, s[24:27], s88 offen
  s_add_u32 s88, s88, 44032
  ds_read_b32 v16, v60 offset:24576
  ds_read_b32 v17, v60 offset:26624
  ds_read_b32 v18, v60 offset:28672
  ds_read_b32 v19, v60 offset:30720
  ds_read_b32 v20, v60 offset:24640
  ds_read_b32 v21, v60 offset:26688
  ds_read_b32 v22, v60 offset:28736
  ds_read_b32 v23, v60 offset:30784
  s_waitcnt lgkmcnt(0)
  ds_read_b32 v24, v60 offset:24704
  ds_read_b32 v25, v60 offset:26752
  ds_read_b32 v26, v60 offset:28800
  ds_read_b32 v27, v60 offset:30848
  ds_read_b32 v28, v60 offset:24768
  ds_read_b32 v29, v60 offset:26816
  ds_read_b32 v30, v60 offset:28864
  ds_read_b32 v31, v60 offset:30912
  v_add_u32 v60, 256, v60
  s_waitcnt lgkmcnt(0)
  v_lshlrev_b32 v32, 16, v16
  v_lshlrev_b32 v33, 16, v17
  v_lshlrev_b32 v34, 16, v18
  v_lshlrev_b32 v35, 16, v19
  v_lshlrev_b32 v36, 16, v20
  v_lshlrev_b32 v37, 16, v21
  v_lshlrev_b32 v38, 16, v22
  v_lshlrev_b32 v39, 16, v23
  v_lshlrev_b32 v40, 16, v24
  v_lshlrev_b32 v41, 16, v25
  v_lshlrev_b32 v42, 16, v26
  v_lshlrev_b32 v43, 16, v27
  v_lshlrev_b32 v44, 16, v28
  v_lshlrev_b32 v45, 16, v29
  v_lshlrev_b32 v46, 16, v30
  v_lshlrev_b32 v47, 16, v31
  s_waitcnt vmcnt(2)
  buffer_load_dwordx4 v[216:219], v61, s[20:23], s88 offen
  buffer_load_dwordx4 v[220:223], v61, s[24:27], s88 offen
  s_add_u32 s88, s88, 44032
  v_dot2c_f32_bf16 v64, v16, v200
  v_dot2c_f32_bf16 v65, v32, v200
  v_dot2c_f32_bf16 v66, v16, v201
  v_dot2c_f32_bf16 v67, v32, v201
  v_dot2c_f32_bf16 v68, v16, v202
  v_dot2c_f32_bf16 v69, v32, v202
  v_dot2c_f32_bf16 v70, v16, v203
  v_dot2c_f32_bf16 v71, v32, v203
  v_dot2c_f32_bf16 v96, v16, v204
  v_dot2c_f32_bf16 v97, v32, v204
  v_dot2c_f32_bf16 v98, v16, v205
  v_dot2c_f32_bf16 v99, v32, v205
  v_dot2c_f32_bf16 v100, v16, v206
  v_dot2c_f32_bf16 v101, v32, v206
  v_dot2c_f32_bf16 v102, v16, v207
  v_dot2c_f32_bf16 v103, v32, v207
  v_dot2c_f32_bf16 v72, v17, v200
  v_dot2c_f32_bf16 v73, v33, v200
  v_dot2c_f32_bf16 v74, v17, v201
  v_dot2c_f32_bf16 v75, v33, v201
  v_dot2c_f32_bf16 v76, v17, v202
  v_dot2c_f32_bf16 v77, v33, v202
  v_dot2c_f32_bf16 v78, v17, v203
  v_dot2c_f32_bf16 v79, v33, v203
  v_dot2c_f32_bf16 v104, v17, v204
  v_dot2c_f32_bf16 v105, v33, v204
  v_dot2c_f32_bf16 v106, v17, v205
  v_dot2c_f32_bf16 v107, v33, v205
  v_dot2c_f32_bf16 v108, v17, v206
  v_dot2c_f32_bf16 v109, v33, v206
  v_dot2c_f32_bf16 v110, v17, v207
  v_dot2c_f32_bf16 v111, v33, v207
  v_dot2c_f32_bf16 v80, v18, v200
  v_dot2c_f32_bf16 v81, v34, v200
  v_dot2c_f32_bf16 v82, v18, v201
  v_dot2c_f32_bf16 v83, v34, v201
  v_dot2c_f32_bf16 v84, v18, v202
  v_dot2c_f32_bf16 v85, v34, v202
  v_dot2c_f32_bf16 v86, v18, v203
  v_dot2c_f32_bf16 v87, v34, v203
  v_dot2c_f32_bf16 v112, v18, v204
  v_dot2c_f32_bf16 v113, v34, v204
  v_dot2c_f32_bf16 v114, v18, v205
  v_dot2c_f32_bf16 v115, v34, v205
  v_dot2c_f32_bf16 v116, v18, v206
  v_dot2c_f32_bf16 v117, v34, v206
  v_dot2c_f32_bf16 v118, v18, v207
  v_dot2c_f32_bf16 v119, v34, v207
  v_dot2c_f32_bf16 v88, v19, v200
  v_dot2c_f32_bf16 v89, v35, v200
  v_dot2c_f32_bf16 v90, v19, v201
  v_dot2c_f32_bf16 v91, v35, v201
  v_dot2c_f32_bf16 v92, v19, v202
  v_dot2c_f32_bf16 v93, v35, v202
  v_dot2c_f32_bf16 v94, v19, v203
  v_dot2c_f32_bf16 v95, v35, v203
  v_dot2c_f32_bf16 v120, v19, v204
  v_dot2c_f32_bf16 v121, v35, v204
  v_dot2c_f32_bf16 v122, v19, v205
  v_dot2c_f32_bf16 v123, v35, v205
  v_dot2c_f32_bf16 v124, v19, v206
  v_dot2c_f32_bf16 v125, v35, v206
  v_dot2c_f32_bf16 v126, v19, v207
  v_dot2c_f32_bf16 v127, v35, v207
  s_waitcnt vmcnt(2)
  buffer_load_dwordx4 v[224:227], v61, s[20:23], s88 offen
  buffer_load_dwordx4 v[228:231], v61, s[24:27], s88 offen
  s_add_u32 s88, s88, 44032
  v_dot2c_f32_bf16 v64, v20, v208
  v_dot2c_f32_bf16 v65, v36, v208
  v_dot2c_f32_bf16 v66, v20, v209
  v_dot2c_f32_bf16 v67, v36, v209
  v_dot2c_f32_bf16 v68, v20, v210
  v_dot2c_f32_bf16 v69, v36, v210
  v_dot2c_f32_bf16 v70, v20, v211
  v_dot2c_f32_bf16 v71, v36, v211
  v_dot2c_f32_bf16 v96, v20, v212
  v_dot2c_f32_bf16 v97, v36, v212
  v_dot2c_f32_bf16 v98, v20, v213
  v_dot2c_f32_bf16 v99, v36, v213
  v_dot2c_f32_bf16 v100, v20, v214
  v_dot2c_f32_bf16 v101, v36, v214
  v_dot2c_f32_bf16 v102, v20, v215
  v_dot2c_f32_bf16 v103, v36, v215
  v_dot2c_f32_bf16 v72, v21, v208
  v_dot2c_f32_bf16 v73, v37, v208
  v_dot2c_f32_bf16 v74, v21, v209
  v_dot2c_f32_bf16 v75, v37, v209
  v_dot2c_f32_bf16 v76, v21, v210
  v_dot2c_f32_bf16 v77, v37, v210
  v_dot2c_f32_bf16 v78, v21, v211
  v_dot2c_f32_bf16 v79, v37, v211
  v_dot2c_f32_bf16 v104, v21, v212
  v_dot2c_f32_bf16 v105, v37, v212
  v_dot2c_f32_bf16 v106, v21, v213
  v_dot2c_f32_bf16 v107, v37, v213
  v_dot2c_f32_bf16 v108, v21, v214
  v_dot2c_f32_bf16 v109, v37, v214
  v_dot2c_f32_bf16 v110, v21, v215
  v_dot2c_f32_bf16 v111, v37, v215
  v_dot2c_f32_bf16 v80, v22, v208
  v_dot2c_f32_bf16 v81, v38, v208
  v_dot2c_f32_bf16 v82, v22, v209
  v_dot2c_f32_bf16 v83, v38, v209
  v_dot2c_f32_bf16 v84, v22, v210
  v_dot2c_f32_bf16 v85, v38, v210
  v_dot2c_f32_bf16 v86, v22, v211
  v_dot2c_f32_bf16 v87, v38, v211
  v_dot2c_f32_bf16 v112, v22, v212
  v_dot2c_f32_bf16 v113, v38, v212
  v_dot2c_f32_bf16 v114, v22, v213
  v_dot2c_f32_bf16 v115, v38, v213
  v_dot2c_f32_bf16 v116, v22, v214
  v_dot2c_f32_bf16 v117, v38, v214
  v_dot2c_f32_bf16 v118, v22, v215
  v_dot2c_f32_bf16 v119, v38, v215
  v_dot2c_f32_bf16 v88, v23, v208
  v_dot2c_f32_bf16 v89, v39, v208
  v_dot2c_f32_bf16 v90, v23, v209
  v_dot2c_f32_bf16 v91, v39, v209
  v_dot2c_f32_bf16 v92, v23, v210
  v_dot2c_f32_bf16 v93, v39, v210
  v_dot2c_f32_bf16 v94, v23, v211
  v_dot2c_f32_bf16 v95, v39, v211
  v_dot2c_f32_bf16 v120, v23, v212
  v_dot2c_f32_bf16 v121, v39, v212
  v_dot2c_f32_bf16 v122, v23, v213
  v_dot2c_f32_bf16 v123, v39, v213
  v_dot2c_f32_bf16 v124, v23, v214
  v_dot2c_f32_bf16 v125, v39, v214
  v_dot2c_f32_bf16 v126, v23, v215
  v_dot2c_f32_bf16 v127, v39, v215
  s_waitcnt vmcnt(2)
  v_dot2c_f32_bf16 v64, v24, v216
  v_dot2c_f32_bf16 v65, v40, v216
  v_dot2c_f32_bf16 v66, v24, v217
  v_dot2c_f32_bf16 v67, v40, v217
  v_dot2c_f32_bf16 v68, v24, v218
  v_dot2c_f32_bf16 v69, v40, v218
  v_dot2c_f32_bf16 v70, v24, v219
  v_dot2c_f32_bf16 v71, v40, v219
  v_dot2c_f32_bf16 v96, v24, v220
  v_dot2c_f32_bf16 v97, v40, v220
  v_dot2c_f32_bf16 v98, v24, v221
  v_dot2c_f32_bf16 v99, v40, v221
  v_dot2c_f32_bf16 v100, v24, v222
  v_dot2c_f32_bf16 v101, v40, v222
  v_dot2c_f32_bf16 v102, v24, v223
  v_dot2c_f32_bf16 v103, v40, v223
  v_dot2c_f32_bf16 v72, v25, v216
  v_dot2c_f32_bf16 v73, v41, v216
  v_dot2c_f32_bf16 v74, v25, v217
  v_dot2c_f32_bf16 v75, v41, v217
  v_dot2c_f32_bf16 v76, v25, v218
  v_dot2c_f32_bf16 v77, v41, v218
  v_dot2c_f32_bf16 v78, v25, v219
  v_dot2c_f32_bf16 v79, v41, v219
  v_dot2c_f32_bf16 v104, v25, v220
  v_dot2c_f32_bf16 v105, v41, v220
  v_dot2c_f32_bf16 v106, v25, v221
  v_dot2c_f32_bf16 v107, v41, v221
  v_dot2c_f32_bf16 v108, v25, v222
  v_dot2c_f32_bf16 v109, v41, v222
  v_dot2c_f32_bf16 v110, v25, v223
  v_dot2c_f32_bf16 v111, v41, v223
  v_dot2c_f32_bf16 v80, v26, v216
  v_dot2c_f32_bf16 v81, v42, v216
  v_dot2c_f32_bf16 v82, v26, v217
  v_dot2c_f32_bf16 v83, v42, v217
  v_dot2c_f32_bf16 v84, v26, v218
  v_dot2c_f32_bf16 v85, v42, v218
  v_dot2c_f32_bf16 v86, v26, v219
  v_dot2c_f32_bf16 v87, v42, v219
  v_dot2c_f32_bf16 v112, v26, v220
  v_dot2c_f32_bf16 v113, v42, v220
  v_dot2c_f32_bf16 v114, v26, v221
  v_dot2c_f32_bf16 v115, v42, v221
  v_dot2c_f32_bf16 v116, v26, v222
  v_dot2c_f32_bf16 v117, v42, v222
  v_dot2c_f32_bf16 v118, v26, v223
  v_dot2c_f32_bf16 v119, v42, v223
  v_dot2c_f32_bf16 v88, v27, v216
  v_dot2c_f32_bf16 v89, v43, v216
  v_dot2c_f32_bf16 v90, v27, v217
  v_dot2c_f32_bf16 v91, v43, v217
  v_dot2c_f32_bf16 v92, v27, v218
  v_dot2c_f32_bf16 v93, v43, v218
  v_dot2c_f32_bf16 v94, v27, v219
  v_dot2c_f32_bf16 v95, v43, v219
  v_dot2c_f32_bf16 v120, v27, v220
  v_dot2c_f32_bf16 v121, v43, v220
  v_dot2c_f32_bf16 v122, v27, v221
  v_dot2c_f32_bf16 v123, v43, v221
  v_dot2c_f32_bf16 v124, v27, v222
  v_dot2c_f32_bf16 v125, v43, v222
  v_dot2c_f32_bf16 v126, v27, v223
  v_dot2c_f32_bf16 v127, v43, v223
  s_waitcnt vmcnt(0)
  v_dot2c_f32_bf16 v64, v28, v224
  v_dot2c_f32_bf16 v65, v44, v224
  v_dot2c_f32_bf16 v66, v28, v225
  v_dot2c_f32_bf16 v67, v44, v225
  v_dot2c_f32_bf16 v68, v28, v226
  v_dot2c_f32_bf16 v69, v44, v226
  v_dot2c_f32_bf16 v70, v28, v227
  v_dot2c_f32_bf16 v71, v44, v227
  v_dot2c_f32_bf16 v96, v28, v228
  v_dot2c_f32_bf16 v97, v44, v228
  v_dot2c_f32_bf16 v98, v28, v229
  v_dot2c_f32_bf16 v99, v44, v229
  v_dot2c_f32_bf16 v100, v28, v230
  v_dot2c_f32_bf16 v101, v44, v230
  v_dot2c_f32_bf16 v102, v28, v231
  v_dot2c_f32_bf16 v103, v44, v231
  v_dot2c_f32_bf16 v72, v29, v224
  v_dot2c_f32_bf16 v73, v45, v224
  v_dot2c_f32_bf16 v74, v29, v225
  v_dot2c_f32_bf16 v75, v45, v225
  v_dot2c_f32_bf16 v76, v29, v226
  v_dot2c_f32_bf16 v77, v45, v226
  v_dot2c_f32_bf16 v78, v29, v227
  v_dot2c_f32_bf16 v79, v45, v227
  v_dot2c_f32_bf16 v104, v29, v228
  v_dot2c_f32_bf16 v105, v45, v228
  v_dot2c_f32_bf16 v106, v29, v229
  v_dot2c_f32_bf16 v107, v45, v229
  v_dot2c_f32_bf16 v108, v29, v230
  v_dot2c_f32_bf16 v109, v45, v230
  v_dot2c_f32_bf16 v110, v29, v231
  v_dot2c_f32_bf16 v111, v45, v231
  v_dot2c_f32_bf16 v80, v30, v224
  v_dot2c_f32_bf16 v81, v46, v224
  v_dot2c_f32_bf16 v82, v30, v225
  v_dot2c_f32_bf16 v83, v46, v225
  v_dot2c_f32_bf16 v84, v30, v226
  v_dot2c_f32_bf16 v85, v46, v226
  v_dot2c_f32_bf16 v86, v30, v227
  v_dot2c_f32_bf16 v87, v46, v227
  v_dot2c_f32_bf16 v112, v30, v228
  v_dot2c_f32_bf16 v113, v46, v228
  v_dot2c_f32_bf16 v114, v30, v229
  v_dot2c_f32_bf16 v115, v46, v229
  v_dot2c_f32_bf16 v116, v30, v230
  v_dot2c_f32_bf16 v117, v46, v230
  v_dot2c_f32_bf16 v118, v30, v231
  v_dot2c_f32_bf16 v119, v46, v231
  v_dot2c_f32_bf16 v88, v31, v224
  v_dot2c_f32_bf16 v89, v47, v224
  v_dot2c_f32_bf16 v90, v31, v225
  v_dot2c_f32_bf16 v91, v47, v225
  v_dot2c_f32_bf16 v92, v31, v226
  v_dot2c_f32_bf16 v93, v47, v226
  v_dot2c_f32_bf16 v94, v31, v227
  v_dot2c_f32_bf16 v95, v47, v227
  v_dot2c_f32_bf16 v120, v31, v228
  v_dot2c_f32_bf16 v121, v47, v228
  v_dot2c_f32_bf16 v122, v31, v229
  v_dot2c_f32_bf16 v123, v47, v229
  v_dot2c_f32_bf16 v124, v31, v230
  v_dot2c_f32_bf16 v125, v47, v230
  v_dot2c_f32_bf16 v126, v31, v231
  v_dot2c_f32_bf16 v127, v47, v231
  s_sub_u32 s87, s87, 1
  s_cmp_lg_u32 s87, 0
  s_cbranch_scc1 L_f1_5
  v_and_b32 v44, 3, v2
  v_lshlrev_b32 v44, 3, v44
  v_bfe_u32 v45, v2, 2, 2
  v_add_u32 v44, v44, v45
  v_bfe_u32 v45, v2, 4, 1
  v_lshl_add_u32 v44, v45, 2, v44
  v_lshlrev_b32 v44, 2, v44
  v_permlane32_swap_b32 v64, v96
  v_permlane32_swap_b32 v65, v97
  v_permlane32_swap_b32 v66, v98
  v_permlane32_swap_b32 v67, v99
  v_permlane32_swap_b32 v68, v100
  v_permlane32_swap_b32 v69, v101
  v_permlane32_swap_b32 v70, v102
  v_permlane32_swap_b32 v71, v103
  v_add_f32 v64, v64, v96
  v_add_f32 v65, v65, v97
  v_add_f32 v66, v66, v98
  v_add_f32 v67, v67, v99
  v_add_f32 v68, v68, v100
  v_add_f32 v69, v69, v101
  v_add_f32 v70, v70, v102
  v_add_f32 v71, v71, v103
  v_permlane16_swap_b32 v64, v68
  v_permlane16_swap_b32 v65, v69
  v_permlane16_swap_b32 v66, v70
  v_permlane16_swap_b32 v67, v71
  v_add_f32 v64, v64, v68
  v_add_f32 v65, v65, v69
  v_add_f32 v66, v66, v70
  v_add_f32 v67, v67, v71
  s_nop 0
  v_add_f32_dpp v64, v64, v64 row_ror:8 row_mask:0xf bank_mask:0x3
  v_add_f32_dpp v64, v66, v66 row_ror:8 row_mask:0xf bank_mask:0xc
  v_add_f32_dpp v65, v65, v65 row_ror:8 row_mask:0xf bank_mask:0x3
  v_add_f32_dpp v65, v67, v67 row_ror:8 row_mask:0xf bank_mask:0xc
  s_nop 1
  v_add_f32_dpp v64, v64, v64 row_shl:4 row_mask:0xf bank_mask:0x5
  v_add_f32_dpp v64, v65, v65 row_shr:4 row_mask:0xf bank_mask:0xa
  v_mov_b32 v96, v64
  s_nop 1
  v_permlane32_swap_b32 v64, v96
  v_cvt_pk_bf16_f32 v64, v64, v64
  v_and_b32 v64, 0xffff0000, v64
  v_cvt_pk_bf16_f32 v96, v96, v96
  v_and_b32 v96, 0xffff0000, v96
  v_mul_f32 v43, v64, v64
  v_mul_f32 v43, v43, v64
  v_mul_f32 v43, 0x3d372713, v43
  v_add_f32 v43, v64, v43
  v_mul_f32 v43, 0xc0135761, v43
  v_exp_f32 v43, v43
  s_nop 0
  v_add_f32 v43, 1.0, v43
  v_rcp_f32 v43, v43
  s_nop 0
  v_mul_f32 v43, v64, v43
  v_cvt_pk_bf16_f32 v43, v43, v43
  v_and_b32 v43, 0xffff0000, v43
  v_mul_f32 v43, v43, v96
  v_cvt_pk_bf16_f32 v43, v43, 0
  s_mov_b32 exec_hi, 0
  ds_write_b32 v44, v43 offset:23040
  s_mov_b32 exec_hi, -1
  v_permlane32_swap_b32 v72, v104
  v_permlane32_swap_b32 v73, v105
  v_permlane32_swap_b32 v74, v106
  v_permlane32_swap_b32 v75, v107
  v_permlane32_swap_b32 v76, v108
  v_permlane32_swap_b32 v77, v109
  v_permlane32_swap_b32 v78, v110
  v_permlane32_swap_b32 v79, v111
  v_add_f32 v72, v72, v104
  v_add_f32 v73, v73, v105
  v_add_f32 v74, v74, v106
  v_add_f32 v75, v75, v107
  v_add_f32 v76, v76, v108
  v_add_f32 v77, v77, v109
  v_add_f32 v78, v78, v110
  v_add_f32 v79, v79, v111
  v_permlane16_swap_b32 v72, v76
  v_permlane16_swap_b32 v73, v77
  v_permlane16_swap_b32 v74, v78
  v_permlane16_swap_b32 v75, v79
  v_add_f32 v72, v72, v76
  v_add_f32 v73, v73, v77
  v_add_f32 v74, v74, v78
  v_add_f32 v75, v75, v79
  s_nop 0
  v_add_f32_dpp v72, v72, v72 row_ror:8 row_mask:0xf bank_mask:0x3
  v_add_f32_dpp v72, v74, v74 row_ror:8 row_mask:0xf bank_mask:0xc
  v_add_f32_dpp v73, v73, v73 row_ror:8 row_mask:0xf bank_mask:0x3
  v_add_f32_dpp v73, v75, v75 row_ror:8 row_mask:0xf bank_mask:0xc
  s_nop 1
  v_add_f32_dpp v72, v72, v72 row_shl:4 row_mask:0xf bank_mask:0x5
  v_add_f32_dpp v72, v73, v73 row_shr:4 row_mask:0xf bank_mask:0xa
  v_mov_b32 v104, v72
  s_nop 1
  v_permlane32_swap_b32 v72, v104
  v_cvt_pk_bf16_f32 v72, v72, v72
  v_and_b32 v72, 0xffff0000, v72
  v_cvt_pk_bf16_f32 v104, v104, v104
  v_and_b32 v104, 0xffff0000, v104
  v_mul_f32 v43, v72, v72
  v_mul_f32 v43, v43, v72
  v_mul_f32 v43, 0x3d372713, v43
  v_add_f32 v43, v72, v43
  v_mul_f32 v43, 0xc0135761, v43
  v_exp_f32 v43, v43
  s_nop 0
  v_add_f32 v43, 1.0, v43
  v_rcp_f32 v43, v43
  s_nop 0
  v_mul_f32 v43, v72, v43
  v_cvt_pk_bf16_f32 v43, v43, v43
  v_and_b32 v43, 0xffff0000, v43
  v_mul_f32 v43, v43, v104
  v_cvt_pk_bf16_f32 v43, v43, 0
  s_mov_b32 exec_hi, 0
  ds_write_b32 v44, v43 offset:23168
  s_mov_b32 exec_hi, -1
  v_permlane32_swap_b32 v80, v112
  v_permlane32_swap_b32 v81, v113
  v_permlane32_swap_b32 v82, v114
  v_permlane32_swap_b32 v83, v115
  v_permlane32_swap_b32 v84, v116
  v_permlane32_swap_b32 v85, v117
  v_permlane32_swap_b32 v86, v118
  v_permlane32_swap_b32 v87, v119
  v_add_f32 v80, v80, v112
  v_add_f32 v81, v81, v113
  v_add_f32 v82, v82, v114
  v_add_f32 v83, v83, v115
  v_add_f32 v84, v84, v116
  v_add_f32 v85, v85, v117
  v_add_f32 v86, v86, v118
  v_add_f32 v87, v87, v119
  v_permlane16_swap_b32 v80, v84
  v_permlane16_swap_b32 v81, v85
  v_permlane16_swap_b32 v82, v86
  v_permlane16_swap_b32 v83, v87
  v_add_f32 v80, v80, v84
  v_add_f32 v81, v81, v85
  v_add_f32 v82, v82, v86
  v_add_f32 v83, v83, v87
  s_nop 0
  v_add_f32_dpp v80, v80, v80 row_ror:8 row_mask:0xf bank_mask:0x3
  v_add_f32_dpp v80, v82, v82 row_ror:8 row_mask:0xf bank_mask:0xc
  v_add_f32_dpp v81, v81, v81 row_ror:8 row_mask:0xf bank_mask:0x3
  v_add_f32_dpp v81, v83, v83 row_ror:8 row_mask:0xf bank_mask:0xc
  s_nop 1
  v_add_f32_dpp v80, v80, v80 row_shl:4 row_mask:0xf bank_mask:0x5
  v_add_f32_dpp v80, v81, v81 row_shr:4 row_mask:0xf bank_mask:0xa
  v_mov_b32 v112, v80
  s_nop 1
  v_permlane32_swap_b32 v80, v112
  v_cvt_pk_bf16_f32 v80, v80, v80
  v_and_b32 v80, 0xffff0000, v80
  v_cvt_pk_bf16_f32 v112, v112, v112
  v_and_b32 v112, 0xffff0000, v112
  v_mul_f32 v43, v80, v80
  v_mul_f32 v43, v43, v80
  v_mul_f32 v43, 0x3d372713, v43
  v_add_f32 v43, v80, v43
  v_mul_f32 v43, 0xc0135761, v43
  v_exp_f32 v43, v43
  s_nop 0
  v_add_f32 v43, 1.0, v43
  v_rcp_f32 v43, v43
  s_nop 0
  v_mul_f32 v43, v80, v43
  v_cvt_pk_bf16_f32 v43, v43, v43
  v_and_b32 v43, 0xffff0000, v43
  v_mul_f32 v43, v43, v112
  v_cvt_pk_bf16_f32 v43, v43, 0
  s_mov_b32 exec_hi, 0
  ds_write_b32 v44, v43 offset:23296
  s_mov_b32 exec_hi, -1
  v_permlane32_swap_b32 v88, v120
  v_permlane32_swap_b32 v89, v121
  v_permlane32_swap_b32 v90, v122
  v_permlane32_swap_b32 v91, v123
  v_permlane32_swap_b32 v92, v124
  v_permlane32_swap_b32 v93, v125
  v_permlane32_swap_b32 v94, v126
  v_permlane32_swap_b32 v95, v127
  v_add_f32 v88, v88, v120
  v_add_f32 v89, v89, v121
  v_add_f32 v90, v90, v122
  v_add_f32 v91, v91, v123
  v_add_f32 v92, v92, v124
  v_add_f32 v93, v93, v125
  v_add_f32 v94, v94, v126
  v_add_f32 v95, v95, v127
  v_permlane16_swap_b32 v88, v92
  v_permlane16_swap_b32 v89, v93
  v_permlane16_swap_b32 v90, v94
  v_permlane16_swap_b32 v91, v95
  v_add_f32 v88, v88, v92
  v_add_f32 v89, v89, v93
  v_add_f32 v90, v90, v94
  v_add_f32 v91, v91, v95
  s_nop 0
  v_add_f32_dpp v88, v88, v88 row_ror:8 row_mask:0xf bank_mask:0x3
  v_add_f32_dpp v88, v90, v90 row_ror:8 row_mask:0xf bank_mask:0xc
  v_add_f32_dpp v89, v89, v89 row_ror:8 row_mask:0xf bank_mask:0x3
  v_add_f32_dpp v89, v91, v91 row_ror:8 row_mask:0xf bank_mask:0xc
  s_nop 1
  v_add_f32_dpp v88, v88, v88 row_shl:4 row_mask:0xf bank_mask:0x5
  v_add_f32_dpp v88, v89, v89 row_shr:4 row_mask:0xf bank_mask:0xa
  v_mov_b32 v120, v88
  s_nop 1
  v_permlane32_swap_b32 v88, v120
  v_cvt_pk_bf16_f32 v88, v88, v88
  v_and_b32 v88, 0xffff0000, v88
  v_cvt_pk_bf16_f32 v120, v120, v120
  v_and_b32 v120, 0xffff0000, v120
  v_mul_f32 v43, v88, v88
  v_mul_f32 v43, v43, v88
  v_mul_f32 v43, 0x3d372713, v43
  v_add_f32 v43, v88, v43
  v_mul_f32 v43, 0xc0135761, v43
  v_exp_f32 v43, v43
  s_nop 0
  v_add_f32 v43, 1.0, v43
  v_rcp_f32 v43, v43
  s_nop 0
  v_mul_f32 v43, v88, v43
  v_cvt_pk_bf16_f32 v43, v43, v43
  v_and_b32 v43, 0xffff0000, v43
  v_mul_f32 v43, v43, v120
  v_cvt_pk_bf16_f32 v43, v43, 0
  s_mov_b32 exec_hi, 0
  ds_write_b32 v44, v43 offset:23424
  s_mov_b32 exec_hi, -1
  v_lshlrev_b32 v44, 2, v4
  ds_read_b32 v16, v44 offset:23040
  ds_read_b32 v17, v44 offset:23104
  ds_read_b32 v18, v44 offset:23168
  ds_read_b32 v19, v44 offset:23232
  ds_read_b32 v20, v44 offset:23296
  ds_read_b32 v21, v44 offset:23360
  ds_read_b32 v22, v44 offset:23424
  ds_read_b32 v23, v44 offset:23488
  v_mov_b32 v64, 0
  v_mov_b32 v65, 0
  v_mov_b32 v66, 0
  v_mov_b32 v67, 0
  v_mov_b32 v68, 0
  v_mov_b32 v69, 0
  v_mov_b32 v70, 0
  v_mov_b32 v71, 0
  v_mov_b32 v72, 0
  v_mov_b32 v73, 0
  v_mov_b32 v74, 0
  v_mov_b32 v75, 0
  v_mov_b32 v76, 0
  v_mov_b32 v77, 0
  v_mov_b32 v78, 0
  v_mov_b32 v79, 0
  v_mov_b32 v80, 0
  v_mov_b32 v81, 0
  v_mov_b32 v82, 0
  v_mov_b32 v83, 0
  v_mov_b32 v84, 0
  v_mov_b32 v85, 0
  v_mov_b32 v86, 0
  v_mov_b32 v87, 0
  v_mov_b32 v88, 0
  v_mov_b32 v89, 0
  v_mov_b32 v90, 0
  v_mov_b32 v91, 0
  v_mov_b32 v92, 0
  v_mov_b32 v93, 0
  v_mov_b32 v94, 0
  v_mov_b32 v95, 0
  s_waitcnt lgkmcnt(0)
  v_lshlrev_b32 v24, 16, v16
  v_lshlrev_b32 v25, 16, v17
  v_lshlrev_b32 v26, 16, v18
  v_lshlrev_b32 v27, 16, v19
  v_lshlrev_b32 v28, 16, v20
  v_lshlrev_b32 v29, 16, v21
  v_lshlrev_b32 v30, 16, v22
  v_lshlrev_b32 v31, 16, v23
  v_lshlrev_b32 v61, 4, v2
  s_lshl_b32 s88, s5, 15
  buffer_load_dwordx4 v[200:203], v61, s[28:31], s88 offen
  s_add_u32 s88, s88, 0x400
  buffer_load_dwordx4 v[204:207], v61, s[28:31], s88 offen
  s_add_u32 s88, s88, 0x400
  buffer_load_dwordx4 v[208:211], v61, s[28:31], s88 offen
  s_add_u32 s88, s88, 0x400
  buffer_load_dwordx4 v[212:215], v61, s[28:31], s88 offen
  s_add_u32 s88, s88, 0x400
  s_waitcnt vmcnt(3)
  buffer_load_dwordx4 v[216:219], v61, s[28:31], s88 offen
  s_add_u32 s88, s88, 0x400
  v_dot2c_f32_bf16_dpp v64, v16, v200 row_newbcast:0 row_mask:0xf bank_mask:0xf
  v_dot2c_f32_bf16_dpp v65, v24, v200 row_newbcast:0 row_mask:0xf bank_mask:0xf
  v_dot2c_f32_bf16_dpp v66, v16, v201 row_newbcast:0 row_mask:0xf bank_mask:0xf
  v_dot2c_f32_bf16_dpp v67, v24, v201 row_newbcast:0 row_mask:0xf bank_mask:0xf
  v_dot2c_f32_bf16_dpp v68, v16, v202 row_newbcast:0 row_mask:0xf bank_mask:0xf
  v_dot2c_f32_bf16_dpp v69, v24, v202 row_newbcast:0 row_mask:0xf bank_mask:0xf
  v_dot2c_f32_bf16_dpp v70, v16, v203 row_newbcast:0 row_mask:0xf bank_mask:0xf
  v_dot2c_f32_bf16_dpp v71, v24, v203 row_newbcast:0 row_mask:0xf bank_mask:0xf
  v_dot2c_f32_bf16_dpp v72, v18, v200 row_newbcast:0 row_mask:0xf bank_mask:0xf
  v_dot2c_f32_bf16_dpp v73, v26, v200 row_newbcast:0 row_mask:0xf bank_mask:0xf
  v_dot2c_f32_bf16_dpp v74, v18, v201 row_newbcast:0 row_mask:0xf bank_mask:0xf
  v_dot2c_f32_bf16_dpp v75, v26, v201 row_newbcast:0 row_mask:0xf bank_mask:0xf
  v_dot2c_f32_bf16_dpp v76, v18, v202 row_newbcast:0 row_mask:0xf bank_mask:0xf
  v_dot2c_f32_bf16_dpp v77, v26, v202 row_newbcast:0 row_mask:0xf bank_mask:0xf
  v_dot2c_f32_bf16_dpp v78, v18, v203 row_newbcast:0 row_mask:0xf bank_mask:0xf
  v_dot2c_f32_bf16_dpp v79, v26, v203 row_newbcast:0 row_mask:0xf bank_mask:0xf
  v_dot2c_f32_bf16_dpp v80, v20, v200 row_newbcast:0 row_mask:0xf bank_mask:0xf
  v_dot2c_f32_bf16_dpp v81, v28, v200 row_newbcast:0 row_mask:0xf bank_mask:0xf
  v_dot2c_f32_bf16_dpp v82, v20, v201 row_newbcast:0 row_mask:0xf bank_mask:0xf
  v_dot2c_f32_bf16_dpp v83, v28, v201 row_newbcast:0 row_mask:0xf bank_mask:0xf
  v_dot2c_f32_bf16_dpp v84, v20, v202 row_newbcast:0 row_mask:0xf bank_mask:0xf
  v_dot2c_f32_bf16_dpp v85, v28, v202 row_newbcast:0 row_mask:0xf bank_mask:0xf
  v_dot2c_f32_bf16_dpp v86, v20, v203 row_newbcast:0 row_mask:0xf bank_mask:0xf
  v_dot2c_f32_bf16_dpp v87, v28, v203 row_newbcast:0 row_mask:0xf bank_mask:0xf
  v_dot2c_f32_bf16_dpp v88, v22, v200 row_newbcast:0 row_mask:0xf bank_mask:0xf
  v_dot2c_f32_bf16_dpp v89, v30, v200 row_newbcast:0 row_mask:0xf bank_mask:0xf
  v_dot2c_f32_bf16_dpp v90, v22, v201 row_newbcast:0 row_mask:0xf bank_mask:0xf
  v_dot2c_f32_bf16_dpp v91, v30, v201 row_newbcast:0 row_mask:0xf bank_mask:0xf
  v_dot2c_f32_bf16_dpp v92, v22, v202 row_newbcast:0 row_mask:0xf bank_mask:0xf
  v_dot2c_f32_bf16_dpp v93, v30, v202 row_newbcast:0 row_mask:0xf bank_mask:0xf
  v_dot2c_f32_bf16_dpp v94, v22, v203 row_newbcast:0 row_mask:0xf bank_mask:0xf
  v_dot2c_f32_bf16_dpp v95, v30, v203 row_newbcast:0 row_mask:0xf bank_mask:0xf
  s_waitcnt vmcnt(3)
  buffer_load_dwordx4 v[220:223], v61, s[28:31], s88 offen
  s_add_u32 s88, s88, 0x400
  v_dot2c_f32_bf16_dpp v64, v16, v204 row_newbcast:1 row_mask:0xf bank_mask:0xf
  v_dot2c_f32_bf16_dpp v65, v24, v204 row_newbcast:1 row_mask:0xf bank_mask:0xf
  v_dot2c_f32_bf16_dpp v66, v16, v205 row_newbcast:1 row_mask:0xf bank_mask:0xf
  v_dot2c_f32_bf16_dpp v67, v24, v205 row_newbcast:1 row_mask:0xf bank_mask:0xf
  v_dot2c_f32_bf16_dpp v68, v16, v206 row_newbcast:1 row_mask:0xf bank_mask:0xf
  v_dot2c_f32_bf16_dpp v69, v24, v206 row_newbcast:1 row_mask:0xf bank_mask:0xf
  v_dot2c_f32_bf16_dpp v70, v16, v207 row_newbcast:1 row_mask:0xf bank_mask:0xf
  v_dot2c_f32_bf16_dpp v71, v24, v207 row_newbcast:1 row_mask:0xf bank_mask:0xf
  v_dot2c_f32_bf16_dpp v72, v18, v204 row_newbcast:1 row_mask:0xf bank_mask:0xf
  v_dot2c_f32_bf16_dpp v73, v26, v204 row_newbcast:1 row_mask:0xf bank_mask:0xf
  v_dot2c_f32_bf16_dpp v74, v18, v205 row_newbcast:1 row_mask:0xf bank_mask:0xf
  v_dot2c_f32_bf16_dpp v75, v26, v205 row_newbcast:1 row_mask:0xf bank_mask:0xf
  v_dot2c_f32_bf16_dpp v76, v18, v206 row_newbcast:1 row_mask:0xf bank_mask:0xf
  v_dot2c_f32_bf16_dpp v77, v26, v206 row_newbcast:1 row_mask:0xf bank_mask:0xf
  v_dot2c_f32_bf16_dpp v78, v18, v207 row_newbcast:1 row_mask:0xf bank_mask:0xf
  v_dot2c_f32_bf16_dpp v79, v26, v207 row_newbcast:1 row_mask:0xf bank_mask:0xf
  v_dot2c_f32_bf16_dpp v80, v20, v204 row_newbcast:1 row_mask:0xf bank_mask:0xf
  v_dot2c_f32_bf16_dpp v81, v28, v204 row_newbcast:1 row_mask:0xf bank_mask:0xf
  v_dot2c_f32_bf16_dpp v82, v20, v205 row_newbcast:1 row_mask:0xf bank_mask:0xf
  v_dot2c_f32_bf16_dpp v83, v28, v205 row_newbcast:1 row_mask:0xf bank_mask:0xf
  v_dot2c_f32_bf16_dpp v84, v20, v206 row_newbcast:1 row_mask:0xf bank_mask:0xf
  v_dot2c_f32_bf16_dpp v85, v28, v206 row_newbcast:1 row_mask:0xf bank_mask:0xf
  v_dot2c_f32_bf16_dpp v86, v20, v207 row_newbcast:1 row_mask:0xf bank_mask:0xf
  v_dot2c_f32_bf16_dpp v87, v28, v207 row_newbcast:1 row_mask:0xf bank_mask:0xf
  v_dot2c_f32_bf16_dpp v88, v22, v204 row_newbcast:1 row_mask:0xf bank_mask:0xf
  v_dot2c_f32_bf16_dpp v89, v30, v204 row_newbcast:1 row_mask:0xf bank_mask:0xf
  v_dot2c_f32_bf16_dpp v90, v22, v205 row_newbcast:1 row_mask:0xf bank_mask:0xf
  v_dot2c_f32_bf16_dpp v91, v30, v205 row_newbcast:1 row_mask:0xf bank_mask:0xf
  v_dot2c_f32_bf16_dpp v92, v22, v206 row_newbcast:1 row_mask:0xf bank_mask:0xf
  v_dot2c_f32_bf16_dpp v93, v30, v206 row_newbcast:1 row_mask:0xf bank_mask:0xf
  v_dot2c_f32_bf16_dpp v94, v22, v207 row_newbcast:1 row_mask:0xf bank_mask:0xf
  v_dot2c_f32_bf16_dpp v95, v30, v207 row_newbcast:1 row_mask:0xf bank_mask:0xf
  s_waitcnt vmcnt(3)
  buffer_load_dwordx4 v[224:227], v61, s[28:31], s88 offen
  s_add_u32 s88, s88, 0x400
  v_dot2c_f32_bf16_dpp v64, v16, v208 row_newbcast:2 row_mask:0xf bank_mask:0xf
  v_dot2c_f32_bf16_dpp v65, v24, v208 row_newbcast:2 row_mask:0xf bank_mask:0xf
  v_dot2c_f32_bf16_dpp v66, v16, v209 row_newbcast:2 row_mask:0xf bank_mask:0xf
  v_dot2c_f32_bf16_dpp v67, v24, v209 row_newbcast:2 row_mask:0xf bank_mask:0xf
  v_dot2c_f32_bf16_dpp v68, v16, v210 row_newbcast:2 row_mask:0xf bank_mask:0xf
  v_dot2c_f32_bf16_dpp v69, v24, v210 row_newbcast:2 row_mask:0xf bank_mask:0xf
  v_dot2c_f32_bf16_dpp v70, v16, v211 row_newbcast:2 row_mask:0xf bank_mask:0xf
  v_dot2c_f32_bf16_dpp v71, v24, v211 row_newbcast:2 row_mask:0xf bank_mask:0xf
  v_dot2c_f32_bf16_dpp v72, v18, v208 row_newbcast:2 row_mask:0xf bank_mask:0xf
  v_dot2c_f32_bf16_dpp v73, v26, v208 row_newbcast:2 row_mask:0xf bank_mask:0xf
  v_dot2c_f32_bf16_dpp v74, v18, v209 row_newbcast:2 row_mask:0xf bank_mask:0xf
  v_dot2c_f32_bf16_dpp v75, v26, v209 row_newbcast:2 row_mask:0xf bank_mask:0xf
  v_dot2c_f32_bf16_dpp v76, v18, v210 row_newbcast:2 row_mask:0xf bank_mask:0xf
  v_dot2c_f32_bf16_dpp v77, v26, v210 row_newbcast:2 row_mask:0xf bank_mask:0xf
  v_dot2c_f32_bf16_dpp v78, v18, v211 row_newbcast:2 row_mask:0xf bank_mask:0xf
  v_dot2c_f32_bf16_dpp v79, v26, v211 row_newbcast:2 row_mask:0xf bank_mask:0xf
  v_dot2c_f32_bf16_dpp v80, v20, v208 row_newbcast:2 row_mask:0xf bank_mask:0xf
  v_dot2c_f32_bf16_dpp v81, v28, v208 row_newbcast:2 row_mask:0xf bank_mask:0xf
  v_dot2c_f32_bf16_dpp v82, v20, v209 row_newbcast:2 row_mask:0xf bank_mask:0xf
  v_dot2c_f32_bf16_dpp v83, v28, v209 row_newbcast:2 row_mask:0xf bank_mask:0xf
  v_dot2c_f32_bf16_dpp v84, v20, v210 row_newbcast:2 row_mask:0xf bank_mask:0xf
  v_dot2c_f32_bf16_dpp v85, v28, v210 row_newbcast:2 row_mask:0xf bank_mask:0xf
  v_dot2c_f32_bf16_dpp v86, v20, v211 row_newbcast:2 row_mask:0xf bank_mask:0xf
  v_dot2c_f32_bf16_dpp v87, v28, v211 row_newbcast:2 row_mask:0xf bank_mask:0xf
  v_dot2c_f32_bf16_dpp v88, v22, v208 row_newbcast:2 row_mask:0xf bank_mask:0xf
  v_dot2c_f32_bf16_dpp v89, v30, v208 row_newbcast:2 row_mask:0xf bank_mask:0xf
  v_dot2c_f32_bf16_dpp v90, v22, v209 row_newbcast:2 row_mask:0xf bank_mask:0xf
  v_dot2c_f32_bf16_dpp v91, v30, v209 row_newbcast:2 row_mask:0xf bank_mask:0xf
  v_dot2c_f32_bf16_dpp v92, v22, v210 row_newbcast:2 row_mask:0xf bank_mask:0xf
  v_dot2c_f32_bf16_dpp v93, v30, v210 row_newbcast:2 row_mask:0xf bank_mask:0xf
  v_dot2c_f32_bf16_dpp v94, v22, v211 row_newbcast:2 row_mask:0xf bank_mask:0xf
  v_dot2c_f32_bf16_dpp v95, v30, v211 row_newbcast:2 row_mask:0xf bank_mask:0xf
  s_waitcnt vmcnt(3)
  buffer_load_dwordx4 v[228:231], v61, s[28:31], s88 offen
  s_add_u32 s88, s88, 0x400
  v_dot2c_f32_bf16_dpp v64, v16, v212 row_newbcast:3 row_mask:0xf bank_mask:0xf
  v_dot2c_f32_bf16_dpp v65, v24, v212 row_newbcast:3 row_mask:0xf bank_mask:0xf
  v_dot2c_f32_bf16_dpp v66, v16, v213 row_newbcast:3 row_mask:0xf bank_mask:0xf
  v_dot2c_f32_bf16_dpp v67, v24, v213 row_newbcast:3 row_mask:0xf bank_mask:0xf
  v_dot2c_f32_bf16_dpp v68, v16, v214 row_newbcast:3 row_mask:0xf bank_mask:0xf
  v_dot2c_f32_bf16_dpp v69, v24, v214 row_newbcast:3 row_mask:0xf bank_mask:0xf
  v_dot2c_f32_bf16_dpp v70, v16, v215 row_newbcast:3 row_mask:0xf bank_mask:0xf
  v_dot2c_f32_bf16_dpp v71, v24, v215 row_newbcast:3 row_mask:0xf bank_mask:0xf
  v_dot2c_f32_bf16_dpp v72, v18, v212 row_newbcast:3 row_mask:0xf bank_mask:0xf
  v_dot2c_f32_bf16_dpp v73, v26, v212 row_newbcast:3 row_mask:0xf bank_mask:0xf
  v_dot2c_f32_bf16_dpp v74, v18, v213 row_newbcast:3 row_mask:0xf bank_mask:0xf
  v_dot2c_f32_bf16_dpp v75, v26, v213 row_newbcast:3 row_mask:0xf bank_mask:0xf
  v_dot2c_f32_bf16_dpp v76, v18, v214 row_newbcast:3 row_mask:0xf bank_mask:0xf
  v_dot2c_f32_bf16_dpp v77, v26, v214 row_newbcast:3 row_mask:0xf bank_mask:0xf
  v_dot2c_f32_bf16_dpp v78, v18, v215 row_newbcast:3 row_mask:0xf bank_mask:0xf
  v_dot2c_f32_bf16_dpp v79, v26, v215 row_newbcast:3 row_mask:0xf bank_mask:0xf
  v_dot2c_f32_bf16_dpp v80, v20, v212 row_newbcast:3 row_mask:0xf bank_mask:0xf
  v_dot2c_f32_bf16_dpp v81, v28, v212 row_newbcast:3 row_mask:0xf bank_mask:0xf
  v_dot2c_f32_bf16_dpp v82, v20, v213 row_newbcast:3 row_mask:0xf bank_mask:0xf
  v_dot2c_f32_bf16_dpp v83, v28, v213 row_newbcast:3 row_mask:0xf bank_mask:0xf
  v_dot2c_f32_bf16_dpp v84, v20, v214 row_newbcast:3 row_mask:0xf bank_mask:0xf
  v_dot2c_f32_bf16_dpp v85, v28, v214 row_newbcast:3 row_mask:0xf bank_mask:0xf
  v_dot2c_f32_bf16_dpp v86, v20, v215 row_newbcast:3 row_mask:0xf bank_mask:0xf
  v_dot2c_f32_bf16_dpp v87, v28, v215 row_newbcast:3 row_mask:0xf bank_mask:0xf
  v_dot2c_f32_bf16_dpp v88, v22, v212 row_newbcast:3 row_mask:0xf bank_mask:0xf
  v_dot2c_f32_bf16_dpp v89, v30, v212 row_newbcast:3 row_mask:0xf bank_mask:0xf
  v_dot2c_f32_bf16_dpp v90, v22, v213 row_newbcast:3 row_mask:0xf bank_mask:0xf
  v_dot2c_f32_bf16_dpp v91, v30, v213 row_newbcast:3 row_mask:0xf bank_mask:0xf
  v_dot2c_f32_bf16_dpp v92, v22, v214 row_newbcast:3 row_mask:0xf bank_mask:0xf
  v_dot2c_f32_bf16_dpp v93, v30, v214 row_newbcast:3 row_mask:0xf bank_mask:0xf
  v_dot2c_f32_bf16_dpp v94, v22, v215 row_newbcast:3 row_mask:0xf bank_mask:0xf
  v_dot2c_f32_bf16_dpp v95, v30, v215 row_newbcast:3 row_mask:0xf bank_mask:0xf
  s_waitcnt vmcnt(3)
  buffer_load_dwordx4 v[200:203], v61, s[28:31], s88 offen
  s_add_u32 s88, s88, 0x400
  v_dot2c_f32_bf16_dpp v64, v16, v216 row_newbcast:4 row_mask:0xf bank_mask:0xf
  v_dot2c_f32_bf16_dpp v65, v24, v216 row_newbcast:4 row_mask:0xf bank_mask:0xf
  v_dot2c_f32_bf16_dpp v66, v16, v217 row_newbcast:4 row_mask:0xf bank_mask:0xf
  v_dot2c_f32_bf16_dpp v67, v24, v217 row_newbcast:4 row_mask:0xf bank_mask:0xf
  v_dot2c_f32_bf16_dpp v68, v16, v218 row_newbcast:4 row_mask:0xf bank_mask:0xf
  v_dot2c_f32_bf16_dpp v69, v24, v218 row_newbcast:4 row_mask:0xf bank_mask:0xf
  v_dot2c_f32_bf16_dpp v70, v16, v219 row_newbcast:4 row_mask:0xf bank_mask:0xf
  v_dot2c_f32_bf16_dpp v71, v24, v219 row_newbcast:4 row_mask:0xf bank_mask:0xf
  v_dot2c_f32_bf16_dpp v72, v18, v216 row_newbcast:4 row_mask:0xf bank_mask:0xf
  v_dot2c_f32_bf16_dpp v73, v26, v216 row_newbcast:4 row_mask:0xf bank_mask:0xf
  v_dot2c_f32_bf16_dpp v74, v18, v217 row_newbcast:4 row_mask:0xf bank_mask:0xf
  v_dot2c_f32_bf16_dpp v75, v26, v217 row_newbcast:4 row_mask:0xf bank_mask:0xf
  v_dot2c_f32_bf16_dpp v76, v18, v218 row_newbcast:4 row_mask:0xf bank_mask:0xf
  v_dot2c_f32_bf16_dpp v77, v26, v218 row_newbcast:4 row_mask:0xf bank_mask:0xf
  v_dot2c_f32_bf16_dpp v78, v18, v219 row_newbcast:4 row_mask:0xf bank_mask:0xf
  v_dot2c_f32_bf16_dpp v79, v26, v219 row_newbcast:4 row_mask:0xf bank_mask:0xf
  v_dot2c_f32_bf16_dpp v80, v20, v216 row_newbcast:4 row_mask:0xf bank_mask:0xf
  v_dot2c_f32_bf16_dpp v81, v28, v216 row_newbcast:4 row_mask:0xf bank_mask:0xf
  v_dot2c_f32_bf16_dpp v82, v20, v217 row_newbcast:4 row_mask:0xf bank_mask:0xf
  v_dot2c_f32_bf16_dpp v83, v28, v217 row_newbcast:4 row_mask:0xf bank_mask:0xf
  v_dot2c_f32_bf16_dpp v84, v20, v218 row_newbcast:4 row_mask:0xf bank_mask:0xf
  v_dot2c_f32_bf16_dpp v85, v28, v218 row_newbcast:4 row_mask:0xf bank_mask:0xf
  v_dot2c_f32_bf16_dpp v86, v20, v219 row_newbcast:4 row_mask:0xf bank_mask:0xf
  v_dot2c_f32_bf16_dpp v87, v28, v219 row_newbcast:4 row_mask:0xf bank_mask:0xf
  v_dot2c_f32_bf16_dpp v88, v22, v216 row_newbcast:4 row_mask:0xf bank_mask:0xf
  v_dot2c_f32_bf16_dpp v89, v30, v216 row_newbcast:4 row_mask:0xf bank_mask:0xf
  v_dot2c_f32_bf16_dpp v90, v22, v217 row_newbcast:4 row_mask:0xf bank_mask:0xf
  v_dot2c_f32_bf16_dpp v91, v30, v217 row_newbcast:4 row_mask:0xf bank_mask:0xf
  v_dot2c_f32_bf16_dpp v92, v22, v218 row_newbcast:4 row_mask:0xf bank_mask:0xf
  v_dot2c_f32_bf16_dpp v93, v30, v218 row_newbcast:4 row_mask:0xf bank_mask:0xf
  v_dot2c_f32_bf16_dpp v94, v22, v219 row_newbcast:4 row_mask:0xf bank_mask:0xf
  v_dot2c_f32_bf16_dpp v95, v30, v219 row_newbcast:4 row_mask:0xf bank_mask:0xf
  s_waitcnt vmcnt(3)
  buffer_load_dwordx4 v[204:207], v61, s[28:31], s88 offen
  s_add_u32 s88, s88, 0x400
  v_dot2c_f32_bf16_dpp v64, v16, v220 row_newbcast:5 row_mask:0xf bank_mask:0xf
  v_dot2c_f32_bf16_dpp v65, v24, v220 row_newbcast:5 row_mask:0xf bank_mask:0xf
  v_dot2c_f32_bf16_dpp v66, v16, v221 row_newbcast:5 row_mask:0xf bank_mask:0xf
  v_dot2c_f32_bf16_dpp v67, v24, v221 row_newbcast:5 row_mask:0xf bank_mask:0xf
  v_dot2c_f32_bf16_dpp v68, v16, v222 row_newbcast:5 row_mask:0xf bank_mask:0xf
  v_dot2c_f32_bf16_dpp v69, v24, v222 row_newbcast:5 row_mask:0xf bank_mask:0xf
  v_dot2c_f32_bf16_dpp v70, v16, v223 row_newbcast:5 row_mask:0xf bank_mask:0xf
  v_dot2c_f32_bf16_dpp v71, v24, v223 row_newbcast:5 row_mask:0xf bank_mask:0xf
  v_dot2c_f32_bf16_dpp v72, v18, v220 row_newbcast:5 row_mask:0xf bank_mask:0xf
  v_dot2c_f32_bf16_dpp v73, v26, v220 row_newbcast:5 row_mask:0xf bank_mask:0xf
  v_dot2c_f32_bf16_dpp v74, v18, v221 row_newbcast:5 row_mask:0xf bank_mask:0xf
  v_dot2c_f32_bf16_dpp v75, v26, v221 row_newbcast:5 row_mask:0xf bank_mask:0xf
  v_dot2c_f32_bf16_dpp v76, v18, v222 row_newbcast:5 row_mask:0xf bank_mask:0xf
  v_dot2c_f32_bf16_dpp v77, v26, v222 row_newbcast:5 row_mask:0xf bank_mask:0xf
  v_dot2c_f32_bf16_dpp v78, v18, v223 row_newbcast:5 row_mask:0xf bank_mask:0xf
  v_dot2c_f32_bf16_dpp v79, v26, v223 row_newbcast:5 row_mask:0xf bank_mask:0xf
  v_dot2c_f32_bf16_dpp v80, v20, v220 row_newbcast:5 row_mask:0xf bank_mask:0xf
  v_dot2c_f32_bf16_dpp v81, v28, v220 row_newbcast:5 row_mask:0xf bank_mask:0xf
  v_dot2c_f32_bf16_dpp v82, v20, v221 row_newbcast:5 row_mask:0xf bank_mask:0xf
  v_dot2c_f32_bf16_dpp v83, v28, v221 row_newbcast:5 row_mask:0xf bank_mask:0xf
  v_dot2c_f32_bf16_dpp v84, v20, v222 row_newbcast:5 row_mask:0xf bank_mask:0xf
  v_dot2c_f32_bf16_dpp v85, v28, v222 row_newbcast:5 row_mask:0xf bank_mask:0xf
  v_dot2c_f32_bf16_dpp v86, v20, v223 row_newbcast:5 row_mask:0xf bank_mask:0xf
  v_dot2c_f32_bf16_dpp v87, v28, v223 row_newbcast:5 row_mask:0xf bank_mask:0xf
  v_dot2c_f32_bf16_dpp v88, v22, v220 row_newbcast:5 row_mask:0xf bank_mask:0xf
  v_dot2c_f32_bf16_dpp v89, v30, v220 row_newbcast:5 row_mask:0xf bank_mask:0xf
  v_dot2c_f32_bf16_dpp v90, v22, v221 row_newbcast:5 row_mask:0xf bank_mask:0xf
  v_dot2c_f32_bf16_dpp v91, v30, v221 row_newbcast:5 row_mask:0xf bank_mask:0xf
  v_dot2c_f32_bf16_dpp v92, v22, v222 row_newbcast:5 row_mask:0xf bank_mask:0xf
  v_dot2c_f32_bf16_dpp v93, v30, v222 row_newbcast:5 row_mask:0xf bank_mask:0xf
  v_dot2c_f32_bf16_dpp v94, v22, v223 row_newbcast:5 row_mask:0xf bank_mask:0xf
  v_dot2c_f32_bf16_dpp v95, v30, v223 row_newbcast:5 row_mask:0xf bank_mask:0xf
  s_waitcnt vmcnt(3)
  buffer_load_dwordx4 v[208:211], v61, s[28:31], s88 offen
  s_add_u32 s88, s88, 0x400
  v_dot2c_f32_bf16_dpp v64, v16, v224 row_newbcast:6 row_mask:0xf bank_mask:0xf
  v_dot2c_f32_bf16_dpp v65, v24, v224 row_newbcast:6 row_mask:0xf bank_mask:0xf
  v_dot2c_f32_bf16_dpp v66, v16, v225 row_newbcast:6 row_mask:0xf bank_mask:0xf
  v_dot2c_f32_bf16_dpp v67, v24, v225 row_newbcast:6 row_mask:0xf bank_mask:0xf
  v_dot2c_f32_bf16_dpp v68, v16, v226 row_newbcast:6 row_mask:0xf bank_mask:0xf
  v_dot2c_f32_bf16_dpp v69, v24, v226 row_newbcast:6 row_mask:0xf bank_mask:0xf
  v_dot2c_f32_bf16_dpp v70, v16, v227 row_newbcast:6 row_mask:0xf bank_mask:0xf
  v_dot2c_f32_bf16_dpp v71, v24, v227 row_newbcast:6 row_mask:0xf bank_mask:0xf
  v_dot2c_f32_bf16_dpp v72, v18, v224 row_newbcast:6 row_mask:0xf bank_mask:0xf
  v_dot2c_f32_bf16_dpp v73, v26, v224 row_newbcast:6 row_mask:0xf bank_mask:0xf
  v_dot2c_f32_bf16_dpp v74, v18, v225 row_newbcast:6 row_mask:0xf bank_mask:0xf
  v_dot2c_f32_bf16_dpp v75, v26, v225 row_newbcast:6 row_mask:0xf bank_mask:0xf
  v_dot2c_f32_bf16_dpp v76, v18, v226 row_newbcast:6 row_mask:0xf bank_mask:0xf
  v_dot2c_f32_bf16_dpp v77, v26, v226 row_newbcast:6 row_mask:0xf bank_mask:0xf
  v_dot2c_f32_bf16_dpp v78, v18, v227 row_newbcast:6 row_mask:0xf bank_mask:0xf
  v_dot2c_f32_bf16_dpp v79, v26, v227 row_newbcast:6 row_mask:0xf bank_mask:0xf
  v_dot2c_f32_bf16_dpp v80, v20, v224 row_newbcast:6 row_mask:0xf bank_mask:0xf
  v_dot2c_f32_bf16_dpp v81, v28, v224 row_newbcast:6 row_mask:0xf bank_mask:0xf
  v_dot2c_f32_bf16_dpp v82, v20, v225 row_newbcast:6 row_mask:0xf bank_mask:0xf
  v_dot2c_f32_bf16_dpp v83, v28, v225 row_newbcast:6 row_mask:0xf bank_mask:0xf
  v_dot2c_f32_bf16_dpp v84, v20, v226 row_newbcast:6 row_mask:0xf bank_mask:0xf
  v_dot2c_f32_bf16_dpp v85, v28, v226 row_newbcast:6 row_mask:0xf bank_mask:0xf
  v_dot2c_f32_bf16_dpp v86, v20, v227 row_newbcast:6 row_mask:0xf bank_mask:0xf
  v_dot2c_f32_bf16_dpp v87, v28, v227 row_newbcast:6 row_mask:0xf bank_mask:0xf
  v_dot2c_f32_bf16_dpp v88, v22, v224 row_newbcast:6 row_mask:0xf bank_mask:0xf
  v_dot2c_f32_bf16_dpp v89, v30, v224 row_newbcast:6 row_mask:0xf bank_mask:0xf
  v_dot2c_f32_bf16_dpp v90, v22, v225 row_newbcast:6 row_mask:0xf bank_mask:0xf
  v_dot2c_f32_bf16_dpp v91, v30, v225 row_newbcast:6 row_mask:0xf bank_mask:0xf
  v_dot2c_f32_bf16_dpp v92, v22, v226 row_newbcast:6 row_mask:0xf bank_mask:0xf
  v_dot2c_f32_bf16_dpp v93, v30, v226 row_newbcast:6 row_mask:0xf bank_mask:0xf
  v_dot2c_f32_bf16_dpp v94, v22, v227 row_newbcast:6 row_mask:0xf bank_mask:0xf
  v_dot2c_f32_bf16_dpp v95, v30, v227 row_newbcast:6 row_mask:0xf bank_mask:0xf
  s_waitcnt vmcnt(3)
  buffer_load_dwordx4 v[212:215], v61, s[28:31], s88 offen
  s_add_u32 s88, s88, 0x400
  v_dot2c_f32_bf16_dpp v64, v16, v228 row_newbcast:7 row_mask:0xf bank_mask:0xf
  v_dot2c_f32_bf16_dpp v65, v24, v228 row_newbcast:7 row_mask:0xf bank_mask:0xf
  v_dot2c_f32_bf16_dpp v66, v16, v229 row_newbcast:7 row_mask:0xf bank_mask:0xf
  v_dot2c_f32_bf16_dpp v67, v24, v229 row_newbcast:7 row_mask:0xf bank_mask:0xf
  v_dot2c_f32_bf16_dpp v68, v16, v230 row_newbcast:7 row_mask:0xf bank_mask:0xf
  v_dot2c_f32_bf16_dpp v69, v24, v230 row_newbcast:7 row_mask:0xf bank_mask:0xf
  v_dot2c_f32_bf16_dpp v70, v16, v231 row_newbcast:7 row_mask:0xf bank_mask:0xf
  v_dot2c_f32_bf16_dpp v71, v24, v231 row_newbcast:7 row_mask:0xf bank_mask:0xf
  v_dot2c_f32_bf16_dpp v72, v18, v228 row_newbcast:7 row_mask:0xf bank_mask:0xf
  v_dot2c_f32_bf16_dpp v73, v26, v228 row_newbcast:7 row_mask:0xf bank_mask:0xf
  v_dot2c_f32_bf16_dpp v74, v18, v229 row_newbcast:7 row_mask:0xf bank_mask:0xf
  v_dot2c_f32_bf16_dpp v75, v26, v229 row_newbcast:7 row_mask:0xf bank_mask:0xf
  v_dot2c_f32_bf16_dpp v76, v18, v230 row_newbcast:7 row_mask:0xf bank_mask:0xf
  v_dot2c_f32_bf16_dpp v77, v26, v230 row_newbcast:7 row_mask:0xf bank_mask:0xf
  v_dot2c_f32_bf16_dpp v78, v18, v231 row_newbcast:7 row_mask:0xf bank_mask:0xf
  v_dot2c_f32_bf16_dpp v79, v26, v231 row_newbcast:7 row_mask:0xf bank_mask:0xf
  v_dot2c_f32_bf16_dpp v80, v20, v228 row_newbcast:7 row_mask:0xf bank_mask:0xf
  v_dot2c_f32_bf16_dpp v81, v28, v228 row_newbcast:7 row_mask:0xf bank_mask:0xf
  v_dot2c_f32_bf16_dpp v82, v20, v229 row_newbcast:7 row_mask:0xf bank_mask:0xf
  v_dot2c_f32_bf16_dpp v83, v28, v229 row_newbcast:7 row_mask:0xf bank_mask:0xf
  v_dot2c_f32_bf16_dpp v84, v20, v230 row_newbcast:7 row_mask:0xf bank_mask:0xf
  v_dot2c_f32_bf16_dpp v85, v28, v230 row_newbcast:7 row_mask:0xf bank_mask:0xf
  v_dot2c_f32_bf16_dpp v86, v20, v231 row_newbcast:7 row_mask:0xf bank_mask:0xf
  v_dot2c_f32_bf16_dpp v87, v28, v231 row_newbcast:7 row_mask:0xf bank_mask:0xf
  v_dot2c_f32_bf16_dpp v88, v22, v228 row_newbcast:7 row_mask:0xf bank_mask:0xf
  v_dot2c_f32_bf16_dpp v89, v30, v228 row_newbcast:7 row_mask:0xf bank_mask:0xf
  v_dot2c_f32_bf16_dpp v90, v22, v229 row_newbcast:7 row_mask:0xf bank_mask:0xf
  v_dot2c_f32_bf16_dpp v91, v30, v229 row_newbcast:7 row_mask:0xf bank_mask:0xf
  v_dot2c_f32_bf16_dpp v92, v22, v230 row_newbcast:7 row_mask:0xf bank_mask:0xf
  v_dot2c_f32_bf16_dpp v93, v30, v230 row_newbcast:7 row_mask:0xf bank_mask:0xf
  v_dot2c_f32_bf16_dpp v94, v22, v231 row_newbcast:7 row_mask:0xf bank_mask:0xf
  v_dot2c_f32_bf16_dpp v95, v30, v231 row_newbcast:7 row_mask:0xf bank_mask:0xf
  s_waitcnt vmcnt(3)
  buffer_load_dwordx4 v[216:219], v61, s[28:31], s88 offen
  s_add_u32 s88, s88, 0x400
  v_dot2c_f32_bf16_dpp v64, v16, v200 row_newbcast:8 row_mask:0xf bank_mask:0xf
  v_dot2c_f32_bf16_dpp v65, v24, v200 row_newbcast:8 row_mask:0xf bank_mask:0xf
  v_dot2c_f32_bf16_dpp v66, v16, v201 row_newbcast:8 row_mask:0xf bank_mask:0xf
  v_dot2c_f32_bf16_dpp v67, v24, v201 row_newbcast:8 row_mask:0xf bank_mask:0xf
  v_dot2c_f32_bf16_dpp v68, v16, v202 row_newbcast:8 row_mask:0xf bank_mask:0xf
  v_dot2c_f32_bf16_dpp v69, v24, v202 row_newbcast:8 row_mask:0xf bank_mask:0xf
  v_dot2c_f32_bf16_dpp v70, v16, v203 row_newbcast:8 row_mask:0xf bank_mask:0xf
  v_dot2c_f32_bf16_dpp v71, v24, v203 row_newbcast:8 row_mask:0xf bank_mask:0xf
  v_dot2c_f32_bf16_dpp v72, v18, v200 row_newbcast:8 row_mask:0xf bank_mask:0xf
  v_dot2c_f32_bf16_dpp v73, v26, v200 row_newbcast:8 row_mask:0xf bank_mask:0xf
  v_dot2c_f32_bf16_dpp v74, v18, v201 row_newbcast:8 row_mask:0xf bank_mask:0xf
  v_dot2c_f32_bf16_dpp v75, v26, v201 row_newbcast:8 row_mask:0xf bank_mask:0xf
  v_dot2c_f32_bf16_dpp v76, v18, v202 row_newbcast:8 row_mask:0xf bank_mask:0xf
  v_dot2c_f32_bf16_dpp v77, v26, v202 row_newbcast:8 row_mask:0xf bank_mask:0xf
  v_dot2c_f32_bf16_dpp v78, v18, v203 row_newbcast:8 row_mask:0xf bank_mask:0xf
  v_dot2c_f32_bf16_dpp v79, v26, v203 row_newbcast:8 row_mask:0xf bank_mask:0xf
  v_dot2c_f32_bf16_dpp v80, v20, v200 row_newbcast:8 row_mask:0xf bank_mask:0xf
  v_dot2c_f32_bf16_dpp v81, v28, v200 row_newbcast:8 row_mask:0xf bank_mask:0xf
  v_dot2c_f32_bf16_dpp v82, v20, v201 row_newbcast:8 row_mask:0xf bank_mask:0xf
  v_dot2c_f32_bf16_dpp v83, v28, v201 row_newbcast:8 row_mask:0xf bank_mask:0xf
  v_dot2c_f32_bf16_dpp v84, v20, v202 row_newbcast:8 row_mask:0xf bank_mask:0xf
  v_dot2c_f32_bf16_dpp v85, v28, v202 row_newbcast:8 row_mask:0xf bank_mask:0xf
  v_dot2c_f32_bf16_dpp v86, v20, v203 row_newbcast:8 row_mask:0xf bank_mask:0xf
  v_dot2c_f32_bf16_dpp v87, v28, v203 row_newbcast:8 row_mask:0xf bank_mask:0xf
  v_dot2c_f32_bf16_dpp v88, v22, v200 row_newbcast:8 row_mask:0xf bank_mask:0xf
  v_dot2c_f32_bf16_dpp v89, v30, v200 row_newbcast:8 row_mask:0xf bank_mask:0xf
  v_dot2c_f32_bf16_dpp v90, v22, v201 row_newbcast:8 row_mask:0xf bank_mask:0xf
  v_dot2c_f32_bf16_dpp v91, v30, v201 row_newbcast:8 row_mask:0xf bank_mask:0xf
  v_dot2c_f32_bf16_dpp v92, v22, v202 row_newbcast:8 row_mask:0xf bank_mask:0xf
  v_dot2c_f32_bf16_dpp v93, v30, v202 row_newbcast:8 row_mask:0xf bank_mask:0xf
  v_dot2c_f32_bf16_dpp v94, v22, v203 row_newbcast:8 row_mask:0xf bank_mask:0xf
  v_dot2c_f32_bf16_dpp v95, v30, v203 row_newbcast:8 row_mask:0xf bank_mask:0xf
  s_waitcnt vmcnt(3)
  buffer_load_dwordx4 v[220:223], v61, s[28:31], s88 offen
  s_add_u32 s88, s88, 0x400
  v_dot2c_f32_bf16_dpp v64, v16, v204 row_newbcast:9 row_mask:0xf bank_mask:0xf
  v_dot2c_f32_bf16_dpp v65, v24, v204 row_newbcast:9 row_mask:0xf bank_mask:0xf
  v_dot2c_f32_bf16_dpp v66, v16, v205 row_newbcast:9 row_mask:0xf bank_mask:0xf
  v_dot2c_f32_bf16_dpp v67, v24, v205 row_newbcast:9 row_mask:0xf bank_mask:0xf
  v_dot2c_f32_bf16_dpp v68, v16, v206 row_newbcast:9 row_mask:0xf bank_mask:0xf
  v_dot2c_f32_bf16_dpp v69, v24, v206 row_newbcast:9 row_mask:0xf bank_mask:0xf
  v_dot2c_f32_bf16_dpp v70, v16, v207 row_newbcast:9 row_mask:0xf bank_mask:0xf
  v_dot2c_f32_bf16_dpp v71, v24, v207 row_newbcast:9 row_mask:0xf bank_mask:0xf
  v_dot2c_f32_bf16_dpp v72, v18, v204 row_newbcast:9 row_mask:0xf bank_mask:0xf
  v_dot2c_f32_bf16_dpp v73, v26, v204 row_newbcast:9 row_mask:0xf bank_mask:0xf
  v_dot2c_f32_bf16_dpp v74, v18, v205 row_newbcast:9 row_mask:0xf bank_mask:0xf
  v_dot2c_f32_bf16_dpp v75, v26, v205 row_newbcast:9 row_mask:0xf bank_mask:0xf
  v_dot2c_f32_bf16_dpp v76, v18, v206 row_newbcast:9 row_mask:0xf bank_mask:0xf
  v_dot2c_f32_bf16_dpp v77, v26, v206 row_newbcast:9 row_mask:0xf bank_mask:0xf
  v_dot2c_f32_bf16_dpp v78, v18, v207 row_newbcast:9 row_mask:0xf bank_mask:0xf
  v_dot2c_f32_bf16_dpp v79, v26, v207 row_newbcast:9 row_mask:0xf bank_mask:0xf
  v_dot2c_f32_bf16_dpp v80, v20, v204 row_newbcast:9 row_mask:0xf bank_mask:0xf
  v_dot2c_f32_bf16_dpp v81, v28, v204 row_newbcast:9 row_mask:0xf bank_mask:0xf
  v_dot2c_f32_bf16_dpp v82, v20, v205 row_newbcast:9 row_mask:0xf bank_mask:0xf
  v_dot2c_f32_bf16_dpp v83, v28, v205 row_newbcast:9 row_mask:0xf bank_mask:0xf
  v_dot2c_f32_bf16_dpp v84, v20, v206 row_newbcast:9 row_mask:0xf bank_mask:0xf
  v_dot2c_f32_bf16_dpp v85, v28, v206 row_newbcast:9 row_mask:0xf bank_mask:0xf
  v_dot2c_f32_bf16_dpp v86, v20, v207 row_newbcast:9 row_mask:0xf bank_mask:0xf
  v_dot2c_f32_bf16_dpp v87, v28, v207 row_newbcast:9 row_mask:0xf bank_mask:0xf
  v_dot2c_f32_bf16_dpp v88, v22, v204 row_newbcast:9 row_mask:0xf bank_mask:0xf
  v_dot2c_f32_bf16_dpp v89, v30, v204 row_newbcast:9 row_mask:0xf bank_mask:0xf
  v_dot2c_f32_bf16_dpp v90, v22, v205 row_newbcast:9 row_mask:0xf bank_mask:0xf
  v_dot2c_f32_bf16_dpp v91, v30, v205 row_newbcast:9 row_mask:0xf bank_mask:0xf
  v_dot2c_f32_bf16_dpp v92, v22, v206 row_newbcast:9 row_mask:0xf bank_mask:0xf
  v_dot2c_f32_bf16_dpp v93, v30, v206 row_newbcast:9 row_mask:0xf bank_mask:0xf
  v_dot2c_f32_bf16_dpp v94, v22, v207 row_newbcast:9 row_mask:0xf bank_mask:0xf
  v_dot2c_f32_bf16_dpp v95, v30, v207 row_newbcast:9 row_mask:0xf bank_mask:0xf
  s_waitcnt vmcnt(3)
  buffer_load_dwordx4 v[224:227], v61, s[28:31], s88 offen
  s_add_u32 s88, s88, 0x400
  v_dot2c_f32_bf16_dpp v64, v16, v208 row_newbcast:10 row_mask:0xf bank_mask:0xf
  v_dot2c_f32_bf16_dpp v65, v24, v208 row_newbcast:10 row_mask:0xf bank_mask:0xf
  v_dot2c_f32_bf16_dpp v66, v16, v209 row_newbcast:10 row_mask:0xf bank_mask:0xf
  v_dot2c_f32_bf16_dpp v67, v24, v209 row_newbcast:10 row_mask:0xf bank_mask:0xf
  v_dot2c_f32_bf16_dpp v68, v16, v210 row_newbcast:10 row_mask:0xf bank_mask:0xf
  v_dot2c_f32_bf16_dpp v69, v24, v210 row_newbcast:10 row_mask:0xf bank_mask:0xf
  v_dot2c_f32_bf16_dpp v70, v16, v211 row_newbcast:10 row_mask:0xf bank_mask:0xf
  v_dot2c_f32_bf16_dpp v71, v24, v211 row_newbcast:10 row_mask:0xf bank_mask:0xf
  v_dot2c_f32_bf16_dpp v72, v18, v208 row_newbcast:10 row_mask:0xf bank_mask:0xf
  v_dot2c_f32_bf16_dpp v73, v26, v208 row_newbcast:10 row_mask:0xf bank_mask:0xf
  v_dot2c_f32_bf16_dpp v74, v18, v209 row_newbcast:10 row_mask:0xf bank_mask:0xf
  v_dot2c_f32_bf16_dpp v75, v26, v209 row_newbcast:10 row_mask:0xf bank_mask:0xf
  v_dot2c_f32_bf16_dpp v76, v18, v210 row_newbcast:10 row_mask:0xf bank_mask:0xf
  v_dot2c_f32_bf16_dpp v77, v26, v210 row_newbcast:10 row_mask:0xf bank_mask:0xf
  v_dot2c_f32_bf16_dpp v78, v18, v211 row_newbcast:10 row_mask:0xf bank_mask:0xf
  v_dot2c_f32_bf16_dpp v79, v26, v211 row_newbcast:10 row_mask:0xf bank_mask:0xf
  v_dot2c_f32_bf16_dpp v80, v20, v208 row_newbcast:10 row_mask:0xf bank_mask:0xf
  v_dot2c_f32_bf16_dpp v81, v28, v208 row_newbcast:10 row_mask:0xf bank_mask:0xf
  v_dot2c_f32_bf16_dpp v82, v20, v209 row_newbcast:10 row_mask:0xf bank_mask:0xf
  v_dot2c_f32_bf16_dpp v83, v28, v209 row_newbcast:10 row_mask:0xf bank_mask:0xf
  v_dot2c_f32_bf16_dpp v84, v20, v210 row_newbcast:10 row_mask:0xf bank_mask:0xf
  v_dot2c_f32_bf16_dpp v85, v28, v210 row_newbcast:10 row_mask:0xf bank_mask:0xf
  v_dot2c_f32_bf16_dpp v86, v20, v211 row_newbcast:10 row_mask:0xf bank_mask:0xf
  v_dot2c_f32_bf16_dpp v87, v28, v211 row_newbcast:10 row_mask:0xf bank_mask:0xf
  v_dot2c_f32_bf16_dpp v88, v22, v208 row_newbcast:10 row_mask:0xf bank_mask:0xf
  v_dot2c_f32_bf16_dpp v89, v30, v208 row_newbcast:10 row_mask:0xf bank_mask:0xf
  v_dot2c_f32_bf16_dpp v90, v22, v209 row_newbcast:10 row_mask:0xf bank_mask:0xf
  v_dot2c_f32_bf16_dpp v91, v30, v209 row_newbcast:10 row_mask:0xf bank_mask:0xf
  v_dot2c_f32_bf16_dpp v92, v22, v210 row_newbcast:10 row_mask:0xf bank_mask:0xf
  v_dot2c_f32_bf16_dpp v93, v30, v210 row_newbcast:10 row_mask:0xf bank_mask:0xf
  v_dot2c_f32_bf16_dpp v94, v22, v211 row_newbcast:10 row_mask:0xf bank_mask:0xf
  v_dot2c_f32_bf16_dpp v95, v30, v211 row_newbcast:10 row_mask:0xf bank_mask:0xf
  s_waitcnt vmcnt(3)
  buffer_load_dwordx4 v[228:231], v61, s[28:31], s88 offen
  s_add_u32 s88, s88, 0x400
  v_dot2c_f32_bf16_dpp v64, v16, v212 row_newbcast:11 row_mask:0xf bank_mask:0xf
  v_dot2c_f32_bf16_dpp v65, v24, v212 row_newbcast:11 row_mask:0xf bank_mask:0xf
  v_dot2c_f32_bf16_dpp v66, v16, v213 row_newbcast:11 row_mask:0xf bank_mask:0xf
  v_dot2c_f32_bf16_dpp v67, v24, v213 row_newbcast:11 row_mask:0xf bank_mask:0xf
  v_dot2c_f32_bf16_dpp v68, v16, v214 row_newbcast:11 row_mask:0xf bank_mask:0xf
  v_dot2c_f32_bf16_dpp v69, v24, v214 row_newbcast:11 row_mask:0xf bank_mask:0xf
  v_dot2c_f32_bf16_dpp v70, v16, v215 row_newbcast:11 row_mask:0xf bank_mask:0xf
  v_dot2c_f32_bf16_dpp v71, v24, v215 row_newbcast:11 row_mask:0xf bank_mask:0xf
  v_dot2c_f32_bf16_dpp v72, v18, v212 row_newbcast:11 row_mask:0xf bank_mask:0xf
  v_dot2c_f32_bf16_dpp v73, v26, v212 row_newbcast:11 row_mask:0xf bank_mask:0xf
  v_dot2c_f32_bf16_dpp v74, v18, v213 row_newbcast:11 row_mask:0xf bank_mask:0xf
  v_dot2c_f32_bf16_dpp v75, v26, v213 row_newbcast:11 row_mask:0xf bank_mask:0xf
  v_dot2c_f32_bf16_dpp v76, v18, v214 row_newbcast:11 row_mask:0xf bank_mask:0xf
  v_dot2c_f32_bf16_dpp v77, v26, v214 row_newbcast:11 row_mask:0xf bank_mask:0xf
  v_dot2c_f32_bf16_dpp v78, v18, v215 row_newbcast:11 row_mask:0xf bank_mask:0xf
  v_dot2c_f32_bf16_dpp v79, v26, v215 row_newbcast:11 row_mask:0xf bank_mask:0xf
  v_dot2c_f32_bf16_dpp v80, v20, v212 row_newbcast:11 row_mask:0xf bank_mask:0xf
  v_dot2c_f32_bf16_dpp v81, v28, v212 row_newbcast:11 row_mask:0xf bank_mask:0xf
  v_dot2c_f32_bf16_dpp v82, v20, v213 row_newbcast:11 row_mask:0xf bank_mask:0xf
  v_dot2c_f32_bf16_dpp v83, v28, v213 row_newbcast:11 row_mask:0xf bank_mask:0xf
  v_dot2c_f32_bf16_dpp v84, v20, v214 row_newbcast:11 row_mask:0xf bank_mask:0xf
  v_dot2c_f32_bf16_dpp v85, v28, v214 row_newbcast:11 row_mask:0xf bank_mask:0xf
  v_dot2c_f32_bf16_dpp v86, v20, v215 row_newbcast:11 row_mask:0xf bank_mask:0xf
  v_dot2c_f32_bf16_dpp v87, v28, v215 row_newbcast:11 row_mask:0xf bank_mask:0xf
  v_dot2c_f32_bf16_dpp v88, v22, v212 row_newbcast:11 row_mask:0xf bank_mask:0xf
  v_dot2c_f32_bf16_dpp v89, v30, v212 row_newbcast:11 row_mask:0xf bank_mask:0xf
  v_dot2c_f32_bf16_dpp v90, v22, v213 row_newbcast:11 row_mask:0xf bank_mask:0xf
  v_dot2c_f32_bf16_dpp v91, v30, v213 row_newbcast:11 row_mask:0xf bank_mask:0xf
  v_dot2c_f32_bf16_dpp v92, v22, v214 row_newbcast:11 row_mask:0xf bank_mask:0xf
  v_dot2c_f32_bf16_dpp v93, v30, v214 row_newbcast:11 row_mask:0xf bank_mask:0xf
  v_dot2c_f32_bf16_dpp v94, v22, v215 row_newbcast:11 row_mask:0xf bank_mask:0xf
  v_dot2c_f32_bf16_dpp v95, v30, v215 row_newbcast:11 row_mask:0xf bank_mask:0xf
  s_waitcnt vmcnt(3)
  buffer_load_dwordx4 v[200:203], v61, s[28:31], s88 offen
  s_add_u32 s88, s88, 0x400
  v_dot2c_f32_bf16_dpp v64, v16, v216 row_newbcast:12 row_mask:0xf bank_mask:0xf
  v_dot2c_f32_bf16_dpp v65, v24, v216 row_newbcast:12 row_mask:0xf bank_mask:0xf
  v_dot2c_f32_bf16_dpp v66, v16, v217 row_newbcast:12 row_mask:0xf bank_mask:0xf
  v_dot2c_f32_bf16_dpp v67, v24, v217 row_newbcast:12 row_mask:0xf bank_mask:0xf
  v_dot2c_f32_bf16_dpp v68, v16, v218 row_newbcast:12 row_mask:0xf bank_mask:0xf
  v_dot2c_f32_bf16_dpp v69, v24, v218 row_newbcast:12 row_mask:0xf bank_mask:0xf
  v_dot2c_f32_bf16_dpp v70, v16, v219 row_newbcast:12 row_mask:0xf bank_mask:0xf
  v_dot2c_f32_bf16_dpp v71, v24, v219 row_newbcast:12 row_mask:0xf bank_mask:0xf
  v_dot2c_f32_bf16_dpp v72, v18, v216 row_newbcast:12 row_mask:0xf bank_mask:0xf
  v_dot2c_f32_bf16_dpp v73, v26, v216 row_newbcast:12 row_mask:0xf bank_mask:0xf
  v_dot2c_f32_bf16_dpp v74, v18, v217 row_newbcast:12 row_mask:0xf bank_mask:0xf
  v_dot2c_f32_bf16_dpp v75, v26, v217 row_newbcast:12 row_mask:0xf bank_mask:0xf
  v_dot2c_f32_bf16_dpp v76, v18, v218 row_newbcast:12 row_mask:0xf bank_mask:0xf
  v_dot2c_f32_bf16_dpp v77, v26, v218 row_newbcast:12 row_mask:0xf bank_mask:0xf
  v_dot2c_f32_bf16_dpp v78, v18, v219 row_newbcast:12 row_mask:0xf bank_mask:0xf
  v_dot2c_f32_bf16_dpp v79, v26, v219 row_newbcast:12 row_mask:0xf bank_mask:0xf
  v_dot2c_f32_bf16_dpp v80, v20, v216 row_newbcast:12 row_mask:0xf bank_mask:0xf
  v_dot2c_f32_bf16_dpp v81, v28, v216 row_newbcast:12 row_mask:0xf bank_mask:0xf
  v_dot2c_f32_bf16_dpp v82, v20, v217 row_newbcast:12 row_mask:0xf bank_mask:0xf
  v_dot2c_f32_bf16_dpp v83, v28, v217 row_newbcast:12 row_mask:0xf bank_mask:0xf
  v_dot2c_f32_bf16_dpp v84, v20, v218 row_newbcast:12 row_mask:0xf bank_mask:0xf
  v_dot2c_f32_bf16_dpp v85, v28, v218 row_newbcast:12 row_mask:0xf bank_mask:0xf
  v_dot2c_f32_bf16_dpp v86, v20, v219 row_newbcast:12 row_mask:0xf bank_mask:0xf
  v_dot2c_f32_bf16_dpp v87, v28, v219 row_newbcast:12 row_mask:0xf bank_mask:0xf
  v_dot2c_f32_bf16_dpp v88, v22, v216 row_newbcast:12 row_mask:0xf bank_mask:0xf
  v_dot2c_f32_bf16_dpp v89, v30, v216 row_newbcast:12 row_mask:0xf bank_mask:0xf
  v_dot2c_f32_bf16_dpp v90, v22, v217 row_newbcast:12 row_mask:0xf bank_mask:0xf
  v_dot2c_f32_bf16_dpp v91, v30, v217 row_newbcast:12 row_mask:0xf bank_mask:0xf
  v_dot2c_f32_bf16_dpp v92, v22, v218 row_newbcast:12 row_mask:0xf bank_mask:0xf
  v_dot2c_f32_bf16_dpp v93, v30, v218 row_newbcast:12 row_mask:0xf bank_mask:0xf
  v_dot2c_f32_bf16_dpp v94, v22, v219 row_newbcast:12 row_mask:0xf bank_mask:0xf
  v_dot2c_f32_bf16_dpp v95, v30, v219 row_newbcast:12 row_mask:0xf bank_mask:0xf
  s_waitcnt vmcnt(3)
  buffer_load_dwordx4 v[204:207], v61, s[28:31], s88 offen
  s_add_u32 s88, s88, 0x400
  v_dot2c_f32_bf16_dpp v64, v16, v220 row_newbcast:13 row_mask:0xf bank_mask:0xf
  v_dot2c_f32_bf16_dpp v65, v24, v220 row_newbcast:13 row_mask:0xf bank_mask:0xf
  v_dot2c_f32_bf16_dpp v66, v16, v221 row_newbcast:13 row_mask:0xf bank_mask:0xf
  v_dot2c_f32_bf16_dpp v67, v24, v221 row_newbcast:13 row_mask:0xf bank_mask:0xf
  v_dot2c_f32_bf16_dpp v68, v16, v222 row_newbcast:13 row_mask:0xf bank_mask:0xf
  v_dot2c_f32_bf16_dpp v69, v24, v222 row_newbcast:13 row_mask:0xf bank_mask:0xf
  v_dot2c_f32_bf16_dpp v70, v16, v223 row_newbcast:13 row_mask:0xf bank_mask:0xf
  v_dot2c_f32_bf16_dpp v71, v24, v223 row_newbcast:13 row_mask:0xf bank_mask:0xf
  v_dot2c_f32_bf16_dpp v72, v18, v220 row_newbcast:13 row_mask:0xf bank_mask:0xf
  v_dot2c_f32_bf16_dpp v73, v26, v220 row_newbcast:13 row_mask:0xf bank_mask:0xf
  v_dot2c_f32_bf16_dpp v74, v18, v221 row_newbcast:13 row_mask:0xf bank_mask:0xf
  v_dot2c_f32_bf16_dpp v75, v26, v221 row_newbcast:13 row_mask:0xf bank_mask:0xf
  v_dot2c_f32_bf16_dpp v76, v18, v222 row_newbcast:13 row_mask:0xf bank_mask:0xf
  v_dot2c_f32_bf16_dpp v77, v26, v222 row_newbcast:13 row_mask:0xf bank_mask:0xf
  v_dot2c_f32_bf16_dpp v78, v18, v223 row_newbcast:13 row_mask:0xf bank_mask:0xf
  v_dot2c_f32_bf16_dpp v79, v26, v223 row_newbcast:13 row_mask:0xf bank_mask:0xf
  v_dot2c_f32_bf16_dpp v80, v20, v220 row_newbcast:13 row_mask:0xf bank_mask:0xf
  v_dot2c_f32_bf16_dpp v81, v28, v220 row_newbcast:13 row_mask:0xf bank_mask:0xf
  v_dot2c_f32_bf16_dpp v82, v20, v221 row_newbcast:13 row_mask:0xf bank_mask:0xf
  v_dot2c_f32_bf16_dpp v83, v28, v221 row_newbcast:13 row_mask:0xf bank_mask:0xf
  v_dot2c_f32_bf16_dpp v84, v20, v222 row_newbcast:13 row_mask:0xf bank_mask:0xf
  v_dot2c_f32_bf16_dpp v85, v28, v222 row_newbcast:13 row_mask:0xf bank_mask:0xf
  v_dot2c_f32_bf16_dpp v86, v20, v223 row_newbcast:13 row_mask:0xf bank_mask:0xf
  v_dot2c_f32_bf16_dpp v87, v28, v223 row_newbcast:13 row_mask:0xf bank_mask:0xf
  v_dot2c_f32_bf16_dpp v88, v22, v220 row_newbcast:13 row_mask:0xf bank_mask:0xf
  v_dot2c_f32_bf16_dpp v89, v30, v220 row_newbcast:13 row_mask:0xf bank_mask:0xf
  v_dot2c_f32_bf16_dpp v90, v22, v221 row_newbcast:13 row_mask:0xf bank_mask:0xf
  v_dot2c_f32_bf16_dpp v91, v30, v221 row_newbcast:13 row_mask:0xf bank_mask:0xf
  v_dot2c_f32_bf16_dpp v92, v22, v222 row_newbcast:13 row_mask:0xf bank_mask:0xf
  v_dot2c_f32_bf16_dpp v93, v30, v222 row_newbcast:13 row_mask:0xf bank_mask:0xf
  v_dot2c_f32_bf16_dpp v94, v22, v223 row_newbcast:13 row_mask:0xf bank_mask:0xf
  v_dot2c_f32_bf16_dpp v95, v30, v223 row_newbcast:13 row_mask:0xf bank_mask:0xf
  s_waitcnt vmcnt(3)
  buffer_load_dwordx4 v[208:211], v61, s[28:31], s88 offen
  s_add_u32 s88, s88, 0x400
  v_dot2c_f32_bf16_dpp v64, v16, v224 row_newbcast:14 row_mask:0xf bank_mask:0xf
  v_dot2c_f32_bf16_dpp v65, v24, v224 row_newbcast:14 row_mask:0xf bank_mask:0xf
  v_dot2c_f32_bf16_dpp v66, v16, v225 row_newbcast:14 row_mask:0xf bank_mask:0xf
  v_dot2c_f32_bf16_dpp v67, v24, v225 row_newbcast:14 row_mask:0xf bank_mask:0xf
  v_dot2c_f32_bf16_dpp v68, v16, v226 row_newbcast:14 row_mask:0xf bank_mask:0xf
  v_dot2c_f32_bf16_dpp v69, v24, v226 row_newbcast:14 row_mask:0xf bank_mask:0xf
  v_dot2c_f32_bf16_dpp v70, v16, v227 row_newbcast:14 row_mask:0xf bank_mask:0xf
  v_dot2c_f32_bf16_dpp v71, v24, v227 row_newbcast:14 row_mask:0xf bank_mask:0xf
  v_dot2c_f32_bf16_dpp v72, v18, v224 row_newbcast:14 row_mask:0xf bank_mask:0xf
  v_dot2c_f32_bf16_dpp v73, v26, v224 row_newbcast:14 row_mask:0xf bank_mask:0xf
  v_dot2c_f32_bf16_dpp v74, v18, v225 row_newbcast:14 row_mask:0xf bank_mask:0xf
  v_dot2c_f32_bf16_dpp v75, v26, v225 row_newbcast:14 row_mask:0xf bank_mask:0xf
  v_dot2c_f32_bf16_dpp v76, v18, v226 row_newbcast:14 row_mask:0xf bank_mask:0xf
  v_dot2c_f32_bf16_dpp v77, v26, v226 row_newbcast:14 row_mask:0xf bank_mask:0xf
  v_dot2c_f32_bf16_dpp v78, v18, v227 row_newbcast:14 row_mask:0xf bank_mask:0xf
  v_dot2c_f32_bf16_dpp v79, v26, v227 row_newbcast:14 row_mask:0xf bank_mask:0xf
  v_dot2c_f32_bf16_dpp v80, v20, v224 row_newbcast:14 row_mask:0xf bank_mask:0xf
  v_dot2c_f32_bf16_dpp v81, v28, v224 row_newbcast:14 row_mask:0xf bank_mask:0xf
  v_dot2c_f32_bf16_dpp v82, v20, v225 row_newbcast:14 row_mask:0xf bank_mask:0xf
  v_dot2c_f32_bf16_dpp v83, v28, v225 row_newbcast:14 row_mask:0xf bank_mask:0xf
  v_dot2c_f32_bf16_dpp v84, v20, v226 row_newbcast:14 row_mask:0xf bank_mask:0xf
  v_dot2c_f32_bf16_dpp v85, v28, v226 row_newbcast:14 row_mask:0xf bank_mask:0xf
  v_dot2c_f32_bf16_dpp v86, v20, v227 row_newbcast:14 row_mask:0xf bank_mask:0xf
  v_dot2c_f32_bf16_dpp v87, v28, v227 row_newbcast:14 row_mask:0xf bank_mask:0xf
  v_dot2c_f32_bf16_dpp v88, v22, v224 row_newbcast:14 row_mask:0xf bank_mask:0xf
  v_dot2c_f32_bf16_dpp v89, v30, v224 row_newbcast:14 row_mask:0xf bank_mask:0xf
  v_dot2c_f32_bf16_dpp v90, v22, v225 row_newbcast:14 row_mask:0xf bank_mask:0xf
  v_dot2c_f32_bf16_dpp v91, v30, v225 row_newbcast:14 row_mask:0xf bank_mask:0xf
  v_dot2c_f32_bf16_dpp v92, v22, v226 row_newbcast:14 row_mask:0xf bank_mask:0xf
  v_dot2c_f32_bf16_dpp v93, v30, v226 row_newbcast:14 row_mask:0xf bank_mask:0xf
  v_dot2c_f32_bf16_dpp v94, v22, v227 row_newbcast:14 row_mask:0xf bank_mask:0xf
  v_dot2c_f32_bf16_dpp v95, v30, v227 row_newbcast:14 row_mask:0xf bank_mask:0xf
  s_waitcnt vmcnt(3)
  buffer_load_dwordx4 v[212:215], v61, s[28:31], s88 offen
  s_add_u32 s88, s88, 0x400
  v_dot2c_f32_bf16_dpp v64, v16, v228 row_newbcast:15 row_mask:0xf bank_mask:0xf
  v_dot2c_f32_bf16_dpp v65, v24, v228 row_newbcast:15 row_mask:0xf bank_mask:0xf
  v_dot2c_f32_bf16_dpp v66, v16, v229 row_newbcast:15 row_mask:0xf bank_mask:0xf
  v_dot2c_f32_bf16_dpp v67, v24, v229 row_newbcast:15 row_mask:0xf bank_mask:0xf
  v_dot2c_f32_bf16_dpp v68, v16, v230 row_newbcast:15 row_mask:0xf bank_mask:0xf
  v_dot2c_f32_bf16_dpp v69, v24, v230 row_newbcast:15 row_mask:0xf bank_mask:0xf
  v_dot2c_f32_bf16_dpp v70, v16, v231 row_newbcast:15 row_mask:0xf bank_mask:0xf
  v_dot2c_f32_bf16_dpp v71, v24, v231 row_newbcast:15 row_mask:0xf bank_mask:0xf
  v_dot2c_f32_bf16_dpp v72, v18, v228 row_newbcast:15 row_mask:0xf bank_mask:0xf
  v_dot2c_f32_bf16_dpp v73, v26, v228 row_newbcast:15 row_mask:0xf bank_mask:0xf
  v_dot2c_f32_bf16_dpp v74, v18, v229 row_newbcast:15 row_mask:0xf bank_mask:0xf
  v_dot2c_f32_bf16_dpp v75, v26, v229 row_newbcast:15 row_mask:0xf bank_mask:0xf
  v_dot2c_f32_bf16_dpp v76, v18, v230 row_newbcast:15 row_mask:0xf bank_mask:0xf
  v_dot2c_f32_bf16_dpp v77, v26, v230 row_newbcast:15 row_mask:0xf bank_mask:0xf
  v_dot2c_f32_bf16_dpp v78, v18, v231 row_newbcast:15 row_mask:0xf bank_mask:0xf
  v_dot2c_f32_bf16_dpp v79, v26, v231 row_newbcast:15 row_mask:0xf bank_mask:0xf
  v_dot2c_f32_bf16_dpp v80, v20, v228 row_newbcast:15 row_mask:0xf bank_mask:0xf
  v_dot2c_f32_bf16_dpp v81, v28, v228 row_newbcast:15 row_mask:0xf bank_mask:0xf
  v_dot2c_f32_bf16_dpp v82, v20, v229 row_newbcast:15 row_mask:0xf bank_mask:0xf
  v_dot2c_f32_bf16_dpp v83, v28, v229 row_newbcast:15 row_mask:0xf bank_mask:0xf
  v_dot2c_f32_bf16_dpp v84, v20, v230 row_newbcast:15 row_mask:0xf bank_mask:0xf
  v_dot2c_f32_bf16_dpp v85, v28, v230 row_newbcast:15 row_mask:0xf bank_mask:0xf
  v_dot2c_f32_bf16_dpp v86, v20, v231 row_newbcast:15 row_mask:0xf bank_mask:0xf
  v_dot2c_f32_bf16_dpp v87, v28, v231 row_newbcast:15 row_mask:0xf bank_mask:0xf
  v_dot2c_f32_bf16_dpp v88, v22, v228 row_newbcast:15 row_mask:0xf bank_mask:0xf
  v_dot2c_f32_bf16_dpp v89, v30, v228 row_newbcast:15 row_mask:0xf bank_mask:0xf
  v_dot2c_f32_bf16_dpp v90, v22, v229 row_newbcast:15 row_mask:0xf bank_mask:0xf
  v_dot2c_f32_bf16_dpp v91, v30, v229 row_newbcast:15 row_mask:0xf bank_mask:0xf
  v_dot2c_f32_bf16_dpp v92, v22, v230 row_newbcast:15 row_mask:0xf bank_mask:0xf
  v_dot2c_f32_bf16_dpp v93, v30, v230 row_newbcast:15 row_mask:0xf bank_mask:0xf
  v_dot2c_f32_bf16_dpp v94, v22, v231 row_newbcast:15 row_mask:0xf bank_mask:0xf
  v_dot2c_f32_bf16_dpp v95, v30, v231 row_newbcast:15 row_mask:0xf bank_mask:0xf
  s_waitcnt vmcnt(3)
  buffer_load_dwordx4 v[216:219], v61, s[28:31], s88 offen
  s_add_u32 s88, s88, 0x400
  v_dot2c_f32_bf16_dpp v64, v17, v200 row_newbcast:0 row_mask:0xf bank_mask:0xf
  v_dot2c_f32_bf16_dpp v65, v25, v200 row_newbcast:0 row_mask:0xf bank_mask:0xf
  v_dot2c_f32_bf16_dpp v66, v17, v201 row_newbcast:0 row_mask:0xf bank_mask:0xf
  v_dot2c_f32_bf16_dpp v67, v25, v201 row_newbcast:0 row_mask:0xf bank_mask:0xf
  v_dot2c_f32_bf16_dpp v68, v17, v202 row_newbcast:0 row_mask:0xf bank_mask:0xf
  v_dot2c_f32_bf16_dpp v69, v25, v202 row_newbcast:0 row_mask:0xf bank_mask:0xf
  v_dot2c_f32_bf16_dpp v70, v17, v203 row_newbcast:0 row_mask:0xf bank_mask:0xf
  v_dot2c_f32_bf16_dpp v71, v25, v203 row_newbcast:0 row_mask:0xf bank_mask:0xf
  v_dot2c_f32_bf16_dpp v72, v19, v200 row_newbcast:0 row_mask:0xf bank_mask:0xf
  v_dot2c_f32_bf16_dpp v73, v27, v200 row_newbcast:0 row_mask:0xf bank_mask:0xf
  v_dot2c_f32_bf16_dpp v74, v19, v201 row_newbcast:0 row_mask:0xf bank_mask:0xf
  v_dot2c_f32_bf16_dpp v75, v27, v201 row_newbcast:0 row_mask:0xf bank_mask:0xf
  v_dot2c_f32_bf16_dpp v76, v19, v202 row_newbcast:0 row_mask:0xf bank_mask:0xf
  v_dot2c_f32_bf16_dpp v77, v27, v202 row_newbcast:0 row_mask:0xf bank_mask:0xf
  v_dot2c_f32_bf16_dpp v78, v19, v203 row_newbcast:0 row_mask:0xf bank_mask:0xf
  v_dot2c_f32_bf16_dpp v79, v27, v203 row_newbcast:0 row_mask:0xf bank_mask:0xf
  v_dot2c_f32_bf16_dpp v80, v21, v200 row_newbcast:0 row_mask:0xf bank_mask:0xf
  v_dot2c_f32_bf16_dpp v81, v29, v200 row_newbcast:0 row_mask:0xf bank_mask:0xf
  v_dot2c_f32_bf16_dpp v82, v21, v201 row_newbcast:0 row_mask:0xf bank_mask:0xf
  v_dot2c_f32_bf16_dpp v83, v29, v201 row_newbcast:0 row_mask:0xf bank_mask:0xf
  v_dot2c_f32_bf16_dpp v84, v21, v202 row_newbcast:0 row_mask:0xf bank_mask:0xf
  v_dot2c_f32_bf16_dpp v85, v29, v202 row_newbcast:0 row_mask:0xf bank_mask:0xf
  v_dot2c_f32_bf16_dpp v86, v21, v203 row_newbcast:0 row_mask:0xf bank_mask:0xf
  v_dot2c_f32_bf16_dpp v87, v29, v203 row_newbcast:0 row_mask:0xf bank_mask:0xf
  v_dot2c_f32_bf16_dpp v88, v23, v200 row_newbcast:0 row_mask:0xf bank_mask:0xf
  v_dot2c_f32_bf16_dpp v89, v31, v200 row_newbcast:0 row_mask:0xf bank_mask:0xf
  v_dot2c_f32_bf16_dpp v90, v23, v201 row_newbcast:0 row_mask:0xf bank_mask:0xf
  v_dot2c_f32_bf16_dpp v91, v31, v201 row_newbcast:0 row_mask:0xf bank_mask:0xf
  v_dot2c_f32_bf16_dpp v92, v23, v202 row_newbcast:0 row_mask:0xf bank_mask:0xf
  v_dot2c_f32_bf16_dpp v93, v31, v202 row_newbcast:0 row_mask:0xf bank_mask:0xf
  v_dot2c_f32_bf16_dpp v94, v23, v203 row_newbcast:0 row_mask:0xf bank_mask:0xf
  v_dot2c_f32_bf16_dpp v95, v31, v203 row_newbcast:0 row_mask:0xf bank_mask:0xf
  s_waitcnt vmcnt(3)
  buffer_load_dwordx4 v[220:223], v61, s[28:31], s88 offen
  s_add_u32 s88, s88, 0x400
  v_dot2c_f32_bf16_dpp v64, v17, v204 row_newbcast:1 row_mask:0xf bank_mask:0xf
  v_dot2c_f32_bf16_dpp v65, v25, v204 row_newbcast:1 row_mask:0xf bank_mask:0xf
  v_dot2c_f32_bf16_dpp v66, v17, v205 row_newbcast:1 row_mask:0xf bank_mask:0xf
  v_dot2c_f32_bf16_dpp v67, v25, v205 row_newbcast:1 row_mask:0xf bank_mask:0xf
  v_dot2c_f32_bf16_dpp v68, v17, v206 row_newbcast:1 row_mask:0xf bank_mask:0xf
  v_dot2c_f32_bf16_dpp v69, v25, v206 row_newbcast:1 row_mask:0xf bank_mask:0xf
  v_dot2c_f32_bf16_dpp v70, v17, v207 row_newbcast:1 row_mask:0xf bank_mask:0xf
  v_dot2c_f32_bf16_dpp v71, v25, v207 row_newbcast:1 row_mask:0xf bank_mask:0xf
  v_dot2c_f32_bf16_dpp v72, v19, v204 row_newbcast:1 row_mask:0xf bank_mask:0xf
  v_dot2c_f32_bf16_dpp v73, v27, v204 row_newbcast:1 row_mask:0xf bank_mask:0xf
  v_dot2c_f32_bf16_dpp v74, v19, v205 row_newbcast:1 row_mask:0xf bank_mask:0xf
  v_dot2c_f32_bf16_dpp v75, v27, v205 row_newbcast:1 row_mask:0xf bank_mask:0xf
  v_dot2c_f32_bf16_dpp v76, v19, v206 row_newbcast:1 row_mask:0xf bank_mask:0xf
  v_dot2c_f32_bf16_dpp v77, v27, v206 row_newbcast:1 row_mask:0xf bank_mask:0xf
  v_dot2c_f32_bf16_dpp v78, v19, v207 row_newbcast:1 row_mask:0xf bank_mask:0xf
  v_dot2c_f32_bf16_dpp v79, v27, v207 row_newbcast:1 row_mask:0xf bank_mask:0xf
  v_dot2c_f32_bf16_dpp v80, v21, v204 row_newbcast:1 row_mask:0xf bank_mask:0xf
  v_dot2c_f32_bf16_dpp v81, v29, v204 row_newbcast:1 row_mask:0xf bank_mask:0xf
  v_dot2c_f32_bf16_dpp v82, v21, v205 row_newbcast:1 row_mask:0xf bank_mask:0xf
  v_dot2c_f32_bf16_dpp v83, v29, v205 row_newbcast:1 row_mask:0xf bank_mask:0xf
  v_dot2c_f32_bf16_dpp v84, v21, v206 row_newbcast:1 row_mask:0xf bank_mask:0xf
  v_dot2c_f32_bf16_dpp v85, v29, v206 row_newbcast:1 row_mask:0xf bank_mask:0xf
  v_dot2c_f32_bf16_dpp v86, v21, v207 row_newbcast:1 row_mask:0xf bank_mask:0xf
  v_dot2c_f32_bf16_dpp v87, v29, v207 row_newbcast:1 row_mask:0xf bank_mask:0xf
  v_dot2c_f32_bf16_dpp v88, v23, v204 row_newbcast:1 row_mask:0xf bank_mask:0xf
  v_dot2c_f32_bf16_dpp v89, v31, v204 row_newbcast:1 row_mask:0xf bank_mask:0xf
  v_dot2c_f32_bf16_dpp v90, v23, v205 row_newbcast:1 row_mask:0xf bank_mask:0xf
  v_dot2c_f32_bf16_dpp v91, v31, v205 row_newbcast:1 row_mask:0xf bank_mask:0xf
  v_dot2c_f32_bf16_dpp v92, v23, v206 row_newbcast:1 row_mask:0xf bank_mask:0xf
  v_dot2c_f32_bf16_dpp v93, v31, v206 row_newbcast:1 row_mask:0xf bank_mask:0xf
  v_dot2c_f32_bf16_dpp v94, v23, v207 row_newbcast:1 row_mask:0xf bank_mask:0xf
  v_dot2c_f32_bf16_dpp v95, v31, v207 row_newbcast:1 row_mask:0xf bank_mask:0xf
  s_waitcnt vmcnt(3)
  buffer_load_dwordx4 v[224:227], v61, s[28:31], s88 offen
  s_add_u32 s88, s88, 0x400
  v_dot2c_f32_bf16_dpp v64, v17, v208 row_newbcast:2 row_mask:0xf bank_mask:0xf
  v_dot2c_f32_bf16_dpp v65, v25, v208 row_newbcast:2 row_mask:0xf bank_mask:0xf
  v_dot2c_f32_bf16_dpp v66, v17, v209 row_newbcast:2 row_mask:0xf bank_mask:0xf
  v_dot2c_f32_bf16_dpp v67, v25, v209 row_newbcast:2 row_mask:0xf bank_mask:0xf
  v_dot2c_f32_bf16_dpp v68, v17, v210 row_newbcast:2 row_mask:0xf bank_mask:0xf
  v_dot2c_f32_bf16_dpp v69, v25, v210 row_newbcast:2 row_mask:0xf bank_mask:0xf
  v_dot2c_f32_bf16_dpp v70, v17, v211 row_newbcast:2 row_mask:0xf bank_mask:0xf
  v_dot2c_f32_bf16_dpp v71, v25, v211 row_newbcast:2 row_mask:0xf bank_mask:0xf
  v_dot2c_f32_bf16_dpp v72, v19, v208 row_newbcast:2 row_mask:0xf bank_mask:0xf
  v_dot2c_f32_bf16_dpp v73, v27, v208 row_newbcast:2 row_mask:0xf bank_mask:0xf
  v_dot2c_f32_bf16_dpp v74, v19, v209 row_newbcast:2 row_mask:0xf bank_mask:0xf
  v_dot2c_f32_bf16_dpp v75, v27, v209 row_newbcast:2 row_mask:0xf bank_mask:0xf
  v_dot2c_f32_bf16_dpp v76, v19, v210 row_newbcast:2 row_mask:0xf bank_mask:0xf
  v_dot2c_f32_bf16_dpp v77, v27, v210 row_newbcast:2 row_mask:0xf bank_mask:0xf
  v_dot2c_f32_bf16_dpp v78, v19, v211 row_newbcast:2 row_mask:0xf bank_mask:0xf
  v_dot2c_f32_bf16_dpp v79, v27, v211 row_newbcast:2 row_mask:0xf bank_mask:0xf
  v_dot2c_f32_bf16_dpp v80, v21, v208 row_newbcast:2 row_mask:0xf bank_mask:0xf
  v_dot2c_f32_bf16_dpp v81, v29, v208 row_newbcast:2 row_mask:0xf bank_mask:0xf
  v_dot2c_f32_bf16_dpp v82, v21, v209 row_newbcast:2 row_mask:0xf bank_mask:0xf
  v_dot2c_f32_bf16_dpp v83, v29, v209 row_newbcast:2 row_mask:0xf bank_mask:0xf
  v_dot2c_f32_bf16_dpp v84, v21, v210 row_newbcast:2 row_mask:0xf bank_mask:0xf
  v_dot2c_f32_bf16_dpp v85, v29, v210 row_newbcast:2 row_mask:0xf bank_mask:0xf
  v_dot2c_f32_bf16_dpp v86, v21, v211 row_newbcast:2 row_mask:0xf bank_mask:0xf
  v_dot2c_f32_bf16_dpp v87, v29, v211 row_newbcast:2 row_mask:0xf bank_mask:0xf
  v_dot2c_f32_bf16_dpp v88, v23, v208 row_newbcast:2 row_mask:0xf bank_mask:0xf
  v_dot2c_f32_bf16_dpp v89, v31, v208 row_newbcast:2 row_mask:0xf bank_mask:0xf
  v_dot2c_f32_bf16_dpp v90, v23, v209 row_newbcast:2 row_mask:0xf bank_mask:0xf
  v_dot2c_f32_bf16_dpp v91, v31, v209 row_newbcast:2 row_mask:0xf bank_mask:0xf
  v_dot2c_f32_bf16_dpp v92, v23, v210 row_newbcast:2 row_mask:0xf bank_mask:0xf
  v_dot2c_f32_bf16_dpp v93, v31, v210 row_newbcast:2 row_mask:0xf bank_mask:0xf
  v_dot2c_f32_bf16_dpp v94, v23, v211 row_newbcast:2 row_mask:0xf bank_mask:0xf
  v_dot2c_f32_bf16_dpp v95, v31, v211 row_newbcast:2 row_mask:0xf bank_mask:0xf
  s_waitcnt vmcnt(3)
  buffer_load_dwordx4 v[228:231], v61, s[28:31], s88 offen
  s_add_u32 s88, s88, 0x400
  v_dot2c_f32_bf16_dpp v64, v17, v212 row_newbcast:3 row_mask:0xf bank_mask:0xf
  v_dot2c_f32_bf16_dpp v65, v25, v212 row_newbcast:3 row_mask:0xf bank_mask:0xf
  v_dot2c_f32_bf16_dpp v66, v17, v213 row_newbcast:3 row_mask:0xf bank_mask:0xf
  v_dot2c_f32_bf16_dpp v67, v25, v213 row_newbcast:3 row_mask:0xf bank_mask:0xf
  v_dot2c_f32_bf16_dpp v68, v17, v214 row_newbcast:3 row_mask:0xf bank_mask:0xf
  v_dot2c_f32_bf16_dpp v69, v25, v214 row_newbcast:3 row_mask:0xf bank_mask:0xf
  v_dot2c_f32_bf16_dpp v70, v17, v215 row_newbcast:3 row_mask:0xf bank_mask:0xf
  v_dot2c_f32_bf16_dpp v71, v25, v215 row_newbcast:3 row_mask:0xf bank_mask:0xf
  v_dot2c_f32_bf16_dpp v72, v19, v212 row_newbcast:3 row_mask:0xf bank_mask:0xf
  v_dot2c_f32_bf16_dpp v73, v27, v212 row_newbcast:3 row_mask:0xf bank_mask:0xf
  v_dot2c_f32_bf16_dpp v74, v19, v213 row_newbcast:3 row_mask:0xf bank_mask:0xf
  v_dot2c_f32_bf16_dpp v75, v27, v213 row_newbcast:3 row_mask:0xf bank_mask:0xf
  v_dot2c_f32_bf16_dpp v76, v19, v214 row_newbcast:3 row_mask:0xf bank_mask:0xf
  v_dot2c_f32_bf16_dpp v77, v27, v214 row_newbcast:3 row_mask:0xf bank_mask:0xf
  v_dot2c_f32_bf16_dpp v78, v19, v215 row_newbcast:3 row_mask:0xf bank_mask:0xf
  v_dot2c_f32_bf16_dpp v79, v27, v215 row_newbcast:3 row_mask:0xf bank_mask:0xf
  v_dot2c_f32_bf16_dpp v80, v21, v212 row_newbcast:3 row_mask:0xf bank_mask:0xf
  v_dot2c_f32_bf16_dpp v81, v29, v212 row_newbcast:3 row_mask:0xf bank_mask:0xf
  v_dot2c_f32_bf16_dpp v82, v21, v213 row_newbcast:3 row_mask:0xf bank_mask:0xf
  v_dot2c_f32_bf16_dpp v83, v29, v213 row_newbcast:3 row_mask:0xf bank_mask:0xf
  v_dot2c_f32_bf16_dpp v84, v21, v214 row_newbcast:3 row_mask:0xf bank_mask:0xf
  v_dot2c_f32_bf16_dpp v85, v29, v214 row_newbcast:3 row_mask:0xf bank_mask:0xf
  v_dot2c_f32_bf16_dpp v86, v21, v215 row_newbcast:3 row_mask:0xf bank_mask:0xf
  v_dot2c_f32_bf16_dpp v87, v29, v215 row_newbcast:3 row_mask:0xf bank_mask:0xf
  v_dot2c_f32_bf16_dpp v88, v23, v212 row_newbcast:3 row_mask:0xf bank_mask:0xf
  v_dot2c_f32_bf16_dpp v89, v31, v212 row_newbcast:3 row_mask:0xf bank_mask:0xf
  v_dot2c_f32_bf16_dpp v90, v23, v213 row_newbcast:3 row_mask:0xf bank_mask:0xf
  v_dot2c_f32_bf16_dpp v91, v31, v213 row_newbcast:3 row_mask:0xf bank_mask:0xf
  v_dot2c_f32_bf16_dpp v92, v23, v214 row_newbcast:3 row_mask:0xf bank_mask:0xf
  v_dot2c_f32_bf16_dpp v93, v31, v214 row_newbcast:3 row_mask:0xf bank_mask:0xf
  v_dot2c_f32_bf16_dpp v94, v23, v215 row_newbcast:3 row_mask:0xf bank_mask:0xf
  v_dot2c_f32_bf16_dpp v95, v31, v215 row_newbcast:3 row_mask:0xf bank_mask:0xf
  s_waitcnt vmcnt(3)
  buffer_load_dwordx4 v[200:203], v61, s[28:31], s88 offen
  s_add_u32 s88, s88, 0x400
  v_dot2c_f32_bf16_dpp v64, v17, v216 row_newbcast:4 row_mask:0xf bank_mask:0xf
  v_dot2c_f32_bf16_dpp v65, v25, v216 row_newbcast:4 row_mask:0xf bank_mask:0xf
  v_dot2c_f32_bf16_dpp v66, v17, v217 row_newbcast:4 row_mask:0xf bank_mask:0xf
  v_dot2c_f32_bf16_dpp v67, v25, v217 row_newbcast:4 row_mask:0xf bank_mask:0xf
  v_dot2c_f32_bf16_dpp v68, v17, v218 row_newbcast:4 row_mask:0xf bank_mask:0xf
  v_dot2c_f32_bf16_dpp v69, v25, v218 row_newbcast:4 row_mask:0xf bank_mask:0xf
  v_dot2c_f32_bf16_dpp v70, v17, v219 row_newbcast:4 row_mask:0xf bank_mask:0xf
  v_dot2c_f32_bf16_dpp v71, v25, v219 row_newbcast:4 row_mask:0xf bank_mask:0xf
  v_dot2c_f32_bf16_dpp v72, v19, v216 row_newbcast:4 row_mask:0xf bank_mask:0xf
  v_dot2c_f32_bf16_dpp v73, v27, v216 row_newbcast:4 row_mask:0xf bank_mask:0xf
  v_dot2c_f32_bf16_dpp v74, v19, v217 row_newbcast:4 row_mask:0xf bank_mask:0xf
  v_dot2c_f32_bf16_dpp v75, v27, v217 row_newbcast:4 row_mask:0xf bank_mask:0xf
  v_dot2c_f32_bf16_dpp v76, v19, v218 row_newbcast:4 row_mask:0xf bank_mask:0xf
  v_dot2c_f32_bf16_dpp v77, v27, v218 row_newbcast:4 row_mask:0xf bank_mask:0xf
  v_dot2c_f32_bf16_dpp v78, v19, v219 row_newbcast:4 row_mask:0xf bank_mask:0xf
  v_dot2c_f32_bf16_dpp v79, v27, v219 row_newbcast:4 row_mask:0xf bank_mask:0xf
  v_dot2c_f32_bf16_dpp v80, v21, v216 row_newbcast:4 row_mask:0xf bank_mask:0xf
  v_dot2c_f32_bf16_dpp v81, v29, v216 row_newbcast:4 row_mask:0xf bank_mask:0xf
  v_dot2c_f32_bf16_dpp v82, v21, v217 row_newbcast:4 row_mask:0xf bank_mask:0xf
  v_dot2c_f32_bf16_dpp v83, v29, v217 row_newbcast:4 row_mask:0xf bank_mask:0xf
  v_dot2c_f32_bf16_dpp v84, v21, v218 row_newbcast:4 row_mask:0xf bank_mask:0xf
  v_dot2c_f32_bf16_dpp v85, v29, v218 row_newbcast:4 row_mask:0xf bank_mask:0xf
  v_dot2c_f32_bf16_dpp v86, v21, v219 row_newbcast:4 row_mask:0xf bank_mask:0xf
  v_dot2c_f32_bf16_dpp v87, v29, v219 row_newbcast:4 row_mask:0xf bank_mask:0xf
  v_dot2c_f32_bf16_dpp v88, v23, v216 row_newbcast:4 row_mask:0xf bank_mask:0xf
  v_dot2c_f32_bf16_dpp v89, v31, v216 row_newbcast:4 row_mask:0xf bank_mask:0xf
  v_dot2c_f32_bf16_dpp v90, v23, v217 row_newbcast:4 row_mask:0xf bank_mask:0xf
  v_dot2c_f32_bf16_dpp v91, v31, v217 row_newbcast:4 row_mask:0xf bank_mask:0xf
  v_dot2c_f32_bf16_dpp v92, v23, v218 row_newbcast:4 row_mask:0xf bank_mask:0xf
  v_dot2c_f32_bf16_dpp v93, v31, v218 row_newbcast:4 row_mask:0xf bank_mask:0xf
  v_dot2c_f32_bf16_dpp v94, v23, v219 row_newbcast:4 row_mask:0xf bank_mask:0xf
  v_dot2c_f32_bf16_dpp v95, v31, v219 row_newbcast:4 row_mask:0xf bank_mask:0xf
  s_waitcnt vmcnt(3)
  buffer_load_dwordx4 v[204:207], v61, s[28:31], s88 offen
  s_add_u32 s88, s88, 0x400
  v_dot2c_f32_bf16_dpp v64, v17, v220 row_newbcast:5 row_mask:0xf bank_mask:0xf
  v_dot2c_f32_bf16_dpp v65, v25, v220 row_newbcast:5 row_mask:0xf bank_mask:0xf
  v_dot2c_f32_bf16_dpp v66, v17, v221 row_newbcast:5 row_mask:0xf bank_mask:0xf
  v_dot2c_f32_bf16_dpp v67, v25, v221 row_newbcast:5 row_mask:0xf bank_mask:0xf
  v_dot2c_f32_bf16_dpp v68, v17, v222 row_newbcast:5 row_mask:0xf bank_mask:0xf
  v_dot2c_f32_bf16_dpp v69, v25, v222 row_newbcast:5 row_mask:0xf bank_mask:0xf
  v_dot2c_f32_bf16_dpp v70, v17, v223 row_newbcast:5 row_mask:0xf bank_mask:0xf
  v_dot2c_f32_bf16_dpp v71, v25, v223 row_newbcast:5 row_mask:0xf bank_mask:0xf
  v_dot2c_f32_bf16_dpp v72, v19, v220 row_newbcast:5 row_mask:0xf bank_mask:0xf
  v_dot2c_f32_bf16_dpp v73, v27, v220 row_newbcast:5 row_mask:0xf bank_mask:0xf
  v_dot2c_f32_bf16_dpp v74, v19, v221 row_newbcast:5 row_mask:0xf bank_mask:0xf
  v_dot2c_f32_bf16_dpp v75, v27, v221 row_newbcast:5 row_mask:0xf bank_mask:0xf
  v_dot2c_f32_bf16_dpp v76, v19, v222 row_newbcast:5 row_mask:0xf bank_mask:0xf
  v_dot2c_f32_bf16_dpp v77, v27, v222 row_newbcast:5 row_mask:0xf bank_mask:0xf
  v_dot2c_f32_bf16_dpp v78, v19, v223 row_newbcast:5 row_mask:0xf bank_mask:0xf
  v_dot2c_f32_bf16_dpp v79, v27, v223 row_newbcast:5 row_mask:0xf bank_mask:0xf
  v_dot2c_f32_bf16_dpp v80, v21, v220 row_newbcast:5 row_mask:0xf bank_mask:0xf
  v_dot2c_f32_bf16_dpp v81, v29, v220 row_newbcast:5 row_mask:0xf bank_mask:0xf
  v_dot2c_f32_bf16_dpp v82, v21, v221 row_newbcast:5 row_mask:0xf bank_mask:0xf
  v_dot2c_f32_bf16_dpp v83, v29, v221 row_newbcast:5 row_mask:0xf bank_mask:0xf
  v_dot2c_f32_bf16_dpp v84, v21, v222 row_newbcast:5 row_mask:0xf bank_mask:0xf
  v_dot2c_f32_bf16_dpp v85, v29, v222 row_newbcast:5 row_mask:0xf bank_mask:0xf
  v_dot2c_f32_bf16_dpp v86, v21, v223 row_newbcast:5 row_mask:0xf bank_mask:0xf
  v_dot2c_f32_bf16_dpp v87, v29, v223 row_newbcast:5 row_mask:0xf bank_mask:0xf
  v_dot2c_f32_bf16_dpp v88, v23, v220 row_newbcast:5 row_mask:0xf bank_mask:0xf
  v_dot2c_f32_bf16_dpp v89, v31, v220 row_newbcast:5 row_mask:0xf bank_mask:0xf
  v_dot2c_f32_bf16_dpp v90, v23, v221 row_newbcast:5 row_mask:0xf bank_mask:0xf
  v_dot2c_f32_bf16_dpp v91, v31, v221 row_newbcast:5 row_mask:0xf bank_mask:0xf
  v_dot2c_f32_bf16_dpp v92, v23, v222 row_newbcast:5 row_mask:0xf bank_mask:0xf
  v_dot2c_f32_bf16_dpp v93, v31, v222 row_newbcast:5 row_mask:0xf bank_mask:0xf
  v_dot2c_f32_bf16_dpp v94, v23, v223 row_newbcast:5 row_mask:0xf bank_mask:0xf
  v_dot2c_f32_bf16_dpp v95, v31, v223 row_newbcast:5 row_mask:0xf bank_mask:0xf
  s_waitcnt vmcnt(3)
  buffer_load_dwordx4 v[208:211], v61, s[28:31], s88 offen
  s_add_u32 s88, s88, 0x400
  v_dot2c_f32_bf16_dpp v64, v17, v224 row_newbcast:6 row_mask:0xf bank_mask:0xf
  v_dot2c_f32_bf16_dpp v65, v25, v224 row_newbcast:6 row_mask:0xf bank_mask:0xf
  v_dot2c_f32_bf16_dpp v66, v17, v225 row_newbcast:6 row_mask:0xf bank_mask:0xf
  v_dot2c_f32_bf16_dpp v67, v25, v225 row_newbcast:6 row_mask:0xf bank_mask:0xf
  v_dot2c_f32_bf16_dpp v68, v17, v226 row_newbcast:6 row_mask:0xf bank_mask:0xf
  v_dot2c_f32_bf16_dpp v69, v25, v226 row_newbcast:6 row_mask:0xf bank_mask:0xf
  v_dot2c_f32_bf16_dpp v70, v17, v227 row_newbcast:6 row_mask:0xf bank_mask:0xf
  v_dot2c_f32_bf16_dpp v71, v25, v227 row_newbcast:6 row_mask:0xf bank_mask:0xf
  v_dot2c_f32_bf16_dpp v72, v19, v224 row_newbcast:6 row_mask:0xf bank_mask:0xf
  v_dot2c_f32_bf16_dpp v73, v27, v224 row_newbcast:6 row_mask:0xf bank_mask:0xf
  v_dot2c_f32_bf16_dpp v74, v19, v225 row_newbcast:6 row_mask:0xf bank_mask:0xf
  v_dot2c_f32_bf16_dpp v75, v27, v225 row_newbcast:6 row_mask:0xf bank_mask:0xf
  v_dot2c_f32_bf16_dpp v76, v19, v226 row_newbcast:6 row_mask:0xf bank_mask:0xf
  v_dot2c_f32_bf16_dpp v77, v27, v226 row_newbcast:6 row_mask:0xf bank_mask:0xf
  v_dot2c_f32_bf16_dpp v78, v19, v227 row_newbcast:6 row_mask:0xf bank_mask:0xf
  v_dot2c_f32_bf16_dpp v79, v27, v227 row_newbcast:6 row_mask:0xf bank_mask:0xf
  v_dot2c_f32_bf16_dpp v80, v21, v224 row_newbcast:6 row_mask:0xf bank_mask:0xf
  v_dot2c_f32_bf16_dpp v81, v29, v224 row_newbcast:6 row_mask:0xf bank_mask:0xf
  v_dot2c_f32_bf16_dpp v82, v21, v225 row_newbcast:6 row_mask:0xf bank_mask:0xf
  v_dot2c_f32_bf16_dpp v83, v29, v225 row_newbcast:6 row_mask:0xf bank_mask:0xf
  v_dot2c_f32_bf16_dpp v84, v21, v226 row_newbcast:6 row_mask:0xf bank_mask:0xf
  v_dot2c_f32_bf16_dpp v85, v29, v226 row_newbcast:6 row_mask:0xf bank_mask:0xf
  v_dot2c_f32_bf16_dpp v86, v21, v227 row_newbcast:6 row_mask:0xf bank_mask:0xf
  v_dot2c_f32_bf16_dpp v87, v29, v227 row_newbcast:6 row_mask:0xf bank_mask:0xf
  v_dot2c_f32_bf16_dpp v88, v23, v224 row_newbcast:6 row_mask:0xf bank_mask:0xf
  v_dot2c_f32_bf16_dpp v89, v31, v224 row_newbcast:6 row_mask:0xf bank_mask:0xf
  v_dot2c_f32_bf16_dpp v90, v23, v225 row_newbcast:6 row_mask:0xf bank_mask:0xf
  v_dot2c_f32_bf16_dpp v91, v31, v225 row_newbcast:6 row_mask:0xf bank_mask:0xf
  v_dot2c_f32_bf16_dpp v92, v23, v226 row_newbcast:6 row_mask:0xf bank_mask:0xf
  v_dot2c_f32_bf16_dpp v93, v31, v226 row_newbcast:6 row_mask:0xf bank_mask:0xf
  v_dot2c_f32_bf16_dpp v94, v23, v227 row_newbcast:6 row_mask:0xf bank_mask:0xf
  v_dot2c_f32_bf16_dpp v95, v31, v227 row_newbcast:6 row_mask:0xf bank_mask:0xf
  s_waitcnt vmcnt(3)
  buffer_load_dwordx4 v[212:215], v61, s[28:31], s88 offen
  s_add_u32 s88, s88, 0x400
  v_dot2c_f32_bf16_dpp v64, v17, v228 row_newbcast:7 row_mask:0xf bank_mask:0xf
  v_dot2c_f32_bf16_dpp v65, v25, v228 row_newbcast:7 row_mask:0xf bank_mask:0xf
  v_dot2c_f32_bf16_dpp v66, v17, v229 row_newbcast:7 row_mask:0xf bank_mask:0xf
  v_dot2c_f32_bf16_dpp v67, v25, v229 row_newbcast:7 row_mask:0xf bank_mask:0xf
  v_dot2c_f32_bf16_dpp v68, v17, v230 row_newbcast:7 row_mask:0xf bank_mask:0xf
  v_dot2c_f32_bf16_dpp v69, v25, v230 row_newbcast:7 row_mask:0xf bank_mask:0xf
  v_dot2c_f32_bf16_dpp v70, v17, v231 row_newbcast:7 row_mask:0xf bank_mask:0xf
  v_dot2c_f32_bf16_dpp v71, v25, v231 row_newbcast:7 row_mask:0xf bank_mask:0xf
  v_dot2c_f32_bf16_dpp v72, v19, v228 row_newbcast:7 row_mask:0xf bank_mask:0xf
  v_dot2c_f32_bf16_dpp v73, v27, v228 row_newbcast:7 row_mask:0xf bank_mask:0xf
  v_dot2c_f32_bf16_dpp v74, v19, v229 row_newbcast:7 row_mask:0xf bank_mask:0xf
  v_dot2c_f32_bf16_dpp v75, v27, v229 row_newbcast:7 row_mask:0xf bank_mask:0xf
  v_dot2c_f32_bf16_dpp v76, v19, v230 row_newbcast:7 row_mask:0xf bank_mask:0xf
  v_dot2c_f32_bf16_dpp v77, v27, v230 row_newbcast:7 row_mask:0xf bank_mask:0xf
  v_dot2c_f32_bf16_dpp v78, v19, v231 row_newbcast:7 row_mask:0xf bank_mask:0xf
  v_dot2c_f32_bf16_dpp v79, v27, v231 row_newbcast:7 row_mask:0xf bank_mask:0xf
  v_dot2c_f32_bf16_dpp v80, v21, v228 row_newbcast:7 row_mask:0xf bank_mask:0xf
  v_dot2c_f32_bf16_dpp v81, v29, v228 row_newbcast:7 row_mask:0xf bank_mask:0xf
  v_dot2c_f32_bf16_dpp v82, v21, v229 row_newbcast:7 row_mask:0xf bank_mask:0xf
  v_dot2c_f32_bf16_dpp v83, v29, v229 row_newbcast:7 row_mask:0xf bank_mask:0xf
  v_dot2c_f32_bf16_dpp v84, v21, v230 row_newbcast:7 row_mask:0xf bank_mask:0xf
  v_dot2c_f32_bf16_dpp v85, v29, v230 row_newbcast:7 row_mask:0xf bank_mask:0xf
  v_dot2c_f32_bf16_dpp v86, v21, v231 row_newbcast:7 row_mask:0xf bank_mask:0xf
  v_dot2c_f32_bf16_dpp v87, v29, v231 row_newbcast:7 row_mask:0xf bank_mask:0xf
  v_dot2c_f32_bf16_dpp v88, v23, v228 row_newbcast:7 row_mask:0xf bank_mask:0xf
  v_dot2c_f32_bf16_dpp v89, v31, v228 row_newbcast:7 row_mask:0xf bank_mask:0xf
  v_dot2c_f32_bf16_dpp v90, v23, v229 row_newbcast:7 row_mask:0xf bank_mask:0xf
  v_dot2c_f32_bf16_dpp v91, v31, v229 row_newbcast:7 row_mask:0xf bank_mask:0xf
  v_dot2c_f32_bf16_dpp v92, v23, v230 row_newbcast:7 row_mask:0xf bank_mask:0xf
  v_dot2c_f32_bf16_dpp v93, v31, v230 row_newbcast:7 row_mask:0xf bank_mask:0xf
  v_dot2c_f32_bf16_dpp v94, v23, v231 row_newbcast:7 row_mask:0xf bank_mask:0xf
  v_dot2c_f32_bf16_dpp v95, v31, v231 row_newbcast:7 row_mask:0xf bank_mask:0xf
  s_waitcnt vmcnt(3)
  buffer_load_dwordx4 v[216:219], v61, s[28:31], s88 offen
  s_add_u32 s88, s88, 0x400
  v_dot2c_f32_bf16_dpp v64, v17, v200 row_newbcast:8 row_mask:0xf bank_mask:0xf
  v_dot2c_f32_bf16_dpp v65, v25, v200 row_newbcast:8 row_mask:0xf bank_mask:0xf
  v_dot2c_f32_bf16_dpp v66, v17, v201 row_newbcast:8 row_mask:0xf bank_mask:0xf
  v_dot2c_f32_bf16_dpp v67, v25, v201 row_newbcast:8 row_mask:0xf bank_mask:0xf
  v_dot2c_f32_bf16_dpp v68, v17, v202 row_newbcast:8 row_mask:0xf bank_mask:0xf
  v_dot2c_f32_bf16_dpp v69, v25, v202 row_newbcast:8 row_mask:0xf bank_mask:0xf
  v_dot2c_f32_bf16_dpp v70, v17, v203 row_newbcast:8 row_mask:0xf bank_mask:0xf
  v_dot2c_f32_bf16_dpp v71, v25, v203 row_newbcast:8 row_mask:0xf bank_mask:0xf
  v_dot2c_f32_bf16_dpp v72, v19, v200 row_newbcast:8 row_mask:0xf bank_mask:0xf
  v_dot2c_f32_bf16_dpp v73, v27, v200 row_newbcast:8 row_mask:0xf bank_mask:0xf
  v_dot2c_f32_bf16_dpp v74, v19, v201 row_newbcast:8 row_mask:0xf bank_mask:0xf
  v_dot2c_f32_bf16_dpp v75, v27, v201 row_newbcast:8 row_mask:0xf bank_mask:0xf
  v_dot2c_f32_bf16_dpp v76, v19, v202 row_newbcast:8 row_mask:0xf bank_mask:0xf
  v_dot2c_f32_bf16_dpp v77, v27, v202 row_newbcast:8 row_mask:0xf bank_mask:0xf
  v_dot2c_f32_bf16_dpp v78, v19, v203 row_newbcast:8 row_mask:0xf bank_mask:0xf
  v_dot2c_f32_bf16_dpp v79, v27, v203 row_newbcast:8 row_mask:0xf bank_mask:0xf
  v_dot2c_f32_bf16_dpp v80, v21, v200 row_newbcast:8 row_mask:0xf bank_mask:0xf
  v_dot2c_f32_bf16_dpp v81, v29, v200 row_newbcast:8 row_mask:0xf bank_mask:0xf
  v_dot2c_f32_bf16_dpp v82, v21, v201 row_newbcast:8 row_mask:0xf bank_mask:0xf
  v_dot2c_f32_bf16_dpp v83, v29, v201 row_newbcast:8 row_mask:0xf bank_mask:0xf
  v_dot2c_f32_bf16_dpp v84, v21, v202 row_newbcast:8 row_mask:0xf bank_mask:0xf
  v_dot2c_f32_bf16_dpp v85, v29, v202 row_newbcast:8 row_mask:0xf bank_mask:0xf
  v_dot2c_f32_bf16_dpp v86, v21, v203 row_newbcast:8 row_mask:0xf bank_mask:0xf
  v_dot2c_f32_bf16_dpp v87, v29, v203 row_newbcast:8 row_mask:0xf bank_mask:0xf
  v_dot2c_f32_bf16_dpp v88, v23, v200 row_newbcast:8 row_mask:0xf bank_mask:0xf
  v_dot2c_f32_bf16_dpp v89, v31, v200 row_newbcast:8 row_mask:0xf bank_mask:0xf
  v_dot2c_f32_bf16_dpp v90, v23, v201 row_newbcast:8 row_mask:0xf bank_mask:0xf
  v_dot2c_f32_bf16_dpp v91, v31, v201 row_newbcast:8 row_mask:0xf bank_mask:0xf
  v_dot2c_f32_bf16_dpp v92, v23, v202 row_newbcast:8 row_mask:0xf bank_mask:0xf
  v_dot2c_f32_bf16_dpp v93, v31, v202 row_newbcast:8 row_mask:0xf bank_mask:0xf
  v_dot2c_f32_bf16_dpp v94, v23, v203 row_newbcast:8 row_mask:0xf bank_mask:0xf
  v_dot2c_f32_bf16_dpp v95, v31, v203 row_newbcast:8 row_mask:0xf bank_mask:0xf
  s_waitcnt vmcnt(3)
  buffer_load_dwordx4 v[220:223], v61, s[28:31], s88 offen
  s_add_u32 s88, s88, 0x400
  v_dot2c_f32_bf16_dpp v64, v17, v204 row_newbcast:9 row_mask:0xf bank_mask:0xf
  v_dot2c_f32_bf16_dpp v65, v25, v204 row_newbcast:9 row_mask:0xf bank_mask:0xf
  v_dot2c_f32_bf16_dpp v66, v17, v205 row_newbcast:9 row_mask:0xf bank_mask:0xf
  v_dot2c_f32_bf16_dpp v67, v25, v205 row_newbcast:9 row_mask:0xf bank_mask:0xf
  v_dot2c_f32_bf16_dpp v68, v17, v206 row_newbcast:9 row_mask:0xf bank_mask:0xf
  v_dot2c_f32_bf16_dpp v69, v25, v206 row_newbcast:9 row_mask:0xf bank_mask:0xf
  v_dot2c_f32_bf16_dpp v70, v17, v207 row_newbcast:9 row_mask:0xf bank_mask:0xf
  v_dot2c_f32_bf16_dpp v71, v25, v207 row_newbcast:9 row_mask:0xf bank_mask:0xf
  v_dot2c_f32_bf16_dpp v72, v19, v204 row_newbcast:9 row_mask:0xf bank_mask:0xf
  v_dot2c_f32_bf16_dpp v73, v27, v204 row_newbcast:9 row_mask:0xf bank_mask:0xf
  v_dot2c_f32_bf16_dpp v74, v19, v205 row_newbcast:9 row_mask:0xf bank_mask:0xf
  v_dot2c_f32_bf16_dpp v75, v27, v205 row_newbcast:9 row_mask:0xf bank_mask:0xf
  v_dot2c_f32_bf16_dpp v76, v19, v206 row_newbcast:9 row_mask:0xf bank_mask:0xf
  v_dot2c_f32_bf16_dpp v77, v27, v206 row_newbcast:9 row_mask:0xf bank_mask:0xf
  v_dot2c_f32_bf16_dpp v78, v19, v207 row_newbcast:9 row_mask:0xf bank_mask:0xf
  v_dot2c_f32_bf16_dpp v79, v27, v207 row_newbcast:9 row_mask:0xf bank_mask:0xf
  v_dot2c_f32_bf16_dpp v80, v21, v204 row_newbcast:9 row_mask:0xf bank_mask:0xf
  v_dot2c_f32_bf16_dpp v81, v29, v204 row_newbcast:9 row_mask:0xf bank_mask:0xf
  v_dot2c_f32_bf16_dpp v82, v21, v205 row_newbcast:9 row_mask:0xf bank_mask:0xf
  v_dot2c_f32_bf16_dpp v83, v29, v205 row_newbcast:9 row_mask:0xf bank_mask:0xf
  v_dot2c_f32_bf16_dpp v84, v21, v206 row_newbcast:9 row_mask:0xf bank_mask:0xf
  v_dot2c_f32_bf16_dpp v85, v29, v206 row_newbcast:9 row_mask:0xf bank_mask:0xf
  v_dot2c_f32_bf16_dpp v86, v21, v207 row_newbcast:9 row_mask:0xf bank_mask:0xf
  v_dot2c_f32_bf16_dpp v87, v29, v207 row_newbcast:9 row_mask:0xf bank_mask:0xf
  v_dot2c_f32_bf16_dpp v88, v23, v204 row_newbcast:9 row_mask:0xf bank_mask:0xf
  v_dot2c_f32_bf16_dpp v89, v31, v204 row_newbcast:9 row_mask:0xf bank_mask:0xf
  v_dot2c_f32_bf16_dpp v90, v23, v205 row_newbcast:9 row_mask:0xf bank_mask:0xf
  v_dot2c_f32_bf16_dpp v91, v31, v205 row_newbcast:9 row_mask:0xf bank_mask:0xf
  v_dot2c_f32_bf16_dpp v92, v23, v206 row_newbcast:9 row_mask:0xf bank_mask:0xf
  v_dot2c_f32_bf16_dpp v93, v31, v206 row_newbcast:9 row_mask:0xf bank_mask:0xf
  v_dot2c_f32_bf16_dpp v94, v23, v207 row_newbcast:9 row_mask:0xf bank_mask:0xf
  v_dot2c_f32_bf16_dpp v95, v31, v207 row_newbcast:9 row_mask:0xf bank_mask:0xf
  s_waitcnt vmcnt(3)
  buffer_load_dwordx4 v[224:227], v61, s[28:31], s88 offen
  s_add_u32 s88, s88, 0x400
  v_dot2c_f32_bf16_dpp v64, v17, v208 row_newbcast:10 row_mask:0xf bank_mask:0xf
  v_dot2c_f32_bf16_dpp v65, v25, v208 row_newbcast:10 row_mask:0xf bank_mask:0xf
  v_dot2c_f32_bf16_dpp v66, v17, v209 row_newbcast:10 row_mask:0xf bank_mask:0xf
  v_dot2c_f32_bf16_dpp v67, v25, v209 row_newbcast:10 row_mask:0xf bank_mask:0xf
  v_dot2c_f32_bf16_dpp v68, v17, v210 row_newbcast:10 row_mask:0xf bank_mask:0xf
  v_dot2c_f32_bf16_dpp v69, v25, v210 row_newbcast:10 row_mask:0xf bank_mask:0xf
  v_dot2c_f32_bf16_dpp v70, v17, v211 row_newbcast:10 row_mask:0xf bank_mask:0xf
  v_dot2c_f32_bf16_dpp v71, v25, v211 row_newbcast:10 row_mask:0xf bank_mask:0xf
  v_dot2c_f32_bf16_dpp v72, v19, v208 row_newbcast:10 row_mask:0xf bank_mask:0xf
  v_dot2c_f32_bf16_dpp v73, v27, v208 row_newbcast:10 row_mask:0xf bank_mask:0xf
  v_dot2c_f32_bf16_dpp v74, v19, v209 row_newbcast:10 row_mask:0xf bank_mask:0xf
  v_dot2c_f32_bf16_dpp v75, v27, v209 row_newbcast:10 row_mask:0xf bank_mask:0xf
  v_dot2c_f32_bf16_dpp v76, v19, v210 row_newbcast:10 row_mask:0xf bank_mask:0xf
  v_dot2c_f32_bf16_dpp v77, v27, v210 row_newbcast:10 row_mask:0xf bank_mask:0xf
  v_dot2c_f32_bf16_dpp v78, v19, v211 row_newbcast:10 row_mask:0xf bank_mask:0xf
  v_dot2c_f32_bf16_dpp v79, v27, v211 row_newbcast:10 row_mask:0xf bank_mask:0xf
  v_dot2c_f32_bf16_dpp v80, v21, v208 row_newbcast:10 row_mask:0xf bank_mask:0xf
  v_dot2c_f32_bf16_dpp v81, v29, v208 row_newbcast:10 row_mask:0xf bank_mask:0xf
  v_dot2c_f32_bf16_dpp v82, v21, v209 row_newbcast:10 row_mask:0xf bank_mask:0xf
  v_dot2c_f32_bf16_dpp v83, v29, v209 row_newbcast:10 row_mask:0xf bank_mask:0xf
  v_dot2c_f32_bf16_dpp v84, v21, v210 row_newbcast:10 row_mask:0xf bank_mask:0xf
  v_dot2c_f32_bf16_dpp v85, v29, v210 row_newbcast:10 row_mask:0xf bank_mask:0xf
  v_dot2c_f32_bf16_dpp v86, v21, v211 row_newbcast:10 row_mask:0xf bank_mask:0xf
  v_dot2c_f32_bf16_dpp v87, v29, v211 row_newbcast:10 row_mask:0xf bank_mask:0xf
  v_dot2c_f32_bf16_dpp v88, v23, v208 row_newbcast:10 row_mask:0xf bank_mask:0xf
  v_dot2c_f32_bf16_dpp v89, v31, v208 row_newbcast:10 row_mask:0xf bank_mask:0xf
  v_dot2c_f32_bf16_dpp v90, v23, v209 row_newbcast:10 row_mask:0xf bank_mask:0xf
  v_dot2c_f32_bf16_dpp v91, v31, v209 row_newbcast:10 row_mask:0xf bank_mask:0xf
  v_dot2c_f32_bf16_dpp v92, v23, v210 row_newbcast:10 row_mask:0xf bank_mask:0xf
  v_dot2c_f32_bf16_dpp v93, v31, v210 row_newbcast:10 row_mask:0xf bank_mask:0xf
  v_dot2c_f32_bf16_dpp v94, v23, v211 row_newbcast:10 row_mask:0xf bank_mask:0xf
  v_dot2c_f32_bf16_dpp v95, v31, v211 row_newbcast:10 row_mask:0xf bank_mask:0xf
  s_waitcnt vmcnt(3)
  buffer_load_dwordx4 v[228:231], v61, s[28:31], s88 offen
  s_add_u32 s88, s88, 0x400
  v_dot2c_f32_bf16_dpp v64, v17, v212 row_newbcast:11 row_mask:0xf bank_mask:0xf
  v_dot2c_f32_bf16_dpp v65, v25, v212 row_newbcast:11 row_mask:0xf bank_mask:0xf
  v_dot2c_f32_bf16_dpp v66, v17, v213 row_newbcast:11 row_mask:0xf bank_mask:0xf
  v_dot2c_f32_bf16_dpp v67, v25, v213 row_newbcast:11 row_mask:0xf bank_mask:0xf
  v_dot2c_f32_bf16_dpp v68, v17, v214 row_newbcast:11 row_mask:0xf bank_mask:0xf
  v_dot2c_f32_bf16_dpp v69, v25, v214 row_newbcast:11 row_mask:0xf bank_mask:0xf
  v_dot2c_f32_bf16_dpp v70, v17, v215 row_newbcast:11 row_mask:0xf bank_mask:0xf
  v_dot2c_f32_bf16_dpp v71, v25, v215 row_newbcast:11 row_mask:0xf bank_mask:0xf
  v_dot2c_f32_bf16_dpp v72, v19, v212 row_newbcast:11 row_mask:0xf bank_mask:0xf
  v_dot2c_f32_bf16_dpp v73, v27, v212 row_newbcast:11 row_mask:0xf bank_mask:0xf
  v_dot2c_f32_bf16_dpp v74, v19, v213 row_newbcast:11 row_mask:0xf bank_mask:0xf
  v_dot2c_f32_bf16_dpp v75, v27, v213 row_newbcast:11 row_mask:0xf bank_mask:0xf
  v_dot2c_f32_bf16_dpp v76, v19, v214 row_newbcast:11 row_mask:0xf bank_mask:0xf
  v_dot2c_f32_bf16_dpp v77, v27, v214 row_newbcast:11 row_mask:0xf bank_mask:0xf
  v_dot2c_f32_bf16_dpp v78, v19, v215 row_newbcast:11 row_mask:0xf bank_mask:0xf
  v_dot2c_f32_bf16_dpp v79, v27, v215 row_newbcast:11 row_mask:0xf bank_mask:0xf
  v_dot2c_f32_bf16_dpp v80, v21, v212 row_newbcast:11 row_mask:0xf bank_mask:0xf
  v_dot2c_f32_bf16_dpp v81, v29, v212 row_newbcast:11 row_mask:0xf bank_mask:0xf
  v_dot2c_f32_bf16_dpp v82, v21, v213 row_newbcast:11 row_mask:0xf bank_mask:0xf
  v_dot2c_f32_bf16_dpp v83, v29, v213 row_newbcast:11 row_mask:0xf bank_mask:0xf
  v_dot2c_f32_bf16_dpp v84, v21, v214 row_newbcast:11 row_mask:0xf bank_mask:0xf
  v_dot2c_f32_bf16_dpp v85, v29, v214 row_newbcast:11 row_mask:0xf bank_mask:0xf
  v_dot2c_f32_bf16_dpp v86, v21, v215 row_newbcast:11 row_mask:0xf bank_mask:0xf
  v_dot2c_f32_bf16_dpp v87, v29, v215 row_newbcast:11 row_mask:0xf bank_mask:0xf
  v_dot2c_f32_bf16_dpp v88, v23, v212 row_newbcast:11 row_mask:0xf bank_mask:0xf
  v_dot2c_f32_bf16_dpp v89, v31, v212 row_newbcast:11 row_mask:0xf bank_mask:0xf
  v_dot2c_f32_bf16_dpp v90, v23, v213 row_newbcast:11 row_mask:0xf bank_mask:0xf
  v_dot2c_f32_bf16_dpp v91, v31, v213 row_newbcast:11 row_mask:0xf bank_mask:0xf
  v_dot2c_f32_bf16_dpp v92, v23, v214 row_newbcast:11 row_mask:0xf bank_mask:0xf
  v_dot2c_f32_bf16_dpp v93, v31, v214 row_newbcast:11 row_mask:0xf bank_mask:0xf
  v_dot2c_f32_bf16_dpp v94, v23, v215 row_newbcast:11 row_mask:0xf bank_mask:0xf
  v_dot2c_f32_bf16_dpp v95, v31, v215 row_newbcast:11 row_mask:0xf bank_mask:0xf
  s_waitcnt vmcnt(3)
  v_dot2c_f32_bf16_dpp v64, v17, v216 row_newbcast:12 row_mask:0xf bank_mask:0xf
  v_dot2c_f32_bf16_dpp v65, v25, v216 row_newbcast:12 row_mask:0xf bank_mask:0xf
  v_dot2c_f32_bf16_dpp v66, v17, v217 row_newbcast:12 row_mask:0xf bank_mask:0xf
  v_dot2c_f32_bf16_dpp v67, v25, v217 row_newbcast:12 row_mask:0xf bank_mask:0xf
  v_dot2c_f32_bf16_dpp v68, v17, v218 row_newbcast:12 row_mask:0xf bank_mask:0xf
  v_dot2c_f32_bf16_dpp v69, v25, v218 row_newbcast:12 row_mask:0xf bank_mask:0xf
  v_dot2c_f32_bf16_dpp v70, v17, v219 row_newbcast:12 row_mask:0xf bank_mask:0xf
  v_dot2c_f32_bf16_dpp v71, v25, v219 row_newbcast:12 row_mask:0xf bank_mask:0xf
  v_dot2c_f32_bf16_dpp v72, v19, v216 row_newbcast:12 row_mask:0xf bank_mask:0xf
  v_dot2c_f32_bf16_dpp v73, v27, v216 row_newbcast:12 row_mask:0xf bank_mask:0xf
  v_dot2c_f32_bf16_dpp v74, v19, v217 row_newbcast:12 row_mask:0xf bank_mask:0xf
  v_dot2c_f32_bf16_dpp v75, v27, v217 row_newbcast:12 row_mask:0xf bank_mask:0xf
  v_dot2c_f32_bf16_dpp v76, v19, v218 row_newbcast:12 row_mask:0xf bank_mask:0xf
  v_dot2c_f32_bf16_dpp v77, v27, v218 row_newbcast:12 row_mask:0xf bank_mask:0xf
  v_dot2c_f32_bf16_dpp v78, v19, v219 row_newbcast:12 row_mask:0xf bank_mask:0xf
  v_dot2c_f32_bf16_dpp v79, v27, v219 row_newbcast:12 row_mask:0xf bank_mask:0xf
  v_dot2c_f32_bf16_dpp v80, v21, v216 row_newbcast:12 row_mask:0xf bank_mask:0xf
  v_dot2c_f32_bf16_dpp v81, v29, v216 row_newbcast:12 row_mask:0xf bank_mask:0xf
  v_dot2c_f32_bf16_dpp v82, v21, v217 row_newbcast:12 row_mask:0xf bank_mask:0xf
  v_dot2c_f32_bf16_dpp v83, v29, v217 row_newbcast:12 row_mask:0xf bank_mask:0xf
  v_dot2c_f32_bf16_dpp v84, v21, v218 row_newbcast:12 row_mask:0xf bank_mask:0xf
  v_dot2c_f32_bf16_dpp v85, v29, v218 row_newbcast:12 row_mask:0xf bank_mask:0xf
  v_dot2c_f32_bf16_dpp v86, v21, v219 row_newbcast:12 row_mask:0xf bank_mask:0xf
  v_dot2c_f32_bf16_dpp v87, v29, v219 row_newbcast:12 row_mask:0xf bank_mask:0xf
  v_dot2c_f32_bf16_dpp v88, v23, v216 row_newbcast:12 row_mask:0xf bank_mask:0xf
  v_dot2c_f32_bf16_dpp v89, v31, v216 row_newbcast:12 row_mask:0xf bank_mask:0xf
  v_dot2c_f32_bf16_dpp v90, v23, v217 row_newbcast:12 row_mask:0xf bank_mask:0xf
  v_dot2c_f32_bf16_dpp v91, v31, v217 row_newbcast:12 row_mask:0xf bank_mask:0xf
  v_dot2c_f32_bf16_dpp v92, v23, v218 row_newbcast:12 row_mask:0xf bank_mask:0xf
  v_dot2c_f32_bf16_dpp v93, v31, v218 row_newbcast:12 row_mask:0xf bank_mask:0xf
  v_dot2c_f32_bf16_dpp v94, v23, v219 row_newbcast:12 row_mask:0xf bank_mask:0xf
  v_dot2c_f32_bf16_dpp v95, v31, v219 row_newbcast:12 row_mask:0xf bank_mask:0xf
  s_waitcnt vmcnt(2)
  v_dot2c_f32_bf16_dpp v64, v17, v220 row_newbcast:13 row_mask:0xf bank_mask:0xf
  v_dot2c_f32_bf16_dpp v65, v25, v220 row_newbcast:13 row_mask:0xf bank_mask:0xf
  v_dot2c_f32_bf16_dpp v66, v17, v221 row_newbcast:13 row_mask:0xf bank_mask:0xf
  v_dot2c_f32_bf16_dpp v67, v25, v221 row_newbcast:13 row_mask:0xf bank_mask:0xf
  v_dot2c_f32_bf16_dpp v68, v17, v222 row_newbcast:13 row_mask:0xf bank_mask:0xf
  v_dot2c_f32_bf16_dpp v69, v25, v222 row_newbcast:13 row_mask:0xf bank_mask:0xf
  v_dot2c_f32_bf16_dpp v70, v17, v223 row_newbcast:13 row_mask:0xf bank_mask:0xf
  v_dot2c_f32_bf16_dpp v71, v25, v223 row_newbcast:13 row_mask:0xf bank_mask:0xf
  v_dot2c_f32_bf16_dpp v72, v19, v220 row_newbcast:13 row_mask:0xf bank_mask:0xf
  v_dot2c_f32_bf16_dpp v73, v27, v220 row_newbcast:13 row_mask:0xf bank_mask:0xf
  v_dot2c_f32_bf16_dpp v74, v19, v221 row_newbcast:13 row_mask:0xf bank_mask:0xf
  v_dot2c_f32_bf16_dpp v75, v27, v221 row_newbcast:13 row_mask:0xf bank_mask:0xf
  v_dot2c_f32_bf16_dpp v76, v19, v222 row_newbcast:13 row_mask:0xf bank_mask:0xf
  v_dot2c_f32_bf16_dpp v77, v27, v222 row_newbcast:13 row_mask:0xf bank_mask:0xf
  v_dot2c_f32_bf16_dpp v78, v19, v223 row_newbcast:13 row_mask:0xf bank_mask:0xf
  v_dot2c_f32_bf16_dpp v79, v27, v223 row_newbcast:13 row_mask:0xf bank_mask:0xf
  v_dot2c_f32_bf16_dpp v80, v21, v220 row_newbcast:13 row_mask:0xf bank_mask:0xf
  v_dot2c_f32_bf16_dpp v81, v29, v220 row_newbcast:13 row_mask:0xf bank_mask:0xf
  v_dot2c_f32_bf16_dpp v82, v21, v221 row_newbcast:13 row_mask:0xf bank_mask:0xf
  v_dot2c_f32_bf16_dpp v83, v29, v221 row_newbcast:13 row_mask:0xf bank_mask:0xf
  v_dot2c_f32_bf16_dpp v84, v21, v222 row_newbcast:13 row_mask:0xf bank_mask:0xf
  v_dot2c_f32_bf16_dpp v85, v29, v222 row_newbcast:13 row_mask:0xf bank_mask:0xf
  v_dot2c_f32_bf16_dpp v86, v21, v223 row_newbcast:13 row_mask:0xf bank_mask:0xf
  v_dot2c_f32_bf16_dpp v87, v29, v223 row_newbcast:13 row_mask:0xf bank_mask:0xf
  v_dot2c_f32_bf16_dpp v88, v23, v220 row_newbcast:13 row_mask:0xf bank_mask:0xf
  v_dot2c_f32_bf16_dpp v89, v31, v220 row_newbcast:13 row_mask:0xf bank_mask:0xf
  v_dot2c_f32_bf16_dpp v90, v23, v221 row_newbcast:13 row_mask:0xf bank_mask:0xf
  v_dot2c_f32_bf16_dpp v91, v31, v221 row_newbcast:13 row_mask:0xf bank_mask:0xf
  v_dot2c_f32_bf16_dpp v92, v23, v222 row_newbcast:13 row_mask:0xf bank_mask:0xf
  v_dot2c_f32_bf16_dpp v93, v31, v222 row_newbcast:13 row_mask:0xf bank_mask:0xf
  v_dot2c_f32_bf16_dpp v94, v23, v223 row_newbcast:13 row_mask:0xf bank_mask:0xf
  v_dot2c_f32_bf16_dpp v95, v31, v223 row_newbcast:13 row_mask:0xf bank_mask:0xf
  s_waitcnt vmcnt(1)
  v_dot2c_f32_bf16_dpp v64, v17, v224 row_newbcast:14 row_mask:0xf bank_mask:0xf
  v_dot2c_f32_bf16_dpp v65, v25, v224 row_newbcast:14 row_mask:0xf bank_mask:0xf
  v_dot2c_f32_bf16_dpp v66, v17, v225 row_newbcast:14 row_mask:0xf bank_mask:0xf
  v_dot2c_f32_bf16_dpp v67, v25, v225 row_newbcast:14 row_mask:0xf bank_mask:0xf
  v_dot2c_f32_bf16_dpp v68, v17, v226 row_newbcast:14 row_mask:0xf bank_mask:0xf
  v_dot2c_f32_bf16_dpp v69, v25, v226 row_newbcast:14 row_mask:0xf bank_mask:0xf
  v_dot2c_f32_bf16_dpp v70, v17, v227 row_newbcast:14 row_mask:0xf bank_mask:0xf
  v_dot2c_f32_bf16_dpp v71, v25, v227 row_newbcast:14 row_mask:0xf bank_mask:0xf
  v_dot2c_f32_bf16_dpp v72, v19, v224 row_newbcast:14 row_mask:0xf bank_mask:0xf
  v_dot2c_f32_bf16_dpp v73, v27, v224 row_newbcast:14 row_mask:0xf bank_mask:0xf
  v_dot2c_f32_bf16_dpp v74, v19, v225 row_newbcast:14 row_mask:0xf bank_mask:0xf
  v_dot2c_f32_bf16_dpp v75, v27, v225 row_newbcast:14 row_mask:0xf bank_mask:0xf
  v_dot2c_f32_bf16_dpp v76, v19, v226 row_newbcast:14 row_mask:0xf bank_mask:0xf
  v_dot2c_f32_bf16_dpp v77, v27, v226 row_newbcast:14 row_mask:0xf bank_mask:0xf
  v_dot2c_f32_bf16_dpp v78, v19, v227 row_newbcast:14 row_mask:0xf bank_mask:0xf
  v_dot2c_f32_bf16_dpp v79, v27, v227 row_newbcast:14 row_mask:0xf bank_mask:0xf
  v_dot2c_f32_bf16_dpp v80, v21, v224 row_newbcast:14 row_mask:0xf bank_mask:0xf
  v_dot2c_f32_bf16_dpp v81, v29, v224 row_newbcast:14 row_mask:0xf bank_mask:0xf
  v_dot2c_f32_bf16_dpp v82, v21, v225 row_newbcast:14 row_mask:0xf bank_mask:0xf
  v_dot2c_f32_bf16_dpp v83, v29, v225 row_newbcast:14 row_mask:0xf bank_mask:0xf
  v_dot2c_f32_bf16_dpp v84, v21, v226 row_newbcast:14 row_mask:0xf bank_mask:0xf
  v_dot2c_f32_bf16_dpp v85, v29, v226 row_newbcast:14 row_mask:0xf bank_mask:0xf
  v_dot2c_f32_bf16_dpp v86, v21, v227 row_newbcast:14 row_mask:0xf bank_mask:0xf
  v_dot2c_f32_bf16_dpp v87, v29, v227 row_newbcast:14 row_mask:0xf bank_mask:0xf
  v_dot2c_f32_bf16_dpp v88, v23, v224 row_newbcast:14 row_mask:0xf bank_mask:0xf
  v_dot2c_f32_bf16_dpp v89, v31, v224 row_newbcast:14 row_mask:0xf bank_mask:0xf
  v_dot2c_f32_bf16_dpp v90, v23, v225 row_newbcast:14 row_mask:0xf bank_mask:0xf
  v_dot2c_f32_bf16_dpp v91, v31, v225 row_newbcast:14 row_mask:0xf bank_mask:0xf
  v_dot2c_f32_bf16_dpp v92, v23, v226 row_newbcast:14 row_mask:0xf bank_mask:0xf
  v_dot2c_f32_bf16_dpp v93, v31, v226 row_newbcast:14 row_mask:0xf bank_mask:0xf
  v_dot2c_f32_bf16_dpp v94, v23, v227 row_newbcast:14 row_mask:0xf bank_mask:0xf
  v_dot2c_f32_bf16_dpp v95, v31, v227 row_newbcast:14 row_mask:0xf bank_mask:0xf
  s_waitcnt vmcnt(0)
  v_dot2c_f32_bf16_dpp v64, v17, v228 row_newbcast:15 row_mask:0xf bank_mask:0xf
  v_dot2c_f32_bf16_dpp v65, v25, v228 row_newbcast:15 row_mask:0xf bank_mask:0xf
  v_dot2c_f32_bf16_dpp v66, v17, v229 row_newbcast:15 row_mask:0xf bank_mask:0xf
  v_dot2c_f32_bf16_dpp v67, v25, v229 row_newbcast:15 row_mask:0xf bank_mask:0xf
  v_dot2c_f32_bf16_dpp v68, v17, v230 row_newbcast:15 row_mask:0xf bank_mask:0xf
  v_dot2c_f32_bf16_dpp v69, v25, v230 row_newbcast:15 row_mask:0xf bank_mask:0xf
  v_dot2c_f32_bf16_dpp v70, v17, v231 row_newbcast:15 row_mask:0xf bank_mask:0xf
  v_dot2c_f32_bf16_dpp v71, v25, v231 row_newbcast:15 row_mask:0xf bank_mask:0xf
  v_dot2c_f32_bf16_dpp v72, v19, v228 row_newbcast:15 row_mask:0xf bank_mask:0xf
  v_dot2c_f32_bf16_dpp v73, v27, v228 row_newbcast:15 row_mask:0xf bank_mask:0xf
  v_dot2c_f32_bf16_dpp v74, v19, v229 row_newbcast:15 row_mask:0xf bank_mask:0xf
  v_dot2c_f32_bf16_dpp v75, v27, v229 row_newbcast:15 row_mask:0xf bank_mask:0xf
  v_dot2c_f32_bf16_dpp v76, v19, v230 row_newbcast:15 row_mask:0xf bank_mask:0xf
  v_dot2c_f32_bf16_dpp v77, v27, v230 row_newbcast:15 row_mask:0xf bank_mask:0xf
  v_dot2c_f32_bf16_dpp v78, v19, v231 row_newbcast:15 row_mask:0xf bank_mask:0xf
  v_dot2c_f32_bf16_dpp v79, v27, v231 row_newbcast:15 row_mask:0xf bank_mask:0xf
  v_dot2c_f32_bf16_dpp v80, v21, v228 row_newbcast:15 row_mask:0xf bank_mask:0xf
  v_dot2c_f32_bf16_dpp v81, v29, v228 row_newbcast:15 row_mask:0xf bank_mask:0xf
  v_dot2c_f32_bf16_dpp v82, v21, v229 row_newbcast:15 row_mask:0xf bank_mask:0xf
  v_dot2c_f32_bf16_dpp v83, v29, v229 row_newbcast:15 row_mask:0xf bank_mask:0xf
  v_dot2c_f32_bf16_dpp v84, v21, v230 row_newbcast:15 row_mask:0xf bank_mask:0xf
  v_dot2c_f32_bf16_dpp v85, v29, v230 row_newbcast:15 row_mask:0xf bank_mask:0xf
  v_dot2c_f32_bf16_dpp v86, v21, v231 row_newbcast:15 row_mask:0xf bank_mask:0xf
  v_dot2c_f32_bf16_dpp v87, v29, v231 row_newbcast:15 row_mask:0xf bank_mask:0xf
  v_dot2c_f32_bf16_dpp v88, v23, v228 row_newbcast:15 row_mask:0xf bank_mask:0xf
  v_dot2c_f32_bf16_dpp v89, v31, v228 row_newbcast:15 row_mask:0xf bank_mask:0xf
  v_dot2c_f32_bf16_dpp v90, v23, v229 row_newbcast:15 row_mask:0xf bank_mask:0xf
  v_dot2c_f32_bf16_dpp v91, v31, v229 row_newbcast:15 row_mask:0xf bank_mask:0xf
  v_dot2c_f32_bf16_dpp v92, v23, v230 row_newbcast:15 row_mask:0xf bank_mask:0xf
  v_dot2c_f32_bf16_dpp v93, v31, v230 row_newbcast:15 row_mask:0xf bank_mask:0xf
  v_dot2c_f32_bf16_dpp v94, v23, v231 row_newbcast:15 row_mask:0xf bank_mask:0xf
  v_dot2c_f32_bf16_dpp v95, v31, v231 row_newbcast:15 row_mask:0xf bank_mask:0xf
  s_nop 2
  v_lshlrev_b32 v61, 5, v2
  s_lshl_b32 s84, s5, 11
  s_add_u32 s84, s84, 589824
  s_add_u32 s85, s52, 1
  s_and_b32 s85, s85, 0xff
  v_mov_b32 v60, s85
  v_bfi_b32 v64, s7, v60, v64
  v_bfi_b32 v65, s7, v60, v65
  v_bfi_b32 v66, s7, v60, v66
  v_bfi_b32 v67, s7, v60, v67
  v_bfi_b32 v68, s7, v60, v68
  v_bfi_b32 v69, s7, v60, v69
  v_bfi_b32 v70, s7, v60, v70
  v_bfi_b32 v71, s7, v60, v71
  buffer_store_dwordx4 v[64:67], v61, s[40:43], s84 offen sc1
  buffer_store_dwordx4 v[68:71], v61, s[40:43], s84 offen offset:16 sc1
  s_add_u32 s84, s84, 88064
  s_add_u32 s85, s53, 1
  s_and_b32 s85, s85, 0xff
  v_mov_b32 v60, s85
  v_bfi_b32 v72, s7, v60, v72
  v_bfi_b32 v73, s7, v60, v73
  v_bfi_b32 v74, s7, v60, v74
  v_bfi_b32 v75, s7, v60, v75
  v_bfi_b32 v76, s7, v60, v76
  v_bfi_b32 v77, s7, v60, v77
  v_bfi_b32 v78, s7, v60, v78
  v_bfi_b32 v79, s7, v60, v79
  buffer_store_dwordx4 v[72:75], v61, s[40:43], s84 offen sc1
  buffer_store_dwordx4 v[76:79], v61, s[40:43], s84 offen offset:16 sc1
  s_add_u32 s84, s84, 88064
  s_add_u32 s85, s54, 1
  s_and_b32 s85, s85, 0xff
  v_mov_b32 v60, s85
  v_bfi_b32 v80, s7, v60, v80
  v_bfi_b32 v81, s7, v60, v81
  v_bfi_b32 v82, s7, v60, v82
  v_bfi_b32 v83, s7, v60, v83
  v_bfi_b32 v84, s7, v60, v84
  v_bfi_b32 v85, s7, v60, v85
  v_bfi_b32 v86, s7, v60, v86
  v_bfi_b32 v87, s7, v60, v87
  buffer_store_dwordx4 v[80:83], v61, s[40:43], s84 offen sc1
  buffer_store_dwordx4 v[84:87], v61, s[40:43], s84 offen offset:16 sc1
  s_add_u32 s84, s84, 88064
  s_add_u32 s85, s55, 1
  s_and_b32 s85, s85, 0xff
  v_mov_b32 v60, s85
  v_bfi_b32 v88, s7, v60, v88
  v_bfi_b32 v89, s7, v60, v89
  v_bfi_b32 v90, s7, v60, v90
  v_bfi_b32 v91, s7, v60, v91
  v_bfi_b32 v92, s7, v60, v92
  v_bfi_b32 v93, s7, v60, v93
  v_bfi_b32 v94, s7, v60, v94
  v_bfi_b32 v95, s7, v60, v95
  buffer_store_dwordx4 v[88:91], v61, s[40:43], s84 offen sc1
  buffer_store_dwordx4 v[92:95], v61, s[40:43], s84 offen offset:16 sc1
L_noffn_3:
  v_lshlrev_b32 v8, 11, v3
  v_lshl_add_u32 v8, v4, 4, v8
  s_lshl_b32 s84, s61, 17
  s_lshl_b32 s85, s63, 8
  s_add_u32 s84, s84, s85
  v_add_u32 v8, s84, v8
  s_mov_b32 s88, 0
  s_mov_b32 s84, 0x05040100
  s_mov_b32 s85, 0x07060302
  buffer_load_dwordx4 v[64:67], v8, s[16:19], s88 offen offset:0
  buffer_load_dwordx4 v[68:71], v8, s[16:19], s88 offen offset:1024
  s_add_u32 s88, s88, 0x2000
  s_waitcnt vmcnt(1)
  buffer_load_dwordx4 v[72:75], v8, s[16:19], s88 offen offset:0
  s_waitcnt vmcnt(1)
  buffer_load_dwordx4 v[76:79], v8, s[16:19], s88 offen offset:1024
  s_add_u32 s88, s88, 0x2000
  v_perm_b32 v192, v68, v64, s84
  v_perm_b32 v64, v68, v64, s85
  v_perm_b32 v68, v69, v65, s84
  v_perm_b32 v65, v69, v65, s85
  v_perm_b32 v69, v70, v66, s84
  v_perm_b32 v66, v70, v66, s85
  v_perm_b32 v70, v71, v67, s84
  v_perm_b32 v67, v71, v67, s85
  s_waitcnt vmcnt(1)
  buffer_load_dwordx4 v[80:83], v8, s[16:19], s88 offen offset:0
  s_waitcnt vmcnt(1)
  buffer_load_dwordx4 v[84:87], v8, s[16:19], s88 offen offset:1024
  s_add_u32 s88, s88, 0x2000
  v_perm_b32 v71, v76, v72, s84
  v_perm_b32 v72, v76, v72, s85
  v_perm_b32 v76, v77, v73, s84
  v_perm_b32 v73, v77, v73, s85
  v_perm_b32 v77, v78, v74, s84
  v_perm_b32 v74, v78, v74, s85
  v_perm_b32 v78, v79, v75, s84
  v_perm_b32 v75, v79, v75, s85
  s_waitcnt vmcnt(1)
  buffer_load_dwordx4 v[88:91], v8, s[16:19], s88 offen offset:0
  s_waitcnt vmcnt(1)
  buffer_load_dwordx4 v[92:95], v8, s[16:19], s88 offen offset:1024
  s_add_u32 s88, s88, 0x2000
  v_perm_b32 v79, v84, v80, s84
  v_perm_b32 v80, v84, v80, s85
  v_perm_b32 v84, v85, v81, s84
  v_perm_b32 v81, v85, v81, s85
  v_perm_b32 v85, v86, v82, s84
  v_perm_b32 v82, v86, v82, s85
  v_perm_b32 v86, v87, v83, s84
  v_perm_b32 v83, v87, v83, s85
  s_waitcnt vmcnt(1)
  buffer_load_dwordx4 v[96:99], v8, s[16:19], s88 offen offset:0
  s_waitcnt vmcnt(1)
  buffer_load_dwordx4 v[100:103], v8, s[16:19], s88 offen offset:1024
  s_add_u32 s88, s88, 0x2000
  v_perm_b32 v87, v92, v88, s84
  v_perm_b32 v88, v92, v88, s85
  v_perm_b32 v92, v93, v89, s84
  v_perm_b32 v89, v93, v89, s85
  v_perm_b32 v93, v94, v90, s84
  v_perm_b32 v90, v94, v90, s85
  v_perm_b32 v94, v95, v91, s84
  v_perm_b32 v91, v95, v91, s85
  s_waitcnt vmcnt(1)
  buffer_load_dwordx4 v[104:107], v8, s[16:19], s88 offen offset:0
  s_waitcnt vmcnt(1)
  buffer_load_dwordx4 v[108:111], v8, s[16:19], s88 offen offset:1024
  s_add_u32 s88, s88, 0x2000
  v_perm_b32 v95, v100, v96, s84
  v_perm_b32 v96, v100, v96, s85
  v_perm_b32 v100, v101, v97, s84
  v_perm_b32 v97, v101, v97, s85
  v_perm_b32 v101, v102, v98, s84
  v_perm_b32 v98, v102, v98, s85
  v_perm_b32 v102, v103, v99, s84
  v_perm_b32 v99, v103, v99, s85
  s_waitcnt vmcnt(1)
  buffer_load_dwordx4 v[112:115], v8, s[16:19], s88 offen offset:0
  s_waitcnt vmcnt(1)
  buffer_load_dwordx4 v[116:119], v8, s[16:19], s88 offen offset:1024
  s_add_u32 s88, s88, 0x2000
  v_perm_b32 v103, v108, v104, s84
  v_perm_b32 v104, v108, v104, s85
  v_perm_b32 v108, v109, v105, s84
  v_perm_b32 v105, v109, v105, s85
  v_perm_b32 v109, v110, v106, s84
  v_perm_b32 v106, v110, v106, s85
  v_perm_b32 v110, v111, v107, s84
  v_perm_b32 v107, v111, v107, s85
  s_waitcnt vmcnt(1)
  buffer_load_dwordx4 v[120:123], v8, s[16:19], s88 offen offset:0
  s_waitcnt vmcnt(1)
  buffer_load_dwordx4 v[124:127], v8, s[16:19], s88 offen offset:1024
  s_add_u32 s88, s88, 0x2000
  v_perm_b32 v111, v116, v112, s84
  v_perm_b32 v112, v116, v112, s85
  v_perm_b32 v116, v117, v113, s84
  v_perm_b32 v113, v117, v113, s85
  v_perm_b32 v117, v118, v114, s84
  v_perm_b32 v114, v118, v114, s85
  v_perm_b32 v118, v119, v115, s84
  v_perm_b32 v115, v119, v115, s85
  s_waitcnt vmcnt(1)
  buffer_load_dwordx4 v[128:131], v8, s[16:19], s88 offen offset:0
  s_waitcnt vmcnt(1)
  buffer_load_dwordx4 v[132:135], v8, s[16:19], s88 offen offset:1024
  s_add_u32 s88, s88, 0x2000
  v_perm_b32 v119, v124, v120, s84
  v_perm_b32 v120, v124, v120, s85
  v_perm_b32 v124, v125, v121, s84
  v_perm_b32 v121, v125, v121, s85
  v_perm_b32 v125, v126, v122, s84
  v_perm_b32 v122, v126, v122, s85
  v_perm_b32 v126, v127, v123, s84
  v_perm_b32 v123, v127, v123, s85
  s_waitcnt vmcnt(1)
  buffer_load_dwordx4 v[136:139], v8, s[16:19], s88 offen offset:0
  s_waitcnt vmcnt(1)
  buffer_load_dwordx4 v[140:143], v8, s[16:19], s88 offen offset:1024
  s_add_u32 s88, s88, 0x2000
  v_perm_b32 v127, v132, v128, s84
  v_perm_b32 v128, v132, v128, s85
  v_perm_b32 v132, v133, v129, s84
  v_perm_b32 v129, v133, v129, s85
  v_perm_b32 v133, v134, v130, s84
  v_perm_b32 v130, v134, v130, s85
  v_perm_b32 v134, v135, v131, s84
  v_perm_b32 v131, v135, v131, s85
  s_waitcnt vmcnt(1)
  buffer_load_dwordx4 v[144:147], v8, s[16:19], s88 offen offset:0
  s_waitcnt vmcnt(1)
  buffer_load_dwordx4 v[148:151], v8, s[16:19], s88 offen offset:1024
  s_add_u32 s88, s88, 0x2000
  v_perm_b32 v135, v140, v136, s84
  v_perm_b32 v136, v140, v136, s85
  v_perm_b32 v140, v141, v137, s84
  v_perm_b32 v137, v141, v137, s85
  v_perm_b32 v141, v142, v138, s84
  v_perm_b32 v138, v142, v138, s85
  v_perm_b32 v142, v143, v139, s84
  v_perm_b32 v139, v143, v139, s85
  s_waitcnt vmcnt(1)
  buffer_load_dwordx4 v[152:155], v8, s[16:19], s88 offen offset:0
  s_waitcnt vmcnt(1)
  buffer_load_dwordx4 v[156:159], v8, s[16:19], s88 offen offset:1024
  s_add_u32 s88, s88, 0x2000
  v_perm_b32 v143, v148, v144, s84
  v_perm_b32 v144, v148, v144, s85
  v_perm_b32 v148, v149, v145, s84
  v_perm_b32 v145, v149, v145, s85
  v_perm_b32 v149, v150, v146, s84
  v_perm_b32 v146, v150, v146, s85
  v_perm_b32 v150, v151, v147, s84
  v_perm_b32 v147, v151, v147, s85
  s_waitcnt vmcnt(1)
  buffer_load_dwordx4 v[160:163], v8, s[16:19], s88 offen offset:0
  s_waitcnt vmcnt(1)
  buffer_load_dwordx4 v[164:167], v8, s[16:19], s88 offen offset:1024
  s_add_u32 s88, s88, 0x2000
  v_perm_b32 v151, v156, v152, s84
  v_perm_b32 v152, v156, v152, s85
  v_perm_b32 v156, v157, v153, s84
  v_perm_b32 v153, v157, v153, s85
  v_perm_b32 v157, v158, v154, s84
  v_perm_b32 v154, v158, v154, s85
  v_perm_b32 v158, v159, v155, s84
  v_perm_b32 v155, v159, v155, s85
  s_waitcnt vmcnt(1)
  buffer_load_dwordx4 v[168:171], v8, s[16:19], s88 offen offset:0
  s_waitcnt vmcnt(1)
  buffer_load_dwordx4 v[172:175], v8, s[16:19], s88 offen offset:1024
  s_add_u32 s88, s88, 0x2000
  v_perm_b32 v159, v164, v160, s84
  v_perm_b32 v160, v164, v160, s85
  v_perm_b32 v164, v165, v161, s84
  v_perm_b32 v161, v165, v161, s85
  v_perm_b32 v165, v166, v162, s84
  v_perm_b32 v162, v166, v162, s85
  v_perm_b32 v166, v167, v163, s84
  v_perm_b32 v163, v167, v163, s85
  s_waitcnt vmcnt(1)
  buffer_load_dwordx4 v[176:179], v8, s[16:19], s88 offen offset:0
  s_waitcnt vmcnt(1)
  buffer_load_dwordx4 v[180:183], v8, s[16:19], s88 offen offset:1024
  s_add_u32 s88, s88, 0x2000
  v_perm_b32 v167, v172, v168, s84
  v_perm_b32 v168, v172, v168, s85
  v_perm_b32 v172, v173, v169, s84
  v_perm_b32 v169, v173, v169, s85
  v_perm_b32 v173, v174, v170, s84
  v_perm_b32 v170, v174, v170, s85
  v_perm_b32 v174, v175, v171, s84
  v_perm_b32 v171, v175, v171, s85
  s_waitcnt vmcnt(1)
  buffer_load_dwordx4 v[184:187], v8, s[16:19], s88 offen offset:0
  s_waitcnt vmcnt(1)
  buffer_load_dwordx4 v[188:191], v8, s[16:19], s88 offen offset:1024
  v_perm_b32 v175, v180, v176, s84
  v_perm_b32 v176, v180, v176, s85
  v_perm_b32 v180, v181, v177, s84
  v_perm_b32 v177, v181, v177, s85
  v_perm_b32 v181, v182, v178, s84
  v_perm_b32 v178, v182, v178, s85
  v_perm_b32 v182, v183, v179, s84
  v_perm_b32 v179, v183, v179, s85
  s_waitcnt vmcnt(1)
  s_waitcnt vmcnt(0)
  v_perm_b32 v183, v188, v184, s84
  v_perm_b32 v184, v188, v184, s85
  v_perm_b32 v188, v189, v185, s84
  v_perm_b32 v185, v189, v185, s85
  v_perm_b32 v189, v190, v186, s84
  v_perm_b32 v186, v190, v186, s85
  v_perm_b32 v190, v191, v187, s84
  v_perm_b32 v187, v191, v187, s85
  s_cmp_eq_u32 s63, 1
  s_cbranch_scc0 L_join_6
  v_mov_b32 v10, 0
  s_mov_b32 s60, 262144
L_ldsw_7:
  ds_read_b128 v[24:27], v10 offset:22560
  s_waitcnt lgkmcnt(0)
  v_bitop3_b32 v24, v24, v25, v26 bitop3:0x80
  v_and_b32 v24, v24, v27
  s_nop 0
  v_readfirstlane_b32 s84, v24
  s_nop 3
  s_cmp_eq_u32 s84, 1
  s_cbranch_scc1 L_ldsd_8
  s_sub_u32 s60, s60, 1
  s_cbranch_scc1 L_ldsd_8
  s_sleep 8
  s_branch L_ldsw_7
L_ldsd_8:
  v_and_b32 v13, 3, v2
  v_lshlrev_b32 v13, 3, v13
  ds_read_b64 v[24:25], v13 offset:22528
  s_waitcnt lgkmcnt(0)
  s_mov_b32 s85, 0x3fb8aa3b
  v_max_f32_dpp v26, v24, v24 quad_perm:[2,3,0,1] row_mask:0xf bank_mask:0xf
  s_nop 1
  v_max_f32_dpp v26, v26, v26 quad_perm:[1,0,3,2] row_mask:0xf bank_mask:0xf
  v_sub_f32 v27, v24, v26
  v_mul_f32 v27, s85, v27
  v_exp_f32 v27, v27
  s_nop 0
  v_mul_f32 v27, v27, v25
  s_nop 1
  v_add_f32_dpp v27, v27, v27 quad_perm:[2,3,0,1] row_mask:0xf bank_mask:0xf
  s_nop 1
  v_add_f32_dpp v27, v27, v27 quad_perm:[1,0,3,2] row_mask:0xf bank_mask:0xf
  v_mov_b32 v28, v26
  v_mov_b32 v29, v27
  v_bfi_b32 v28, s7, v12, v28
  v_bfi_b32 v29, s7, v12, v29
  v_mov_b32 v30, v28
  v_mov_b32 v31, v29
  v_and_b32 v26, 0xffffff00, v26
  v_and_b32 v27, 0xffffff00, v27
  s_lshl_b32 s86, s2, 7
  s_add_u32 s86, s86, 524288
  s_mov_b64 exec, 1
  buffer_store_dwordx4 v[28:31], v10, s[40:43], s86 offen sc1
  buffer_store_dwordx4 v[28:31], v10, s[40:43], s86 offen offset:16 sc1
  s_mov_b64 exec, -1
  s_mov_b32 s60, 262144
L_ldsw_9:
  ds_read_b32 v30, v10 offset:22576
  s_waitcnt lgkmcnt(0)
  v_readfirstlane_b32 s84, v30
  s_nop 3
  s_cmp_ge_u32 s84, 20
  s_cbranch_scc1 L_ldsd_10
  s_sub_u32 s60, s60, 1
  s_cbranch_scc1 L_ldsd_10
  s_sleep 16
  s_branch L_ldsw_9
L_ldsd_10:
  v_lshlrev_b32 v10, 11, v2
  s_mul_i32 s86, s62, 88064
  s_lshl_b32 s87, s4, 5
  s_add_u32 s86, s86, s87
  s_add_u32 s86, s86, 589824
  v_mov_b32 v32, 0
  v_mov_b32 v33, 0
  v_mov_b32 v34, 0
  v_mov_b32 v35, 0
  v_mov_b32 v36, 0
  v_mov_b32 v37, 0
  v_mov_b32 v38, 0
  v_mov_b32 v39, 0
  s_mov_b32 exec_hi, 0x7ff
  s_mov_b32 s60, 262144
L_poll_11:
  buffer_load_dwordx4 v[32:35], v10, s[40:43], s86 offen sc1
  buffer_load_dwordx4 v[36:39], v10, s[40:43], s86 offen offset:16 sc1
  s_waitcnt vmcnt(0)
  v_bitop3_b32 v15, v32, v33, v34 bitop3:0x80
  v_or3_b32 v13, v32, v33, v34
  v_bitop3_b32 v15, v15, v35, v36 bitop3:0x80
  v_or3_b32 v13, v13, v35, v36
  v_bitop3_b32 v15, v15, v37, v38 bitop3:0x80
  v_or3_b32 v13, v13, v37, v38
  v_and_b32 v15, v15, v39
  v_or_b32 v13, v13, v39
  v_bitop3_b32 v15, v15, v13, v12 bitop3:0x7e
  v_and_b32 v15, 0xff, v15
  v_cmp_ne_u32 vcc, 0, v15
  s_sub_u32 s60, s60, 1
  s_cbranch_scc1 L_polldone_12
  s_and_b64 exec, exec, vcc
  s_cbranch_scc0 L_polldone_12
  s_sleep 16
  s_branch L_poll_11
L_polldone_12:
  s_mov_b64 exec, -1
  v_and_b32 v32, 0xffffff00, v32
  v_and_b32 v33, 0xffffff00, v33
  v_and_b32 v34, 0xffffff00, v34
  v_and_b32 v35, 0xffffff00, v35
  v_and_b32 v36, 0xffffff00, v36
  v_and_b32 v37, 0xffffff00, v37
  v_and_b32 v38, 0xffffff00, v38
  v_and_b32 v39, 0xffffff00, v39
  s_nop 1
  v_permlane32_swap_b32 v32, v36
  v_permlane32_swap_b32 v33, v37
  v_permlane32_swap_b32 v34, v38
  v_permlane32_swap_b32 v35, v39
  v_add_f32 v32, v32, v36
  v_add_f32 v33, v33, v37
  v_add_f32 v34, v34, v38
  v_add_f32 v35, v35, v39
  s_nop 0
  v_permlane16_swap_b32 v32, v34
  v_permlane16_swap_b32 v33, v35
  v_add_f32 v32, v32, v34
  v_add_f32 v33, v33, v35
  s_nop 1
  v_add_f32_dpp v32, v32, v32 row_ror:8 row_mask:0xf bank_mask:0x3
  v_add_f32_dpp v32, v33, v33 row_ror:8 row_mask:0xf bank_mask:0xc
  s_nop 1
  v_add_f32_dpp v32, v32, v32 row_half_mirror row_mask:0xf bank_mask:0xf
  s_nop 1
  v_add_f32_dpp v32, v32, v32 quad_perm:[2,3,0,1] row_mask:0xf bank_mask:0xf
  s_nop 1
  v_add_f32_dpp v32, v32, v32 quad_perm:[1,0,3,2] row_mask:0xf bank_mask:0xf
  v_cvt_pk_bf16_f32 v32, v32, v32
  v_and_b32 v32, 0xffff0000, v32
  v_mul_f32 v33, 0xbfb8aa3b, v32
  v_exp_f32 v33, v33
  s_nop 0
  v_add_f32 v33, 1.0, v33
  v_rcp_f32 v34, v33
  s_nop 0
  v_mul_f32 v35, v32, v34
  v_cvt_pk_bf16_f32 v35, v35, v35
  v_and_b32 v35, 0xffff0000, v35
  v_lshrrev_b32 v13, 3, v2
  v_lshlrev_b32 v13, 2, v13
  ds_write_b32 v13, v35 offset:22624
  s_xor_b32 s86, s2, 32
  s_lshl_b32 s86, s86, 7
  s_add_u32 s86, s86, 524288
  v_mov_b32 v10, 0
  s_mov_b32 s60, 262144
L_poll_13:
  buffer_load_dwordx4 v[44:47], v10, s[40:43], s86 offen sc1
  buffer_load_dwordx4 v[48:51], v10, s[40:43], s86 offen offset:16 sc1
  s_waitcnt vmcnt(0)
  v_bitop3_b32 v15, v44, v45, v46 bitop3:0x80
  v_or3_b32 v13, v44, v45, v46
  v_bitop3_b32 v15, v15, v47, v48 bitop3:0x80
  v_or3_b32 v13, v13, v47, v48
  v_bitop3_b32 v15, v15, v49, v50 bitop3:0x80
  v_or3_b32 v13, v13, v49, v50
  v_and_b32 v15, v15, v51
  v_or_b32 v13, v13, v51
  v_bitop3_b32 v15, v15, v13, v12 bitop3:0x7e
  v_and_b32 v15, 0xff, v15
  v_cmp_ne_u32 vcc, 0, v15
  s_sub_u32 s60, s60, 1
  s_cbranch_scc1 L_polldone_14
  s_and_b64 exec, exec, vcc
  s_cbranch_scc0 L_polldone_14
  s_sleep 16
  s_branch L_poll_13
L_polldone_14:
  s_mov_b64 exec, -1
  v_and_b32 v44, 0xffffff00, v44
  v_and_b32 v45, 0xffffff00, v45
  v_and_b32 v46, 0xffffff00, v46
  v_and_b32 v47, 0xffffff00, v47
  v_and_b32 v48, 0xffffff00, v48
  v_and_b32 v49, 0xffffff00, v49
  v_and_b32 v50, 0xffffff00, v50
  v_and_b32 v51, 0xffffff00, v51
  v_mov_b32 v28, v44
  v_mov_b32 v29, v45
  v_max_f32 v30, v26, v28
  v_sub_f32 v31, v26, v30
  v_mul_f32 v31, s85, v31
  v_exp_f32 v31, v31
  v_sub_f32 v40, v28, v30
  v_mul_f32 v40, s85, v40
  v_exp_f32 v40, v40
  v_sub_f32 v41, v24, v30
  v_mul_f32 v41, s85, v41
  v_exp_f32 v41, v41
  v_mul_f32 v31, v31, v27
  v_fmac_f32 v31, v40, v29
  v_rcp_f32 v40, v31
  s_nop 0
  v_mul_f32 v42, v41, v40
  v_fma_f32 v43, -v42, v31, v41
  v_fmac_f32 v42, v43, v40
  v_and_b32 v13, 3, v2
  v_lshlrev_b32 v13, 2, v13
  ds_write_b32 v13, v42 offset:22592
L_join_6:
  s_cmp_eq_u32 s63, 2
  s_cbranch_scc0 L_noctl_15
  v_mov_b32 v10, 0
  s_mov_b32 s60, 262144
L_ldsw_16:
  ds_read_b32 v30, v10 offset:22576
  s_waitcnt lgkmcnt(0)
  v_readfirstlane_b32 s84, v30
  s_nop 3
  s_cmp_ge_u32 s84, 10
  s_cbranch_scc1 L_ldsd_17
  s_sub_u32 s60, s60, 1
  s_cbranch_scc1 L_ldsd_17
  s_sleep 8
  s_branch L_ldsw_16
L_ldsd_17:
  s_memrealtime s[94:95]
  s_mov_b32 s85, 1048576
  s_lshl_b32 s87, s2, 7
  v_mov_b32 v26, s87
  s_waitcnt lgkmcnt(0)
  s_and_b32 s94, s94, 0xffff
  s_or_b32 s94, s94, s93
  v_mov_b32 v27, s94
  s_mov_b64 exec, 1
  buffer_store_dword v27, v26, s[40:43], s85 offen sc1
  s_mov_b64 exec, -1
  s_mov_b32 s60, 262144
L_ldsw_18:
  ds_read_b32 v30, v10 offset:22576
  s_waitcnt lgkmcnt(0)
  v_readfirstlane_b32 s84, v30
  s_nop 3
  s_cmp_ge_u32 s84, 11
  s_cbranch_scc1 L_ldsd_19
  s_sub_u32 s60, s60, 1
  s_cbranch_scc1 L_ldsd_19
  s_sleep 8
  s_branch L_ldsw_18
L_ldsd_19:
  v_mov_b32 v28, 0
  s_mov_b64 exec, 255
  buffer_load_dword v28, v32, s[40:43], s85 offen sc1
  s_mov_b64 exec, -1
  s_waitcnt vmcnt(0)
  v_xor_b32 v29, s93, v28
  v_lshrrev_b32 v29, 16, v29
  v_cmp_eq_u32 vcc, 0, v29
  v_sub_u32 v28, v28, v27
  v_bfe_i32 v28, v28, 0, 16
  v_add_u32 v29, 1500, v28
  s_mov_b64 s[86:87], vcc
  v_cmp_gt_u32 vcc, 3000, v29
  s_and_b64 s[86:87], s[86:87], 255
  s_and_b64 vcc, vcc, s[86:87]
  v_cvt_f32_i32 v28, v28
  s_bcnt1_i32_b64 s84, vcc
  v_cndmask_b32 v28, 0, v28, vcc
  s_max_u32 s84, s84, 1
  v_cvt_f32_u32 v29, s84
  s_nop 1
  v_add_f32_dpp v28, v28, v28 row_ror:8 row_mask:0xf bank_mask:0xf
  s_nop 1
  v_add_f32_dpp v28, v28, v28 row_ror:4 row_mask:0xf bank_mask:0xf
  s_nop 1
  v_add_f32_dpp v28, v28, v28 row_ror:2 row_mask:0xf bank_mask:0xf
  s_nop 1
  v_add_f32_dpp v28, v28, v28 row_ror:1 row_mask:0xf bank_mask:0xf
  v_mov_b32 v30, v28
  s_nop 1
  v_permlane16_swap_b32 v28, v30
  v_add_f32 v28, v28, v30
  v_mov_b32 v30, v28
  s_nop 1
  v_permlane32_swap_b32 v28, v30
  v_add_f32 v28, v28, v30
  v_rcp_f32 v29, v29
  s_nop 0
  v_mul_f32 v28, v28, v29
  v_mul_f32 v28, 0xbd088889, v28
  v_add_f32 v28, 0x3f000000, v28
  v_max_f32 v28, 0, v28
  v_cvt_u32_f32 v28, v28
  v_min_u32 v28, 3, v28
  s_nop 0
  v_readfirstlane_b32 s84, v28
  s_nop 3
  s_bfm_b32 s84, s84, 12
  s_or_b32 s92, s92, s84
  v_mov_b32 v28, s92
  s_mov_b64 exec, 15
  ds_write_b32 v25, v28 offset:22784
  s_mov_b64 exec, -1
  v_mov_b32 v10, 0
  s_mov_b32 s60, 262144
L_ldsw_20:
  ds_read_b32 v30, v10 offset:22576
  s_waitcnt lgkmcnt(0)
  v_readfirstlane_b32 s84, v30
  s_nop 3
  s_cmp_ge_u32 s84, 14
  s_cbranch_scc1 L_ldsd_21
  s_sub_u32 s60, s60, 1
  s_cbranch_scc1 L_ldsd_21
  s_sleep 8
  s_branch L_ldsw_20
L_ldsd_21:
  s_memrealtime s[94:95]
  s_mov_b32 s85, 1081344
  s_lshl_b32 s87, s2, 7
  v_mov_b32 v26, s87
  s_waitcnt lgkmcnt(0)
  s_and_b32 s94, s94, 0xffff
  s_or_b32 s94, s94, s93
  v_mov_b32 v27, s94
  s_mov_b64 exec, 1
  buffer_store_dword v27, v26, s[40:43], s85 offen sc1
  s_mov_b64 exec, -1
  s_mov_b32 s60, 262144
L_ldsw_22:
  ds_read_b32 v30, v10 offset:22576
  s_waitcnt lgkmcnt(0)
  v_readfirstlane_b32 s84, v30
  s_nop 3
  s_cmp_ge_u32 s84, 17
  s_cbranch_scc1 L_ldsd_23
  s_sub_u32 s60, s60, 1
  s_cbranch_scc1 L_ldsd_23
  s_sleep 8
  s_branch L_ldsw_22
L_ldsd_23:
  v_mov_b32 v28, 0
  s_mov_b64 exec, 255
  buffer_load_dword v28, v32, s[40:43], s85 offen sc1
  s_mov_b64 exec, -1
  s_waitcnt vmcnt(0)
  v_xor_b32 v29, s93, v28
  v_lshrrev_b32 v29, 16, v29
  v_cmp_eq_u32 vcc, 0, v29
  v_sub_u32 v28, v28, v27
  v_bfe_i32 v28, v28, 0, 16
  v_add_u32 v29, 1500, v28
  s_mov_b64 s[86:87], vcc
  v_cmp_gt_u32 vcc, 3000, v29
  s_and_b64 s[86:87], s[86:87], 255
  s_and_b64 vcc, vcc, s[86:87]
  v_cvt_f32_i32 v28, v28
  s_bcnt1_i32_b64 s84, vcc
  v_cndmask_b32 v28, 0, v28, vcc
  s_max_u32 s84, s84, 1
  v_cvt_f32_u32 v29, s84
  s_nop 1
  v_add_f32_dpp v28, v28, v28 row_ror:8 row_mask:0xf bank_mask:0xf
  s_nop 1
  v_add_f32_dpp v28, v28, v28 row_ror:4 row_mask:0xf bank_mask:0xf
  s_nop 1
  v_add_f32_dpp v28, v28, v28 row_ror:2 row_mask:0xf bank_mask:0xf
  s_nop 1
  v_add_f32_dpp v28, v28, v28 row_ror:1 row_mask:0xf bank_mask:0xf
  v_mov_b32 v30, v28
  s_nop 1
  v_permlane16_swap_b32 v28, v30
  v_add_f32 v28, v28, v30
  v_mov_b32 v30, v28
  s_nop 1
  v_permlane32_swap_b32 v28, v30
  v_add_f32 v28, v28, v30
  v_rcp_f32 v29, v29
  s_nop 0
  v_mul_f32 v28, v28, v29
  v_mul_f32 v28, 0xbd088889, v28
  v_add_f32 v28, 0x3f000000, v28
  v_max_f32 v28, 0, v28
  v_cvt_u32_f32 v28, v28
  v_min_u32 v28, 4, v28
  s_nop 0
  v_readfirstlane_b32 s84, v28
  s_nop 3
  s_bfm_b32 s84, s84, 18
  s_or_b32 s92, s92, s84
  v_mov_b32 v28, s92
  s_mov_b64 exec, 15
  ds_write_b32 v25, v28 offset:22784
  s_mov_b64 exec, -1
  v_mov_b32 v10, 0
  s_mov_b32 s60, 262144
L_ldsw_24:
  ds_read_b32 v30, v10 offset:22576
  s_waitcnt lgkmcnt(0)
  v_readfirstlane_b32 s84, v30
  s_nop 3
  s_cmp_ge_u32 s84, 21
  s_cbranch_scc1 L_ldsd_25
  s_sub_u32 s60, s60, 1
  s_cbranch_scc1 L_ldsd_25
  s_sleep 8
  s_branch L_ldsw_24
L_ldsd_25:
  s_memrealtime s[94:95]
  s_mov_b32 s85, 1114112
  s_lshl_b32 s87, s2, 7
  v_mov_b32 v26, s87
  s_waitcnt lgkmcnt(0)
  s_and_b32 s94, s94, 0xffff
  s_or_b32 s94, s94, s93
  v_mov_b32 v27, s94
  s_mov_b64 exec, 1
  buffer_store_dword v27, v26, s[40:43], s85 offen sc1
  s_mov_b64 exec, -1
  s_mov_b32 s60, 262144
L_ldsw_26:
  ds_read_b32 v30, v10 offset:22576
  s_waitcnt lgkmcnt(0)
  v_readfirstlane_b32 s84, v30
  s_nop 3
  s_cmp_ge_u32 s84, 22
  s_cbranch_scc1 L_ldsd_27
  s_sub_u32 s60, s60, 1
  s_cbranch_scc1 L_ldsd_27
  s_sleep 8
  s_branch L_ldsw_26
L_ldsd_27:
  v_mov_b32 v28, 0
  s_mov_b64 exec, 255
  buffer_load_dword v28, v32, s[40:43], s85 offen sc1
  s_mov_b64 exec, -1
  s_waitcnt vmcnt(0)
  v_xor_b32 v29, s93, v28
  v_lshrrev_b32 v29, 16, v29
  v_cmp_eq_u32 vcc, 0, v29
  v_sub_u32 v28, v28, v27
  v_bfe_i32 v28, v28, 0, 16
  v_add_u32 v29, 1500, v28
  s_mov_b64 s[86:87], vcc
  v_cmp_gt_u32 vcc, 3000, v29
  s_and_b64 s[86:87], s[86:87], 255
  s_and_b64 vcc, vcc, s[86:87]
  v_cvt_f32_i32 v28, v28
  s_bcnt1_i32_b64 s84, vcc
  v_cndmask_b32 v28, 0, v28, vcc
  s_max_u32 s84, s84, 1
  v_cvt_f32_u32 v29, s84
  s_nop 1
  v_add_f32_dpp v28, v28, v28 row_ror:8 row_mask:0xf bank_mask:0xf
  s_nop 1
  v_add_f32_dpp v28, v28, v28 row_ror:4 row_mask:0xf bank_mask:0xf
  s_nop 1
  v_add_f32_dpp v28, v28, v28 row_ror:2 row_mask:0xf bank_mask:0xf
  s_nop 1
  v_add_f32_dpp v28, v28, v28 row_ror:1 row_mask:0xf bank_mask:0xf
  v_mov_b32 v30, v28
  s_nop 1
  v_permlane16_swap_b32 v28, v30
  v_add_f32 v28, v28, v30
  v_mov_b32 v30, v28
  s_nop 1
  v_permlane32_swap_b32 v28, v30
  v_add_f32 v28, v28, v30
  v_rcp_f32 v29, v29
  s_nop 0
  v_mul_f32 v28, v28, v29
  v_mul_f32 v28, 0xbd088889, v28
  v_add_f32 v28, 0x3f000000, v28
  v_max_f32 v28, 0, v28
  v_cvt_u32_f32 v28, v28
  v_min_u32 v28, 4, v28
  s_nop 0
  v_readfirstlane_b32 s84, v28
  s_nop 3
  s_bfm_b32 s84, s84, 23
  s_or_b32 s92, s92, s84
  v_mov_b32 v28, s92
  s_mov_b64 exec, 15
  ds_write_b32 v25, v28 offset:22784
  s_mov_b64 exec, -1
  v_mov_b32 v10, 0
  s_mov_b32 s60, 262144
L_ldsw_28:
  ds_read_b32 v30, v10 offset:22576
  s_waitcnt lgkmcnt(0)
  v_readfirstlane_b32 s84, v30
  s_nop 3
  s_cmp_ge_u32 s84, 26
  s_cbranch_scc1 L_ldsd_29
  s_sub_u32 s60, s60, 1
  s_cbranch_scc1 L_ldsd_29
  s_sleep 8
  s_branch L_ldsw_28
L_ldsd_29:
  s_memrealtime s[94:95]
  s_mov_b32 s85, 1146880
  s_lshl_b32 s87, s2, 7
  v_mov_b32 v26, s87
  s_waitcnt lgkmcnt(0)
  s_and_b32 s94, s94, 0xffff
  s_or_b32 s94, s94, s93
  v_mov_b32 v27, s94
  s_mov_b64 exec, 1
  buffer_store_dword v27, v26, s[40:43], s85 offen sc1
  s_mov_b64 exec, -1
  s_mov_b32 s60, 262144
L_ldsw_30:
  ds_read_b32 v30, v10 offset:22576
  s_waitcnt lgkmcnt(0)
  v_readfirstlane_b32 s84, v30
  s_nop 3
  s_cmp_ge_u32 s84, 27
  s_cbranch_scc1 L_ldsd_31
  s_sub_u32 s60, s60, 1
  s_cbranch_scc1 L_ldsd_31
  s_sleep 8
  s_branch L_ldsw_30
L_ldsd_31:
  v_mov_b32 v28, 0
  s_mov_b64 exec, 255
  buffer_load_dword v28, v32, s[40:43], s85 offen sc1
  s_mov_b64 exec, -1
  s_waitcnt vmcnt(0)
  v_xor_b32 v29, s93, v28
  v_lshrrev_b32 v29, 16, v29
  v_cmp_eq_u32 vcc, 0, v29
  v_sub_u32 v28, v28, v27
  v_bfe_i32 v28, v28, 0, 16
  v_add_u32 v29, 1500, v28
  s_mov_b64 s[86:87], vcc
  v_cmp_gt_u32 vcc, 3000, v29
  s_and_b64 s[86:87], s[86:87], 255
  s_and_b64 vcc, vcc, s[86:87]
  v_cvt_f32_i32 v28, v28
  s_bcnt1_i32_b64 s84, vcc
  v_cndmask_b32 v28, 0, v28, vcc
  s_max_u32 s84, s84, 1
  v_cvt_f32_u32 v29, s84
  s_nop 1
  v_add_f32_dpp v28, v28, v28 row_ror:8 row_mask:0xf bank_mask:0xf
  s_nop 1
  v_add_f32_dpp v28, v28, v28 row_ror:4 row_mask:0xf bank_mask:0xf
  s_nop 1
  v_add_f32_dpp v28, v28, v28 row_ror:2 row_mask:0xf bank_mask:0xf
  s_nop 1
  v_add_f32_dpp v28, v28, v28 row_ror:1 row_mask:0xf bank_mask:0xf
  v_mov_b32 v30, v28
  s_nop 1
  v_permlane16_swap_b32 v28, v30
  v_add_f32 v28, v28, v30
  v_mov_b32 v30, v28
  s_nop 1
  v_permlane32_swap_b32 v28, v30
  v_add_f32 v28, v28, v30
  v_rcp_f32 v29, v29
  s_nop 0
  v_mul_f32 v28, v28, v29
  v_mul_f32 v28, 0xbd088889, v28
  v_add_f32 v28, 0x3f000000, v28
  v_max_f32 v28, 0, v28
  v_cvt_u32_f32 v28, v28
  v_min_u32 v28, 3, v28
  s_nop 0
  v_readfirstlane_b32 s84, v28
  s_nop 3
  s_bfm_b32 s84, s84, 28
  s_or_b32 s92, s92, s84
  v_mov_b32 v28, s92
  s_mov_b64 exec, 15
  ds_write_b32 v25, v28 offset:22784
  s_mov_b64 exec, -1
L_noctl_15:
  s_waitcnt vmcnt(0) lgkmcnt(0)
  s_barrier
  v_mov_b32 v10, 0
  ds_read_b128 v[24:27], v10 offset:22592
  ds_read_b64 v[32:33], v11 offset:18432
  ds_read_b64 v[34:35], v11 offset:18944
  ds_read_b64 v[36:37], v11 offset:19456
  ds_read_b64 v[38:39], v11 offset:19968
  v_mov_b32 v16, 0
  v_mov_b32 v17, 0
  v_mov_b32 v18, 0
  v_mov_b32 v19, 0
  v_mov_b32 v20, 0
  v_mov_b32 v21, 0
  v_mov_b32 v22, 0
  v_mov_b32 v23, 0
  s_lshl_b32 s84, s2, 11
  s_lshl_b32 s85, s63, 9
  s_add_u32 s84, s84, s85
  s_waitcnt lgkmcnt(0)
  v_mul_f32 v28, v24, v32
  v_mul_f32 v29, v24, v33
  v_fmac_f32 v28, v25, v34
  v_fmac_f32 v29, v25, v35
  v_fmac_f32 v28, v26, v36
  v_fmac_f32 v29, v26, v37
  v_fmac_f32 v28, v27, v38
  v_fmac_f32 v29, v27, v39
  v_cvt_pk_bf16_f32 v28, v28, v29
  s_nop 1
  v_dot2c_f32_bf16_dpp v16, v28, v192 row_newbcast:0 row_mask:0xf bank_mask:0xf
  v_dot2c_f32_bf16_dpp v17, v28, v64 row_newbcast:0 row_mask:0xf bank_mask:0xf
  v_dot2c_f32_bf16_dpp v18, v28, v68 row_newbcast:0 row_mask:0xf bank_mask:0xf
  v_dot2c_f32_bf16_dpp v19, v28, v65 row_newbcast:0 row_mask:0xf bank_mask:0xf
  v_dot2c_f32_bf16_dpp v20, v28, v69 row_newbcast:0 row_mask:0xf bank_mask:0xf
  v_dot2c_f32_bf16_dpp v21, v28, v66 row_newbcast:0 row_mask:0xf bank_mask:0xf
  v_dot2c_f32_bf16_dpp v22, v28, v70 row_newbcast:0 row_mask:0xf bank_mask:0xf
  v_dot2c_f32_bf16_dpp v23, v28, v67 row_newbcast:0 row_mask:0xf bank_mask:0xf
  v_dot2c_f32_bf16_dpp v16, v28, v71 row_newbcast:1 row_mask:0xf bank_mask:0xf
  v_dot2c_f32_bf16_dpp v17, v28, v72 row_newbcast:1 row_mask:0xf bank_mask:0xf
  v_dot2c_f32_bf16_dpp v18, v28, v76 row_newbcast:1 row_mask:0xf bank_mask:0xf
  v_dot2c_f32_bf16_dpp v19, v28, v73 row_newbcast:1 row_mask:0xf bank_mask:0xf
  v_dot2c_f32_bf16_dpp v20, v28, v77 row_newbcast:1 row_mask:0xf bank_mask:0xf
  v_dot2c_f32_bf16_dpp v21, v28, v74 row_newbcast:1 row_mask:0xf bank_mask:0xf
  v_dot2c_f32_bf16_dpp v22, v28, v78 row_newbcast:1 row_mask:0xf bank_mask:0xf
  v_dot2c_f32_bf16_dpp v23, v28, v75 row_newbcast:1 row_mask:0xf bank_mask:0xf
  v_dot2c_f32_bf16_dpp v16, v28, v79 row_newbcast:2 row_mask:0xf bank_mask:0xf
  v_dot2c_f32_bf16_dpp v17, v28, v80 row_newbcast:2 row_mask:0xf bank_mask:0xf
  v_dot2c_f32_bf16_dpp v18, v28, v84 row_newbcast:2 row_mask:0xf bank_mask:0xf
  v_dot2c_f32_bf16_dpp v19, v28, v81 row_newbcast:2 row_mask:0xf bank_mask:0xf
  v_dot2c_f32_bf16_dpp v20, v28, v85 row_newbcast:2 row_mask:0xf bank_mask:0xf
  v_dot2c_f32_bf16_dpp v21, v28, v82 row_newbcast:2 row_mask:0xf bank_mask:0xf
  v_dot2c_f32_bf16_dpp v22, v28, v86 row_newbcast:2 row_mask:0xf bank_mask:0xf
  v_dot2c_f32_bf16_dpp v23, v28, v83 row_newbcast:2 row_mask:0xf bank_mask:0xf
  v_dot2c_f32_bf16_dpp v16, v28, v87 row_newbcast:3 row_mask:0xf bank_mask:0xf
  v_dot2c_f32_bf16_dpp v17, v28, v88 row_newbcast:3 row_mask:0xf bank_mask:0xf
  v_dot2c_f32_bf16_dpp v18, v28, v92 row_newbcast:3 row_mask:0xf bank_mask:0xf
  v_dot2c_f32_bf16_dpp v19, v28, v89 row_newbcast:3 row_mask:0xf bank_mask:0xf
  v_dot2c_f32_bf16_dpp v20, v28, v93 row_newbcast:3 row_mask:0xf bank_mask:0xf
  v_dot2c_f32_bf16_dpp v21, v28, v90 row_newbcast:3 row_mask:0xf bank_mask:0xf
  v_dot2c_f32_bf16_dpp v22, v28, v94 row_newbcast:3 row_mask:0xf bank_mask:0xf
  v_dot2c_f32_bf16_dpp v23, v28, v91 row_newbcast:3 row_mask:0xf bank_mask:0xf
  v_dot2c_f32_bf16_dpp v16, v28, v95 row_newbcast:4 row_mask:0xf bank_mask:0xf
  v_dot2c_f32_bf16_dpp v17, v28, v96 row_newbcast:4 row_mask:0xf bank_mask:0xf
  v_dot2c_f32_bf16_dpp v18, v28, v100 row_newbcast:4 row_mask:0xf bank_mask:0xf
  v_dot2c_f32_bf16_dpp v19, v28, v97 row_newbcast:4 row_mask:0xf bank_mask:0xf
  v_dot2c_f32_bf16_dpp v20, v28, v101 row_newbcast:4 row_mask:0xf bank_mask:0xf
  v_dot2c_f32_bf16_dpp v21, v28, v98 row_newbcast:4 row_mask:0xf bank_mask:0xf
  v_dot2c_f32_bf16_dpp v22, v28, v102 row_newbcast:4 row_mask:0xf bank_mask:0xf
  v_dot2c_f32_bf16_dpp v23, v28, v99 row_newbcast:4 row_mask:0xf bank_mask:0xf
  v_dot2c_f32_bf16_dpp v16, v28, v103 row_newbcast:5 row_mask:0xf bank_mask:0xf
  v_dot2c_f32_bf16_dpp v17, v28, v104 row_newbcast:5 row_mask:0xf bank_mask:0xf
  v_dot2c_f32_bf16_dpp v18, v28, v108 row_newbcast:5 row_mask:0xf bank_mask:0xf
  v_dot2c_f32_bf16_dpp v19, v28, v105 row_newbcast:5 row_mask:0xf bank_mask:0xf
  v_dot2c_f32_bf16_dpp v20, v28, v109 row_newbcast:5 row_mask:0xf bank_mask:0xf
  v_dot2c_f32_bf16_dpp v21, v28, v106 row_newbcast:5 row_mask:0xf bank_mask:0xf
  v_dot2c_f32_bf16_dpp v22, v28, v110 row_newbcast:5 row_mask:0xf bank_mask:0xf
  v_dot2c_f32_bf16_dpp v23, v28, v107 row_newbcast:5 row_mask:0xf bank_mask:0xf
  v_dot2c_f32_bf16_dpp v16, v28, v111 row_newbcast:6 row_mask:0xf bank_mask:0xf
  v_dot2c_f32_bf16_dpp v17, v28, v112 row_newbcast:6 row_mask:0xf bank_mask:0xf
  v_dot2c_f32_bf16_dpp v18, v28, v116 row_newbcast:6 row_mask:0xf bank_mask:0xf
  v_dot2c_f32_bf16_dpp v19, v28, v113 row_newbcast:6 row_mask:0xf bank_mask:0xf
  v_dot2c_f32_bf16_dpp v20, v28, v117 row_newbcast:6 row_mask:0xf bank_mask:0xf
  v_dot2c_f32_bf16_dpp v21, v28, v114 row_newbcast:6 row_mask:0xf bank_mask:0xf
  v_dot2c_f32_bf16_dpp v22, v28, v118 row_newbcast:6 row_mask:0xf bank_mask:0xf
  v_dot2c_f32_bf16_dpp v23, v28, v115 row_newbcast:6 row_mask:0xf bank_mask:0xf
  v_dot2c_f32_bf16_dpp v16, v28, v119 row_newbcast:7 row_mask:0xf bank_mask:0xf
  v_dot2c_f32_bf16_dpp v17, v28, v120 row_newbcast:7 row_mask:0xf bank_mask:0xf
  v_dot2c_f32_bf16_dpp v18, v28, v124 row_newbcast:7 row_mask:0xf bank_mask:0xf
  v_dot2c_f32_bf16_dpp v19, v28, v121 row_newbcast:7 row_mask:0xf bank_mask:0xf
  v_dot2c_f32_bf16_dpp v20, v28, v125 row_newbcast:7 row_mask:0xf bank_mask:0xf
  v_dot2c_f32_bf16_dpp v21, v28, v122 row_newbcast:7 row_mask:0xf bank_mask:0xf
  v_dot2c_f32_bf16_dpp v22, v28, v126 row_newbcast:7 row_mask:0xf bank_mask:0xf
  v_dot2c_f32_bf16_dpp v23, v28, v123 row_newbcast:7 row_mask:0xf bank_mask:0xf
  v_dot2c_f32_bf16_dpp v16, v28, v127 row_newbcast:8 row_mask:0xf bank_mask:0xf
  v_dot2c_f32_bf16_dpp v17, v28, v128 row_newbcast:8 row_mask:0xf bank_mask:0xf
  v_dot2c_f32_bf16_dpp v18, v28, v132 row_newbcast:8 row_mask:0xf bank_mask:0xf
  v_dot2c_f32_bf16_dpp v19, v28, v129 row_newbcast:8 row_mask:0xf bank_mask:0xf
  v_dot2c_f32_bf16_dpp v20, v28, v133 row_newbcast:8 row_mask:0xf bank_mask:0xf
  v_dot2c_f32_bf16_dpp v21, v28, v130 row_newbcast:8 row_mask:0xf bank_mask:0xf
  v_dot2c_f32_bf16_dpp v22, v28, v134 row_newbcast:8 row_mask:0xf bank_mask:0xf
  v_dot2c_f32_bf16_dpp v23, v28, v131 row_newbcast:8 row_mask:0xf bank_mask:0xf
  v_dot2c_f32_bf16_dpp v16, v28, v135 row_newbcast:9 row_mask:0xf bank_mask:0xf
  v_dot2c_f32_bf16_dpp v17, v28, v136 row_newbcast:9 row_mask:0xf bank_mask:0xf
  v_dot2c_f32_bf16_dpp v18, v28, v140 row_newbcast:9 row_mask:0xf bank_mask:0xf
  v_dot2c_f32_bf16_dpp v19, v28, v137 row_newbcast:9 row_mask:0xf bank_mask:0xf
  v_dot2c_f32_bf16_dpp v20, v28, v141 row_newbcast:9 row_mask:0xf bank_mask:0xf
  v_dot2c_f32_bf16_dpp v21, v28, v138 row_newbcast:9 row_mask:0xf bank_mask:0xf
  v_dot2c_f32_bf16_dpp v22, v28, v142 row_newbcast:9 row_mask:0xf bank_mask:0xf
  v_dot2c_f32_bf16_dpp v23, v28, v139 row_newbcast:9 row_mask:0xf bank_mask:0xf
  v_dot2c_f32_bf16_dpp v16, v28, v143 row_newbcast:10 row_mask:0xf bank_mask:0xf
  v_dot2c_f32_bf16_dpp v17, v28, v144 row_newbcast:10 row_mask:0xf bank_mask:0xf
  v_dot2c_f32_bf16_dpp v18, v28, v148 row_newbcast:10 row_mask:0xf bank_mask:0xf
  v_dot2c_f32_bf16_dpp v19, v28, v145 row_newbcast:10 row_mask:0xf bank_mask:0xf
  v_dot2c_f32_bf16_dpp v20, v28, v149 row_newbcast:10 row_mask:0xf bank_mask:0xf
  v_dot2c_f32_bf16_dpp v21, v28, v146 row_newbcast:10 row_mask:0xf bank_mask:0xf
  v_dot2c_f32_bf16_dpp v22, v28, v150 row_newbcast:10 row_mask:0xf bank_mask:0xf
  v_dot2c_f32_bf16_dpp v23, v28, v147 row_newbcast:10 row_mask:0xf bank_mask:0xf
  v_dot2c_f32_bf16_dpp v16, v28, v151 row_newbcast:11 row_mask:0xf bank_mask:0xf
  v_dot2c_f32_bf16_dpp v17, v28, v152 row_newbcast:11 row_mask:0xf bank_mask:0xf
  v_dot2c_f32_bf16_dpp v18, v28, v156 row_newbcast:11 row_mask:0xf bank_mask:0xf
  v_dot2c_f32_bf16_dpp v19, v28, v153 row_newbcast:11 row_mask:0xf bank_mask:0xf
  v_dot2c_f32_bf16_dpp v20, v28, v157 row_newbcast:11 row_mask:0xf bank_mask:0xf
  v_dot2c_f32_bf16_dpp v21, v28, v154 row_newbcast:11 row_mask:0xf bank_mask:0xf
  v_dot2c_f32_bf16_dpp v22, v28, v158 row_newbcast:11 row_mask:0xf bank_mask:0xf
  v_dot2c_f32_bf16_dpp v23, v28, v155 row_newbcast:11 row_mask:0xf bank_mask:0xf
  v_dot2c_f32_bf16_dpp v16, v28, v159 row_newbcast:12 row_mask:0xf bank_mask:0xf
  v_dot2c_f32_bf16_dpp v17, v28, v160 row_newbcast:12 row_mask:0xf bank_mask:0xf
  v_dot2c_f32_bf16_dpp v18, v28, v164 row_newbcast:12 row_mask:0xf bank_mask:0xf
  v_dot2c_f32_bf16_dpp v19, v28, v161 row_newbcast:12 row_mask:0xf bank_mask:0xf
  v_dot2c_f32_bf16_dpp v20, v28, v165 row_newbcast:12 row_mask:0xf bank_mask:0xf
  v_dot2c_f32_bf16_dpp v21, v28, v162 row_newbcast:12 row_mask:0xf bank_mask:0xf
  v_dot2c_f32_bf16_dpp v22, v28, v166 row_newbcast:12 row_mask:0xf bank_mask:0xf
  v_dot2c_f32_bf16_dpp v23, v28, v163 row_newbcast:12 row_mask:0xf bank_mask:0xf
  v_dot2c_f32_bf16_dpp v16, v28, v167 row_newbcast:13 row_mask:0xf bank_mask:0xf
  v_dot2c_f32_bf16_dpp v17, v28, v168 row_newbcast:13 row_mask:0xf bank_mask:0xf
  v_dot2c_f32_bf16_dpp v18, v28, v172 row_newbcast:13 row_mask:0xf bank_mask:0xf
  v_dot2c_f32_bf16_dpp v19, v28, v169 row_newbcast:13 row_mask:0xf bank_mask:0xf
  v_dot2c_f32_bf16_dpp v20, v28, v173 row_newbcast:13 row_mask:0xf bank_mask:0xf
  v_dot2c_f32_bf16_dpp v21, v28, v170 row_newbcast:13 row_mask:0xf bank_mask:0xf
  v_dot2c_f32_bf16_dpp v22, v28, v174 row_newbcast:13 row_mask:0xf bank_mask:0xf
  v_dot2c_f32_bf16_dpp v23, v28, v171 row_newbcast:13 row_mask:0xf bank_mask:0xf
  v_dot2c_f32_bf16_dpp v16, v28, v175 row_newbcast:14 row_mask:0xf bank_mask:0xf
  v_dot2c_f32_bf16_dpp v17, v28, v176 row_newbcast:14 row_mask:0xf bank_mask:0xf
  v_dot2c_f32_bf16_dpp v18, v28, v180 row_newbcast:14 row_mask:0xf bank_mask:0xf
  v_dot2c_f32_bf16_dpp v19, v28, v177 row_newbcast:14 row_mask:0xf bank_mask:0xf
  v_dot2c_f32_bf16_dpp v20, v28, v181 row_newbcast:14 row_mask:0xf bank_mask:0xf
  v_dot2c_f32_bf16_dpp v21, v28, v178 row_newbcast:14 row_mask:0xf bank_mask:0xf
  v_dot2c_f32_bf16_dpp v22, v28, v182 row_newbcast:14 row_mask:0xf bank_mask:0xf
  v_dot2c_f32_bf16_dpp v23, v28, v179 row_newbcast:14 row_mask:0xf bank_mask:0xf
  v_dot2c_f32_bf16_dpp v16, v28, v183 row_newbcast:15 row_mask:0xf bank_mask:0xf
  v_dot2c_f32_bf16_dpp v17, v28, v184 row_newbcast:15 row_mask:0xf bank_mask:0xf
  v_dot2c_f32_bf16_dpp v18, v28, v188 row_newbcast:15 row_mask:0xf bank_mask:0xf
  v_dot2c_f32_bf16_dpp v19, v28, v185 row_newbcast:15 row_mask:0xf bank_mask:0xf
  v_dot2c_f32_bf16_dpp v20, v28, v189 row_newbcast:15 row_mask:0xf bank_mask:0xf
  v_dot2c_f32_bf16_dpp v21, v28, v186 row_newbcast:15 row_mask:0xf bank_mask:0xf
  v_dot2c_f32_bf16_dpp v22, v28, v190 row_newbcast:15 row_mask:0xf bank_mask:0xf
  v_dot2c_f32_bf16_dpp v23, v28, v187 row_newbcast:15 row_mask:0xf bank_mask:0xf
  s_nop 2
  v_permlane32_swap_b32 v16, v20
  v_permlane32_swap_b32 v17, v21
  v_permlane32_swap_b32 v18, v22
  v_permlane32_swap_b32 v19, v23
  v_add_f32 v16, v16, v20
  v_add_f32 v17, v17, v21
  v_add_f32 v18, v18, v22
  v_add_f32 v19, v19, v23
  s_nop 0
  v_permlane16_swap_b32 v16, v18
  v_permlane16_swap_b32 v17, v19
  v_add_f32 v16, v16, v18
  v_add_f32 v17, v17, v19
  v_bfi_b32 v16, s7, v12, v16
  v_bfi_b32 v17, s7, v12, v17
  buffer_store_dwordx2 v[16:17], v11, s[40:43], s84 offen sc1
  s_cmp_eq_u32 s63, 0
  s_cbranch_scc0 L_hend_32
  v_lshrrev_b32 v10, 3, v2
  v_lshlrev_b32 v10, 2, v10
  ds_read_b32 v24, v10 offset:22624
  v_lshlrev_b32 v10, 11, v2
  s_lshl_b32 s84, s62, 17
  s_lshl_b32 s85, s4, 5
  s_add_u32 s84, s84, s85
  s_mov_b32 s60, 262144
L_poll_33:
  buffer_load_dwordx4 v[32:35], v10, s[40:43], s84 offen sc1
  buffer_load_dwordx4 v[36:39], v10, s[40:43], s84 offen offset:16 sc1
  s_waitcnt vmcnt(0)
  v_bitop3_b32 v15, v32, v33, v34 bitop3:0x80
  v_or3_b32 v13, v32, v33, v34
  v_bitop3_b32 v15, v15, v35, v36 bitop3:0x80
  v_or3_b32 v13, v13, v35, v36
  v_bitop3_b32 v15, v15, v37, v38 bitop3:0x80
  v_or3_b32 v13, v13, v37, v38
  v_and_b32 v15, v15, v39
  v_or_b32 v13, v13, v39
  v_bitop3_b32 v15, v15, v13, v12 bitop3:0x7e
  v_and_b32 v15, 0xff, v15
  v_cmp_ne_u32 vcc, 0, v15
  s_sub_u32 s60, s60, 1
  s_cbranch_scc1 L_polldone_34
  s_and_b64 exec, exec, vcc
  s_cbranch_scc0 L_polldone_34
  s_sleep 1
  s_branch L_poll_33
L_polldone_34:
  s_mov_b64 exec, -1
  v_and_b32 v32, 0xffffff00, v32
  v_and_b32 v33, 0xffffff00, v33
  v_and_b32 v34, 0xffffff00, v34
  v_and_b32 v35, 0xffffff00, v35
  v_and_b32 v36, 0xffffff00, v36
  v_and_b32 v37, 0xffffff00, v37
  v_and_b32 v38, 0xffffff00, v38
  v_and_b32 v39, 0xffffff00, v39
  s_nop 1
  v_permlane32_swap_b32 v32, v36
  v_permlane32_swap_b32 v33, v37
  v_permlane32_swap_b32 v34, v38
  v_permlane32_swap_b32 v35, v39
  v_add_f32 v32, v32, v36
  v_add_f32 v33, v33, v37
  v_add_f32 v34, v34, v38
  v_add_f32 v35, v35, v39
  s_nop 0
  v_permlane16_swap_b32 v32, v34
  v_permlane16_swap_b32 v33, v35
  v_add_f32 v32, v32, v34
  v_add_f32 v33, v33, v35
  s_nop 1
  v_add_f32_dpp v32, v32, v32 row_ror:8 row_mask:0xf bank_mask:0x3
  v_add_f32_dpp v32, v33, v33 row_ror:8 row_mask:0xf bank_mask:0xc
  s_nop 1
  v_add_f32_dpp v32, v32, v32 row_half_mirror row_mask:0xf bank_mask:0xf
  s_nop 1
  v_add_f32_dpp v32, v32, v32 quad_perm:[2,3,0,1] row_mask:0xf bank_mask:0xf
  s_nop 1
  v_add_f32_dpp v32, v32, v32 quad_perm:[1,0,3,2] row_mask:0xf bank_mask:0xf
  s_waitcnt lgkmcnt(0)
  v_cvt_pk_bf16_f32 v32, v32, v32
  v_and_b32 v32, 0xffff0000, v32
  v_mul_f32 v32, v32, v24
  v_cvt_pk_bf16_f32 v32, v32, v32
  v_and_b32 v32, 0xffff0000, v32
  v_lshlrev_b32 v14, 16, v14
  v_add_f32 v32, v14, v32
  v_cvt_pk_bf16_f32 v32, v32, v32
  v_and_b32 v10, 7, v2
  v_cmp_eq_u32 vcc, 0, v10
  s_nop 1
  s_and_saveexec_b64 s[86:87], vcc
  buffer_store_short v32, v9, s[32:35], 0 offen
  s_mov_b64 exec, s[86:87]
  s_and_b32 s84, s2, 63
  s_cmp_eq_u32 s84, 0
  s_cbranch_scc0 L_hend_32
  v_mov_b32 v10, s89
  v_mov_b32 v13, s6
  s_mov_b64 exec, 1
  buffer_store_dword v13, v10, s[40:43], 0 offen
  s_mov_b64 exec, -1
L_hend_32:
  s_endpgm
L_exit:
  s_endpgm
L_code_end:
.section .rodata,"a"
.p2align 6
.amdhsa_kernel recurrent_scan__mha_block_cached__geglu_ffn__decode_kernel
  .amdhsa_next_free_vgpr 240
  .amdhsa_next_free_sgpr 96
  .amdhsa_accum_offset 240
  .amdhsa_group_segment_fixed_size 0
  .amdhsa_kernarg_size 96
  .amdhsa_user_sgpr_count 2
  .amdhsa_user_sgpr_kernarg_segment_ptr 1
  .amdhsa_system_sgpr_workgroup_id_x 1
  .amdhsa_float_denorm_mode_32 3
.end_amdhsa_kernel
```
